```python
import torch

def _softmax(x, axis=-1):
    return torch.softmax(x, dim=axis)
def _gelu(x):
    return torch.nn.functional.gelu(x, approximate="tanh")
def _silu(x):
    return torch.nn.functional.silu(x)
def _sigmoid(x):
    return torch.sigmoid(x)
def _layernorm(x, axis=-1, eps=1e-5):
    m = x.mean(dim=axis, keepdim=True)
    v = x.var(dim=axis, keepdim=True, unbiased=False)
    return (x - m) / torch.sqrt(v + eps)
def _scatter_add(tgt, idx, src, axis=0):
    return tgt.clone().index_add_(axis, idx, src)
def _segment_sum(src, seg, n):
    out = torch.zeros((n,) + src.shape[1:], dtype=src.dtype)
    return out.index_add_(0, seg, src)
def _pad(x, pw):
    flat = tuple(v for pair in reversed(pw) for v in pair)
    return torch.nn.functional.pad(x, flat)

kernel_name = 'parallel_sum__sliding_local_dilated__dense_activation_gelu__prompt'

def setup_inputs():

    _w = (lambda a: (lambda t: t.to(torch.bfloat16) if t.is_floating_point() else t)(torch.as_tensor(a)))
    def _A_setup():
        B, S, D = 1, 2048, 1024
        return {
            "x": _w((lambda *s: torch.randn(*s, dtype=torch.bfloat16) * 0.05)(B, S, D)),
            "wqkv": _w((lambda *s: torch.randn(*s, dtype=torch.bfloat16) * 0.05)(D, 3 * D)),
            "wo": _w((lambda *s: torch.randn(*s, dtype=torch.bfloat16) * 0.05)(D, D)),
        }
    _A_in = _A_setup()

    def _B_setup():
        B, S, D, F = 1, 2048, 1024, 3584
        return {
            "x": _w((lambda *s: torch.randn(*s, dtype=torch.bfloat16) * 0.05)(B, S, D)),
            "w1": _w((lambda *s: torch.randn(*s, dtype=torch.bfloat16) * 3.2)(D, F) * (D ** -0.5)),
            "b1": _w((lambda *s: torch.randn(*s, dtype=torch.bfloat16) * 3.2)(F) * 0.01),
            "w2": _w((lambda *s: torch.randn(*s, dtype=torch.bfloat16) * 0.4)(F, D) * (F ** -0.5)),
            "b2": _w((lambda *s: torch.randn(*s, dtype=torch.bfloat16) * 0.4)(D) * 0.01),
        }
    _B_in = _B_setup()

    return {
        "A_x": _A_in["x"],
        "A_wqkv": _A_in["wqkv"],
        "A_wo": _A_in["wo"],
        "B_x": _B_in["x"],
        "B_w1": _B_in["w1"],
        "B_b1": _B_in["b1"],
        "B_w2": _B_in["w2"],
        "B_b2": _B_in["b2"],
    }

def reference(A_x, A_wqkv, A_wo, B_x, B_w1, B_b1, B_w2, B_b2):
    def _A_ref(x, wqkv, wo):
        B, S, D = x.shape
        H = 32; Dh = D // H
        W, dil = 8, 2
        qkv = (lambda x, *d: x.permute(*d))((x @ wqkv).reshape(B, S, 3, H, Dh), 2, 0, 3, 1, 4)
        q, k, v = qkv[0], qkv[1], qkv[2]
        scale = Dh ** -0.5
        pos = torch.arange(S)
        off = torch.arange(W) * dil
        idx = pos[:, None] - off[None, :]
        mask = idx >= 0
        idx_c = torch.where(mask, idx, 0).reshape(-1)
        kg = k[:, :, idx_c, :].reshape(B, H, S, W, Dh)
        vg = v[:, :, idx_c, :].reshape(B, H, S, W, Dh)
        logits = torch.einsum("bhsd,bhswd->bhsw", q, kg) * scale
        logits = torch.where(mask[None, None, :, :], logits, -1e9)
        attn = _softmax(logits, axis=-1)
        o = torch.einsum("bhsw,bhswd->bhsd", attn, vg)
        return (lambda x, *d: x.permute(*d))(o, 0, 2, 1, 3).reshape(B, S, D) @ wo

    def _B_ref(x, w1, b1, w2, b2):
        h = torch.einsum("bsd,df->bsf", x, w1) + b1
        h = _gelu(h)
        return torch.einsum("bsf,fd->bsd", h, w2) + b2

    x = A_x
    xn = _layernorm(x, axis=-1)
    return x + _A_ref(xn, A_wqkv, A_wo) + _B_ref(xn, B_w1, B_b1, B_w2, B_b2)
```

```asm
; @launch grid=(256,1,1) block=(256,1,1) lds=163840
.amdgcn_target "amdgcn-amd-amdhsa--gfx950"
.text
.globl parallel_sum__sliding_local_dilated__dense_activation_gelu__prompt_kernel
.p2align 8
.type parallel_sum__sliding_local_dilated__dense_activation_gelu__prompt_kernel,@function
parallel_sum__sliding_local_dilated__dense_activation_gelu__prompt_kernel:
 s_cmp_ge_u32 s2, 256
 s_cbranch_scc1 L_end
 s_load_dwordx16 s[64:79], s[0:1], 0
 s_load_dwordx4 s[80:83], s[0:1], 64
 s_load_dwordx2 s[84:85], s[0:1], 80
 v_lshrrev_b32 v17, 6, v0
 v_and_b32 v0, 63, v0
 v_readfirstlane_b32 s28, v17
 s_and_b32 s29, s2, 1
 s_lshl_b32 s97, s29, 3
 s_lshl_b32 s29, s29, 2
 s_lshr_b32 s3, s2, 6
 s_add_u32 s29, s29, s3
 s_bfe_u32 s63, s2, 0x30003
 s_add_u32 s41, s29, s63
 s_or_b32 s97, s97, 4
 s_and_b32 s34, s41, 3
 s_xor_b32 s34, s34, s97
 s_lshl_b32 s31, s34, 7
 v_lshrrev_b32 v18, 3, v0
 v_lshrrev_b32 v19, 4, v0
 v_and_b32 v20, 7, v0
 v_xor_b32 v21, v20, v19
 v_lshlrev_b32 v18, 11, v18
 v_lshl_add_u32 v18, v21, 4, v18
 s_lshl_b32 s3, s29, 8
 s_lshl_b32 s4, s28, 6
 s_add_u32 s54, s3, s4
 s_lshl_b32 s39, s28, 13
 s_lshl_b32 s4, s54, 11
 v_add_u32 v1, s4, v18
 v_xor_b32 v2, 0x4040, v1
 s_mov_b32 s10, 0x400000
 s_mov_b32 s11, 0x00020000
 s_waitcnt lgkmcnt(0)
 s_mov_b32 s8, s64
 s_and_b32 s9, s65, 0xffff
 s_add_u32 m0, s39, 0
 s_nop 0
 buffer_load_dwordx4 v1, s[8:11], s31 offen lds
 s_add_u32 m0, s39, 1024
 s_nop 0
 buffer_load_dwordx4 v2, s[8:11], s31 offen lds
 s_add_u32 s37, s31, 32768
 s_add_u32 m0, s39, 2048
 s_nop 0
 buffer_load_dwordx4 v1, s[8:11], s37 offen lds
 s_add_u32 m0, s39, 3072
 s_nop 0
 buffer_load_dwordx4 v2, s[8:11], s37 offen lds
 s_add_u32 s37, s31, 65536
 s_add_u32 m0, s39, 4096
 s_nop 0
 buffer_load_dwordx4 v1, s[8:11], s37 offen lds
 s_add_u32 m0, s39, 5120
 s_nop 0
 buffer_load_dwordx4 v2, s[8:11], s37 offen lds
 s_add_u32 s37, s31, 98304
 s_add_u32 m0, s39, 6144
 s_nop 0
 buffer_load_dwordx4 v1, s[8:11], s37 offen lds
 s_add_u32 m0, s39, 7168
 s_nop 0
 buffer_load_dwordx4 v2, s[8:11], s37 offen lds
 s_getpc_b64 s[100:101]
L_pc:
 s_lshr_b32 s4, s2, 3
 s_lshl_b32 s4, s4, 2
 s_add_u32 s4, s4, s28
 s_mul_i32 s4, s4, 512
 s_add_u32 s4, s4, L_main - L_pc
 s_min_u32 s4, s4, L_end - L_pc - 512
 s_add_u32 s100, s100, s4
 s_addc_u32 s101, s101, 0
 v_min_u32 v44, 3, v0
 v_lshlrev_b32 v44, 7, v44
 v_mov_b32 v45, s101
 v_add_co_u32 v44, vcc, s100, v44
 s_nop 1
 v_addc_co_u32 v45, vcc, 0, v45, vcc
 global_load_dword a252, v[44:45], off
 s_bfe_u32 s62, s2, 0x20001
 s_lshl_b32 s30, s62, 3
 s_add_u32 s30, s30, s63
 s_mov_b32 s12, s66
 s_and_b32 s13, s67, 0xffff
 s_mov_b32 s14, 0x600000
 s_mov_b32 s15, 0x00020000
 s_mov_b32 s16, s72
 s_and_b32 s17, s73, 0xffff
 s_mov_b32 s18, 0x700000
 s_mov_b32 s19, 0x00020000
 s_lshl_b32 s46, s28, 10
 s_lshl_b32 s47, s28, 12
 s_mov_b32 s24, s16
 s_mov_b32 s25, s17
 s_cmp_eq_u32 s28, 3
 s_cselect_b32 s26, 0, s18
 s_mov_b32 s27, 0x00020000
 s_mul_i32 s32, s34, 393216
 s_mul_i32 s33, s34, 458752
 s_mul_i32 s4, s28, 98304
 s_add_u32 s56, s63, 7
 s_and_b32 s56, s56, 7
 s_lshl_b32 s38, s62, 3
 s_add_u32 s38, s38, s56
 s_lshl_b32 s38, s38, 6
 s_add_u32 s4, s4, s38
 v_lshrrev_b32 v22, 2, v0
 v_and_b32 v23, 3, v0
 v_and_b32 v24, 2, v19
 v_xor_b32 v24, v24, v23
 v_mul_u32_u24 v26, 6144, v22
 v_lshl_add_u32 v26, v24, 4, v26
 v_add_u32 v3, s4, v26
 v_add_u32 v4, 0x800, v3
 v_add_u32 v5, 0x1000, v3
 s_lshl_b32 s3, s28, 8
 s_mul_i32 s4, s30, 224
 s_movk_i32 s38, 0x1c00
 v_add_u32 v26, s3, v0
 v_mov_b32 v31, s4
 v_mul_u32_u24 v27, 4682, v26
 v_lshrrev_b32 v27, 16, v27
 v_mad_i32_i24 v28, v27, -14, v26
 v_and_b32 v29, 4, v27
 v_bfe_i32 v30, v27, 3, 1
 v_lshl_add_u32 v29, v30, 2, v29
 v_add_u32 v27, v27, v29
 v_mad_u32_u24 v27, v27, s38, v31
 v_lshl_add_u32 v6, v28, 4, v27
 v_add_u32 v26, 64, v26
 v_mul_u32_u24 v27, 4682, v26
 v_lshrrev_b32 v27, 16, v27
 v_mad_i32_i24 v28, v27, -14, v26
 v_and_b32 v29, 4, v27
 v_bfe_i32 v30, v27, 3, 1
 v_lshl_add_u32 v29, v30, 2, v29
 v_add_u32 v27, v27, v29
 v_mad_u32_u24 v27, v27, s38, v31
 v_lshl_add_u32 v7, v28, 4, v27
 v_add_u32 v26, 64, v26
 v_mul_u32_u24 v27, 4682, v26
 v_lshrrev_b32 v27, 16, v27
 v_mad_i32_i24 v28, v27, -14, v26
 v_and_b32 v29, 4, v27
 v_bfe_i32 v30, v27, 3, 1
 v_lshl_add_u32 v29, v30, 2, v29
 v_add_u32 v27, v27, v29
 v_mad_u32_u24 v27, v27, s38, v31
 v_lshl_add_u32 v8, v28, 4, v27
 v_add_u32 v26, 64, v26
 v_mul_u32_u24 v27, 4682, v26
 v_lshrrev_b32 v27, 16, v27
 v_mad_i32_i24 v28, v27, -14, v26
 v_and_b32 v29, 4, v27
 v_bfe_i32 v30, v27, 3, 1
 v_lshl_add_u32 v29, v30, 2, v29
 v_add_u32 v27, v27, v29
 v_mad_u32_u24 v27, v27, s38, v31
 v_lshl_add_u32 v9, v28, 4, v27
 v_and_b32 v32, 15, v0
 v_lshrrev_b32 v21, 1, v32
 v_xor_b32 v21, v21, v19
 v_lshlrev_b32 v21, 4, v21
 v_lshl_add_u32 v21, v32, 7, v21
 v_add_u32 v10, s39, v21
 v_xor_b32 v11, 64, v10
 v_and_b32 v22, 3, v22
 v_lshlrev_b32 v23, 3, v23
 v_lshl_add_u32 v24, v19, 3, v22
 v_lshl_add_u32 v24, v24, 6, v23
 v_and_b32 v25, 1, v19
 v_lshl_add_u32 v24, v25, 5, v24
 v_add_u32 v14, 65536, v24
 v_xor_b32 v15, 32, v14
 v_lshrrev_b32 v26, 1, v19
 v_lshlrev_b32 v26, 4, v26
 v_lshl_add_u32 v26, v25, 2, v26
 v_add_u32 v26, v26, v22
 v_mul_u32_u24 v26, 224, v26
 v_add_u32 v26, v26, v23
 v_add_u32 v16, 102400, v26
 s_and_b32 s3, s28, 1
 s_lshl_b32 s3, s3, 5
 v_xor_b32 v22, s3, v14
 s_lshr_b32 s3, s28, 1
 s_add_u32 s3, s3, 1
 s_lshl_b32 s3, s3, 12
 v_add_u32 v17, s3, v22
 s_add_u32 s3, s41, 1
 s_and_b32 s3, s3, 3
 s_xor_b32 s35, s3, s97
 s_add_u32 m0, s46, 77824
 s_nop 0
 buffer_load_dwordx4 v3, s[12:15], s32 offen lds
 s_add_u32 m0, s46, 81920
 s_nop 0
 buffer_load_dwordx4 v4, s[12:15], s32 offen lds
 s_add_u32 m0, s46, 86016
 s_nop 0
 buffer_load_dwordx4 v5, s[12:15], s32 offen lds
 s_add_u32 m0, s47, 102400
 s_nop 0
 buffer_load_dwordx4 v6, s[16:19], s33 offen lds
 s_add_u32 m0, s47, 103424
 s_nop 0
 buffer_load_dwordx4 v7, s[16:19], s33 offen lds
 s_add_u32 m0, s47, 104448
 s_nop 0
 buffer_load_dwordx4 v8, s[24:27], s33 offen lds
 s_add_u32 m0, s47, 105472
 s_nop 0
 buffer_load_dwordx4 v9, s[24:27], s33 offen lds
 s_xor_b32 s38, s35, 0
 s_lshl_b32 s31, s38, 7
 s_mul_i32 s32, s38, 393216
 s_mul_i32 s33, s38, 458752
 s_add_u32 m0, s46, 90112
 s_nop 0
 buffer_load_dwordx4 v3, s[12:15], s32 offen lds
 s_add_u32 m0, s39, 32768
 s_nop 0
 buffer_load_dwordx4 v1, s[8:11], s31 offen lds
 s_mov_b64 exec, 0
 s_cmp_eq_u32 s28, 1
 s_cbranch_scc1 L_pg1
 s_cmp_eq_u32 s28, 2
 s_cbranch_scc1 L_pg2
 s_cmp_eq_u32 s28, 3
 s_cbranch_scc1 L_pg3
 s_branch L_pg4
.p2align 12
L_main:
 s_mov_b64 exec, -1
 s_waitcnt vmcnt(10)
 ds_read_b128 a[0:3], v10 offset:0
 ds_read_b128 a[4:7], v11 offset:0
 ds_read_b128 a[12:15], v11 offset:2048
 ds_read_b128 a[8:11], v10 offset:2048
 ds_read_b128 a[16:19], v10 offset:4096
 ds_read_b128 a[20:23], v11 offset:4096
 ds_read_b128 a[28:31], v11 offset:6144
 ds_read_b128 a[24:27], v10 offset:6144
 s_waitcnt vmcnt(6)
 s_barrier
 ds_read_b64_tr_b16 a[96:97], v14 offset:12288
 ds_read_b64_tr_b16 a[98:99], v14 offset:12544
 ds_read_b64_tr_b16 a[100:101], v14 offset:14336
 ds_read_b64_tr_b16 a[102:103], v14 offset:14592
 ds_read_b64_tr_b16 a[104:105], v15 offset:12288
 ds_read_b64_tr_b16 a[106:107], v15 offset:12544
 ds_read_b64_tr_b16 a[108:109], v15 offset:14336
 ds_read_b64_tr_b16 a[110:111], v15 offset:14592
 s_waitcnt lgkmcnt(4)
 v_mfma_f32_16x16x32_bf16 v[48:51], a[96:99], a[0:3], 0
 ds_read_b64_tr_b16 a[112:113], v14 offset:16384
 v_mfma_f32_16x16x32_bf16 v[48:51], a[100:103], a[4:7], v[48:51]
 ds_read_b64_tr_b16 a[114:115], v14 offset:16640
 v_mfma_f32_16x16x32_bf16 v[52:55], a[100:103], a[12:15], 0
 ds_read_b64_tr_b16 a[116:117], v14 offset:18432
 s_lshl_b32 s3, s28, 6
 v_add_u32 v23, s3, v16
 v_mov_b32 v28, 0x3f803f80
 v_accvgpr_write_b32 a188, v28
 v_accvgpr_write_b32 a189, v28
 v_accvgpr_write_b32 a190, v28
 v_accvgpr_write_b32 a191, v28
 s_lshl_b32 s3, s63, 1
 s_lshr_b32 s4, s62, 1
 s_add_u32 s3, s3, s4
 s_xor_b32 s3, s3, s97
 s_sub_u32 s4, s3, s41
 v_mfma_f32_16x16x32_bf16 v[52:55], a[96:99], a[8:11], v[52:55]
 ds_read_b64_tr_b16 a[118:119], v14 offset:18688
 s_add_u32 m0, s47, 118784
 v_mfma_f32_16x16x32_bf16 v[56:59], a[96:99], a[16:19], 0
 buffer_load_dwordx4 v6, s[16:19], s33 offen lds
 v_mfma_f32_16x16x32_bf16 v[56:59], a[100:103], a[20:23], v[56:59]
 ds_read_b64_tr_b16 a[136:137], v17 offset:12288
 s_add_u32 m0, s39, 33792
 v_mfma_f32_16x16x32_bf16 v[60:63], a[100:103], a[28:31], 0
 buffer_load_dwordx4 v2, s[8:11], s31 offen lds
 v_mfma_f32_16x16x32_bf16 v[60:63], a[96:99], a[24:27], v[60:63]
 ds_read_b64_tr_b16 a[138:139], v17 offset:12544
 s_waitcnt lgkmcnt(6)
 v_mfma_f32_16x16x32_bf16 v[76:79], a[104:107], a[24:27], 0
 ds_read_b64_tr_b16 a[120:121], v15 offset:16384
 v_mfma_f32_16x16x32_bf16 v[76:79], a[108:111], a[28:31], v[76:79]
 ds_read_b64_tr_b16 a[122:123], v15 offset:16640
 v_mfma_f32_16x16x32_bf16 v[72:75], a[108:111], a[20:23], 0
 ds_read_b64_tr_b16 a[124:125], v15 offset:18432
 s_cmp_ge_u32 s3, 14
 s_cselect_b32 s5, 1, 0
 s_cmp_lt_u32 s3, 8
 s_cselect_b32 s5, 3, s5
 s_and_b32 s4, s4, s5
 s_andn2_b32 s3, s3, s5
 s_or_b32 s70, s3, s4
 s_and_b32 s3, s70, 1
 s_lshl_b32 s3, s3, 15
 s_and_b32 s4, s62, 1
 s_lshl_b32 s4, s4, 6
 s_or_b32 s71, s3, s4
 s_add_u32 s3, s41, 2
 s_and_b32 s3, s3, 3
 v_mfma_f32_16x16x32_bf16 v[72:75], a[104:107], a[16:19], v[72:75]
 ds_read_b64_tr_b16 a[126:127], v15 offset:18688
 s_add_u32 m0, s47, 119808
 v_mfma_f32_16x16x32_bf16 v[68:71], a[104:107], a[8:11], 0
 buffer_load_dwordx4 v7, s[16:19], s33 offen lds
 s_add_u32 s37, s31, 32768
 v_mfma_f32_16x16x32_bf16 v[68:71], a[108:111], a[12:15], v[68:71]
 ds_read_b64_tr_b16 a[140:141], v17 offset:14336
 s_add_u32 m0, s39, 34816
 v_mfma_f32_16x16x32_bf16 v[64:67], a[108:111], a[4:7], 0
 buffer_load_dwordx4 v1, s[8:11], s37 offen lds
 v_mfma_f32_16x16x32_bf16 v[64:67], a[104:107], a[0:3], v[64:67]
 ds_read_b64_tr_b16 a[142:143], v17 offset:14592
 s_waitcnt lgkmcnt(8)
 v_mfma_f32_16x16x32_bf16 v[80:83], a[112:115], a[0:3], 0
 ds_read_b64_tr_b16 a[96:97], v14 offset:20480
 v_mfma_f32_16x16x32_bf16 v[80:83], a[116:119], a[4:7], v[80:83]
 ds_read_b64_tr_b16 a[98:99], v14 offset:20736
 v_mfma_f32_16x16x32_bf16 v[84:87], a[116:119], a[12:15], 0
 ds_read_b64_tr_b16 a[100:101], v14 offset:22528
 s_xor_b32 s36, s3, s97
 s_add_u32 s3, s41, 3
 s_and_b32 s3, s3, 3
 s_xor_b32 s41, s3, s97
 s_mov_b32 s20, s84
 s_and_b32 s21, s85, 0xffff
 s_mov_b32 s22, 0x10000000
 s_mov_b32 s23, 0x00020000
 s_mov_b32 s4, s74
 s_and_b32 s5, s75, 0xffff
 s_mov_b32 s6, 0x1c00
 s_mov_b32 s7, 0x00020000
 v_mfma_f32_16x16x32_bf16 v[84:87], a[112:115], a[8:11], v[84:87]
 ds_read_b64_tr_b16 a[102:103], v14 offset:22784
 s_add_u32 m0, s46, 94208
 v_mfma_f32_16x16x32_bf16 v[88:91], a[112:115], a[16:19], 0
 buffer_load_dwordx4 v4, s[12:15], s32 offen lds
 v_mfma_f32_16x16x32_bf16 v[88:91], a[116:119], a[20:23], v[88:91]
 ds_read_b64_tr_b16 a[144:145], v22 offset:12288
 s_add_u32 m0, s39, 35840
 v_mfma_f32_16x16x32_bf16 v[92:95], a[116:119], a[28:31], 0
 buffer_load_dwordx4 v2, s[8:11], s37 offen lds
 v_mfma_f32_16x16x32_bf16 v[92:95], a[112:115], a[24:27], v[92:95]
 ds_read_b64_tr_b16 a[146:147], v22 offset:12544
 s_waitcnt lgkmcnt(8)
 v_mfma_f32_16x16x32_bf16 v[108:111], a[120:123], a[24:27], 0
 ds_read_b64_tr_b16 a[104:105], v15 offset:20480
 v_mfma_f32_16x16x32_bf16 v[108:111], a[124:127], a[28:31], v[108:111]
 ds_read_b64_tr_b16 a[106:107], v15 offset:20736
 v_mfma_f32_16x16x32_bf16 v[104:107], a[124:127], a[20:23], 0
 ds_read_b64_tr_b16 a[108:109], v15 offset:22528
 s_mov_b32 s48, s78
 s_and_b32 s49, s79, 0xffff
 s_mov_b32 s50, 0x800
 s_mov_b32 s51, 0x00020000
 s_lshl_b32 s3, s29, 8
 s_lshl_b32 s58, s30, 3
 s_add_u32 s3, s3, s58
 s_lshl_b32 s58, s28, 1
 s_add_u32 s58, s58, s3
 v_lshrrev_b32 v26, 5, v0
 v_add_u32 v27, s58, v26
 v_and_b32 v28, 31, v0
 v_mfma_f32_16x16x32_bf16 v[104:107], a[120:123], a[16:19], v[104:107]
 ds_read_b64_tr_b16 a[110:111], v15 offset:22784
 s_add_u32 m0, s47, 120832
 v_mfma_f32_16x16x32_bf16 v[100:103], a[120:123], a[8:11], 0
 buffer_load_dwordx4 v8, s[24:27], s33 offen lds
 s_add_u32 s37, s31, 65536
 v_mfma_f32_16x16x32_bf16 v[100:103], a[124:127], a[12:15], v[100:103]
 ds_read_b64_tr_b16 a[148:149], v22 offset:14336
 s_add_u32 m0, s39, 36864
 v_mfma_f32_16x16x32_bf16 v[96:99], a[124:127], a[4:7], 0
 buffer_load_dwordx4 v1, s[8:11], s37 offen lds
 v_mfma_f32_16x16x32_bf16 v[96:99], a[120:123], a[0:3], v[96:99]
 ds_read_b64_tr_b16 a[150:151], v22 offset:14592
 s_waitcnt vmcnt(10)
 s_barrier
 s_waitcnt lgkmcnt(8)
 v_mfma_f32_16x16x32_bf16 v[112:115], a[0:3], a[96:99], 0
 ds_read_b64_tr_b16 a[112:113], v16 offset:0
 v_mfma_f32_16x16x32_bf16 v[112:115], a[4:7], a[100:103], v[112:115]
 ds_read_b64_tr_b16 a[114:115], v16 offset:1792
 v_mfma_f32_16x16x32_bf16 v[116:119], a[12:15], a[100:103], 0
 ds_read_b64_tr_b16 a[116:117], v16 offset:7168
 v_cmp_eq_u32 vcc, 0, v28
 v_bfrev_b32 v30, 1
 v_lshlrev_b32 v29, 2, v27
 v_lshlrev_b32 v27, 11, v27
 v_cndmask_b32 v24, v30, v29, vcc
 v_lshl_add_u32 v47, v28, 4, v27
 s_mul_i32 s52, s30, 224
 s_lshl_b32 s53, s63, 8
 s_lshl_b32 s3, s62, 6
 s_add_u32 s53, s53, s3
 v_lshlrev_b32 v42, 3, v19
 v_lshlrev_b32 v43, 2, v0
 s_cmp_eq_u32 s70, 0
 s_cbranch_scc1 L_cap0
L_capb0:
 v_mfma_f32_16x16x32_bf16 v[116:119], a[8:11], a[96:99], v[116:119]
 ds_read_b64_tr_b16 a[118:119], v16 offset:8960
 s_add_u32 m0, s47, 121856
 v_mfma_f32_16x16x32_bf16 v[120:123], a[16:19], a[96:99], 0
 buffer_load_dwordx4 v9, s[24:27], s33 offen lds
 v_mfma_f32_16x16x32_bf16 v[120:123], a[20:23], a[100:103], v[120:123]
 s_add_u32 m0, s39, 37888
 v_mfma_f32_16x16x32_bf16 v[124:127], a[28:31], a[100:103], 0
 buffer_load_dwordx4 v2, s[8:11], s37 offen lds
 v_mfma_f32_16x16x32_bf16 v[124:127], a[24:27], a[96:99], v[124:127]
 s_waitcnt lgkmcnt(6)
 v_mfma_f32_16x16x32_bf16 v[140:143], a[24:27], a[104:107], 0
 ds_read_b64_tr_b16 a[120:121], v16 offset:32
 v_mfma_f32_16x16x32_bf16 v[140:143], a[28:31], a[108:111], v[140:143]
 ds_read_b64_tr_b16 a[122:123], v16 offset:1824
 v_mfma_f32_16x16x32_bf16 v[136:139], a[20:23], a[108:111], 0
 ds_read_b64_tr_b16 a[124:125], v16 offset:7200
 s_lshl_b32 s3, s29, 2
 s_add_u32 s3, s3, s62
 s_lshl_b32 s3, s3, 2
 s_add_u32 s3, s3, s28
 s_lshl_b32 s3, s3, 9
 s_add_u32 s86, s3, 65536
 s_lshl_b32 s3, s63, 2
 s_add_u32 s89, s86, s3
 s_lshl_b32 s3, s29, 3
 s_add_u32 s88, s3, s63
 s_lshl_b32 s3, s88, 4
 s_add_u32 s3, s3, s28
 v_mfma_f32_16x16x32_bf16 v[136:139], a[16:19], a[104:107], v[136:139]
 ds_read_b64_tr_b16 a[126:127], v16 offset:8992
 s_add_u32 m0, s46, 98304
 v_mfma_f32_16x16x32_bf16 v[132:135], a[8:11], a[104:107], 0
 buffer_load_dwordx4 v5, s[12:15], s32 offen lds
 s_add_u32 s37, s31, 98304
 v_mfma_f32_16x16x32_bf16 v[132:135], a[12:15], a[108:111], v[132:135]
 ds_read_b64_tr_b16 a[152:153], v23 offset:0
 s_add_u32 m0, s39, 38912
 v_mfma_f32_16x16x32_bf16 v[128:131], a[4:7], a[108:111], 0
 buffer_load_dwordx4 v1, s[8:11], s37 offen lds
 v_mfma_f32_16x16x32_bf16 v[128:131], a[0:3], a[104:107], v[128:131]
 ds_read_b64_tr_b16 a[154:155], v23 offset:1792
 s_waitcnt lgkmcnt(6)
 v_mfma_f32_16x16x32_bf16 v[144:147], a[112:115], a[0:3], 0
 ds_read_b64_tr_b16 a[96:97], v16 offset:64
 v_mfma_f32_16x16x32_bf16 v[144:147], a[116:119], a[4:7], v[144:147]
 ds_read_b64_tr_b16 a[98:99], v16 offset:1856
 v_mfma_f32_16x16x32_bf16 v[148:151], a[116:119], a[12:15], 0
 ds_read_b64_tr_b16 a[100:101], v16 offset:7232
 s_lshl_b32 s3, s3, 9
 s_add_u32 s90, s3, 131072
 s_lshl_b32 s3, s62, 11
 s_add_u32 s87, s90, s3
 v_lshlrev_b32 v26, 7, v0
 v_add_u32 v26, s89, v26
 s_sub_u32 s3, s87, 512
 v_lshl_add_u32 v27, v0, 7, s3
 v_cmp_gt_u32 vcc, 4, v0
 s_movk_i32 s96, 8192
 s_nop 0
 v_cndmask_b32 v26, v27, v26, vcc
 v_cmp_gt_u32 vcc, 8, v0
 v_mfma_f32_16x16x32_bf16 v[148:151], a[112:115], a[8:11], v[148:151]
 ds_read_b64_tr_b16 a[102:103], v16 offset:9024
 s_add_u32 m0, s39, 39936
 v_mfma_f32_16x16x32_bf16 v[152:155], a[112:115], a[16:19], 0
 buffer_load_dwordx4 v2, s[8:11], s37 offen lds
 s_xor_b32 s38, s36, 0
 s_lshl_b32 s31, s38, 7
 v_mfma_f32_16x16x32_bf16 v[152:155], a[116:119], a[20:23], v[152:155]
 ds_read_b64_tr_b16 a[156:157], v23 offset:7168
 s_mul_i32 s32, s38, 393216
 s_mul_i32 s33, s38, 458752
 s_add_u32 m0, s46, 65536
 v_mfma_f32_16x16x32_bf16 v[156:159], a[116:119], a[28:31], 0
 buffer_load_dwordx4 v3, s[12:15], s32 offen lds
 v_mfma_f32_16x16x32_bf16 v[156:159], a[112:115], a[24:27], v[156:159]
 ds_read_b64_tr_b16 a[158:159], v23 offset:8960
 v_mfma_f32_16x16x32_bf16 a[172:175], a[144:147], a[188:191], 0
 v_mfma_f32_16x16x32_bf16 a[172:175], a[148:151], a[188:191], a[172:175]
 s_waitcnt lgkmcnt(8)
 v_mfma_f32_16x16x32_bf16 v[172:175], a[120:123], a[24:27], 0
 ds_read_b64_tr_b16 a[104:105], v16 offset:96
 v_mfma_f32_16x16x32_bf16 v[172:175], a[124:127], a[28:31], v[172:175]
 ds_read_b64_tr_b16 a[106:107], v16 offset:1888
 v_mfma_f32_16x16x32_bf16 v[168:171], a[124:127], a[20:23], 0
 ds_read_b64_tr_b16 a[108:109], v16 offset:7264
 v_cndmask_b32 v25, v30, v26, vcc
 v_accvgpr_write_b32 a249, v25
 s_lshr_b32 s91, s54, 4
 s_mul_i32 s3, s91, 144
 s_mul_i32 s91, s62, 36
 s_add_u32 s3, s3, s91
 s_lshl_b32 s3, s3, 10
 s_add_u32 s91, s3, 1048576
 s_lshl_b32 s3, s29, 5
 v_mov_b32 v27, s3
 v_or_b32 v26, s28, v0
 v_cmp_eq_u32 vcc, 0, v26
 v_mfma_f32_16x16x32_bf16 v[168:171], a[120:123], a[16:19], v[168:171]
 ds_read_b64_tr_b16 a[110:111], v16 offset:9056
 s_add_u32 m0, s39, 0
 v_mfma_f32_16x16x32_bf16 v[164:167], a[120:123], a[8:11], 0
 buffer_load_dwordx4 v1, s[8:11], s31 offen lds
 v_mfma_f32_16x16x32_bf16 v[164:167], a[124:127], a[12:15], v[164:167]
 ds_read_b64_tr_b16 a[160:161], v23 offset:32
 s_add_u32 m0, s47, 135168
 v_mfma_f32_16x16x32_bf16 v[160:163], a[124:127], a[4:7], 0
 buffer_load_dwordx4 v6, s[16:19], s33 offen lds
 v_mfma_f32_16x16x32_bf16 v[160:163], a[120:123], a[0:3], v[160:163]
 ds_read_b64_tr_b16 a[162:163], v23 offset:1824
 v_mfma_f32_16x16x32_bf16 a[176:179], a[136:139], a[188:191], 0
 v_mfma_f32_16x16x32_bf16 a[176:179], a[140:143], a[188:191], a[176:179]
 s_waitcnt lgkmcnt(8)
 v_mfma_f32_16x16x32_bf16 v[176:179], a[96:99], a[0:3], 0
 ds_read_b64_tr_b16 a[112:113], v16 offset:128
 v_mfma_f32_16x16x32_bf16 v[176:179], a[100:103], a[4:7], v[176:179]
 ds_read_b64_tr_b16 a[114:115], v16 offset:1920
 v_mfma_f32_16x16x32_bf16 v[180:183], a[100:103], a[12:15], 0
 ds_read_b64_tr_b16 a[116:117], v16 offset:7296
 v_and_b32 v26, 7, v0
 v_lshlrev_b32 v18, 5, v26
 v_cndmask_b32 v31, -16, v27, vcc
 v_and_b32 v27, 3, v0
 v_lshlrev_b32 v27, 4, v27
 v_bfe_u32 v26, v0, 2, 2
 v_lshl_add_u32 v35, v26, 7, v27
 v_lshl_add_u32 v35, v19, 10, v35
 s_lshl_b32 s3, s28, 1
 s_add_u32 s3, s3, 4
 v_add_u32 v26, s3, v19
 s_add_u32 s3, s28, 2
 v_mfma_f32_16x16x32_bf16 v[180:183], a[96:99], a[8:11], v[180:183]
 ds_read_b64_tr_b16 a[118:119], v16 offset:9088
 s_add_u32 m0, s39, 1024
 v_mfma_f32_16x16x32_bf16 v[184:187], a[96:99], a[16:19], 0
 buffer_load_dwordx4 v2, s[8:11], s31 offen lds
 v_mfma_f32_16x16x32_bf16 v[184:187], a[100:103], a[20:23], v[184:187]
 ds_read_b64_tr_b16 a[164:165], v23 offset:7200
 s_add_u32 m0, s47, 136192
 v_mfma_f32_16x16x32_bf16 v[188:191], a[100:103], a[28:31], 0
 buffer_load_dwordx4 v7, s[16:19], s33 offen lds
 s_add_u32 s37, s31, 32768
 v_mfma_f32_16x16x32_bf16 v[188:191], a[96:99], a[24:27], v[188:191]
 ds_read_b64_tr_b16 a[166:167], v23 offset:8992
 v_mfma_f32_16x16x32_bf16 a[180:183], a[152:155], a[188:191], 0
 s_waitcnt lgkmcnt(12)
 v_mfma_f32_16x16x32_bf16 a[180:183], a[156:159], a[188:191], a[180:183]
 s_waitcnt lgkmcnt(8)
 v_mfma_f32_16x16x32_bf16 v[204:207], a[104:107], a[24:27], 0
 ds_read_b64_tr_b16 a[120:121], v16 offset:160
 v_mfma_f32_16x16x32_bf16 v[204:207], a[108:111], a[28:31], v[204:207]
 ds_read_b64_tr_b16 a[122:123], v16 offset:1952
 v_mfma_f32_16x16x32_bf16 v[200:203], a[108:111], a[20:23], 0
 ds_read_b64_tr_b16 a[124:125], v16 offset:7328
 v_mov_b32 v28, s3
 v_cmp_eq_u32 vcc, 1, v19
 s_and_b32 s3, s28, 1
 s_nop 0
 v_cndmask_b32 v26, v26, v28, vcc
 v_mov_b32 v28, s3
 v_cmp_eq_u32 vcc, 0, v19
 v_add_u32 v27, 151552, v27
 s_nop 0
 v_cndmask_b32 v26, v26, v28, vcc
 v_lshl_add_u32 v34, v26, 6, v27
 v_subrev_u32 v32, 20, v0
 v_min_u32 v32, v32, v0
 s_sub_u32 s3, s54, 16
 v_mfma_f32_16x16x32_bf16 v[200:203], a[104:107], a[16:19], v[200:203]
 ds_read_b64_tr_b16 a[126:127], v16 offset:9120
 s_add_u32 m0, s39, 2048
 v_mfma_f32_16x16x32_bf16 v[196:199], a[104:107], a[8:11], 0
 buffer_load_dwordx4 v1, s[8:11], s37 offen lds
 v_mfma_f32_16x16x32_bf16 v[196:199], a[108:111], a[12:15], v[196:199]
 s_add_u32 m0, s46, 69632
 v_mfma_f32_16x16x32_bf16 v[192:195], a[108:111], a[4:7], 0
 buffer_load_dwordx4 v4, s[12:15], s32 offen lds
 v_mfma_f32_16x16x32_bf16 v[192:195], a[104:107], a[0:3], v[192:195]
 s_waitcnt lgkmcnt(6)
 v_mfma_f32_16x16x32_bf16 v[208:211], a[112:115], a[0:3], 0
 ds_read_b64_tr_b16 a[96:97], v16 offset:192
 v_mfma_f32_16x16x32_bf16 v[208:211], a[116:119], a[4:7], v[208:211]
 ds_read_b64_tr_b16 a[98:99], v16 offset:1984
 v_mfma_f32_16x16x32_bf16 v[212:215], a[116:119], a[12:15], 0
 ds_read_b64_tr_b16 a[100:101], v16 offset:7360
 v_lshl_add_u32 v32, v32, 2, s3
 v_max_i32 v32, 0, v32
 v_cmp_gt_u32 vcc, 20, v0
 v_lshlrev_b32 v32, 2, v32
 v_add_u32 v26, 8192, v32
 v_cndmask_b32 v32, v26, v32, vcc
 v_bfe_u32 v26, v0, 2, 3
 v_lshrrev_b32 v33, 2, v0
 v_lshlrev_b32 v33, 8, v33
 v_lshl_add_u32 v33, v26, 5, v33
 v_and_b32 v26, 3, v0
 v_lshl_add_u32 v33, v26, 3, v33
 v_mfma_f32_16x16x32_bf16 v[212:215], a[112:115], a[8:11], v[212:215]
 ds_read_b64_tr_b16 a[102:103], v16 offset:9152
 v_mfma_f32_16x16x32_bf16 v[216:219], a[112:115], a[16:19], 0
 v_mfma_f32_16x16x32_bf16 v[216:219], a[116:119], a[20:23], v[216:219]
 v_mfma_f32_16x16x32_bf16 v[220:223], a[116:119], a[28:31], 0
 v_mfma_f32_16x16x32_bf16 v[220:223], a[112:115], a[24:27], v[220:223]
 v_mfma_f32_16x16x32_bf16 a[184:187], a[160:163], a[188:191], 0
 s_waitcnt lgkmcnt(8)
 v_mfma_f32_16x16x32_bf16 a[184:187], a[164:167], a[188:191], a[184:187]
 s_waitcnt vmcnt(7) lgkmcnt(0)
 s_barrier
 v_mfma_f32_16x16x32_bf16 v[236:239], a[120:123], a[24:27], 0
 ds_read_b64_tr_b16 a[104:105], v14 offset:24576
 v_mfma_f32_16x16x32_bf16 v[236:239], a[124:127], a[28:31], v[236:239]
 ds_read_b64_tr_b16 a[106:107], v14 offset:24832
 v_mfma_f32_16x16x32_bf16 v[232:235], a[124:127], a[20:23], 0
 ds_read_b64_tr_b16 a[108:109], v14 offset:26624
 v_accvgpr_write_b32 a128, v31
 v_accvgpr_write_b32 a129, v18
 v_accvgpr_write_b32 a130, v35
 v_accvgpr_write_b32 a131, v34
 v_accvgpr_write_b32 a132, v32
 v_accvgpr_write_b32 a133, v33
 s_lshl_b32 s3, s63, 8
 v_lshlrev_b32 v21, 1, v19
 v_and_b32 v26, 15, v0
 v_xor_b32 v21, v21, v26
 v_lshlrev_b32 v26, 11, v19
 v_lshl_add_u32 v21, v21, 4, v26
 v_mfma_f32_16x16x32_bf16 v[232:235], a[120:123], a[16:19], v[232:235]
 ds_read_b64_tr_b16 a[110:111], v14 offset:26880
 v_mfma_f32_16x16x32_bf16 v[228:231], a[120:123], a[8:11], 0
 ds_read_b128 a[32:35], v10 offset:32768
 v_mfma_f32_16x16x32_bf16 v[228:231], a[124:127], a[12:15], v[228:231]
 ds_read_b128 a[36:39], v11 offset:32768
 v_mfma_f32_16x16x32_bf16 v[224:227], a[124:127], a[4:7], 0
 ds_read_b128 a[44:47], v11 offset:34816
 v_mfma_f32_16x16x32_bf16 v[224:227], a[120:123], a[0:3], v[224:227]
 ds_read_b128 a[40:43], v10 offset:34816
 v_mfma_f32_16x16x32_bf16 v[240:243], a[96:99], a[0:3], 0
 ds_read_b64_tr_b16 a[112:113], v15 offset:24576
 v_mfma_f32_16x16x32_bf16 v[240:243], a[100:103], a[4:7], v[240:243]
 ds_read_b64_tr_b16 a[114:115], v15 offset:24832
 v_mfma_f32_16x16x32_bf16 v[244:247], a[100:103], a[12:15], 0
 ds_read_b64_tr_b16 a[116:117], v15 offset:26624
 v_add_u32 v20, s3, v21
 v_xor_b32 v21, 0x2080, v20
 s_lshl_b32 s3, s63, 12
 s_add_u32 s56, s91, s3
 s_lshr_b32 s3, s63, 1
 s_lshl_b32 s3, s3, 10
 s_add_u32 s58, s91, s3
 s_and_b32 s3, s63, 1
 s_mul_i32 s3, s3, 147456
 s_add_u32 s58, s58, s3
 s_add_u32 s58, s58, 32768
 s_mul_i32 s59, s62, 1835008
 v_mfma_f32_16x16x32_bf16 v[244:247], a[96:99], a[8:11], v[244:247]
 ds_read_b64_tr_b16 a[118:119], v15 offset:26880
 v_mfma_f32_16x16x32_bf16 v[248:251], a[96:99], a[16:19], 0
 ds_read_b128 a[48:51], v10 offset:36864
 v_mfma_f32_16x16x32_bf16 v[248:251], a[100:103], a[20:23], v[248:251]
 ds_read_b128 a[52:55], v11 offset:36864
 v_mfma_f32_16x16x32_bf16 v[252:255], a[100:103], a[28:31], 0
 ds_read_b128 a[60:63], v11 offset:38912
 v_mfma_f32_16x16x32_bf16 v[252:255], a[96:99], a[24:27], v[252:255]
 ds_read_b128 a[56:59], v10 offset:38912
 s_waitcnt lgkmcnt(8)
 v_mfma_f32_16x16x32_bf16 v[48:51], a[104:107], a[32:35], v[48:51]
 ds_read_b64_tr_b16 a[120:121], v14 offset:28672
 v_mfma_f32_16x16x32_bf16 v[48:51], a[108:111], a[36:39], v[48:51]
 ds_read_b64_tr_b16 a[122:123], v14 offset:28928
 v_mfma_f32_16x16x32_bf16 v[52:55], a[108:111], a[44:47], v[52:55]
 ds_read_b64_tr_b16 a[124:125], v14 offset:30720
 s_mul_i32 s3, s28, 229376
 s_add_u32 s44, s59, s3
 s_add_u32 s44, s44, 196608
 s_lshl_b32 s43, s62, 19
 s_mov_b32 s64, 229376
 s_cmp_lt_u32 s28, 2
 s_cselect_b32 s43, s43, s59
 s_cselect_b32 s64, 65536, s64
 s_cselect_b32 s65, 7, 0
 s_and_b32 s3, s28, 1
 s_lshl_b32 s3, s3, 15
 s_add_u32 s43, s43, s3
 s_lshl_b32 s3, s28, 15
 s_add_u32 s59, s59, s3
 s_add_u32 s59, s59, 65536
 s_cmp_eq_u32 s70, 1
 s_cbranch_scc1 L_cap1
L_capb1:
 v_mfma_f32_16x16x32_bf16 v[52:55], a[104:107], a[40:43], v[52:55]
 ds_read_b64_tr_b16 a[126:127], v14 offset:30976
 s_add_u32 m0, s39, 3072
 s_waitcnt lgkmcnt(4)
 v_mfma_f32_16x16x32_bf16 v[56:59], a[104:107], a[48:51], v[56:59]
 buffer_load_dwordx4 v2, s[8:11], s37 offen lds
 v_mfma_f32_16x16x32_bf16 v[56:59], a[108:111], a[52:55], v[56:59]
 s_add_u32 m0, s47, 137216
 v_mfma_f32_16x16x32_bf16 v[60:63], a[108:111], a[60:63], v[60:63]
 buffer_load_dwordx4 v8, s[24:27], s33 offen lds
 s_add_u32 s37, s31, 65536
 v_mfma_f32_16x16x32_bf16 v[60:63], a[104:107], a[56:59], v[60:63]
 v_mfma_f32_16x16x32_bf16 v[76:79], a[112:115], a[56:59], v[76:79]
 ds_read_b64_tr_b16 a[96:97], v15 offset:28672
 v_mfma_f32_16x16x32_bf16 v[76:79], a[116:119], a[60:63], v[76:79]
 ds_read_b64_tr_b16 a[98:99], v15 offset:28928
 v_mfma_f32_16x16x32_bf16 v[72:75], a[116:119], a[52:55], v[72:75]
 ds_read_b64_tr_b16 a[100:101], v15 offset:30720
 s_add_u32 s3, s62, 1
 s_and_b32 s3, s3, 3
 s_lshl_b32 s45, s3, 6
 s_add_u32 s3, s62, 2
 s_and_b32 s3, s3, 3
 s_lshl_b32 s60, s3, 6
 s_add_u32 s3, s62, 3
 s_and_b32 s3, s3, 3
 s_lshl_b32 s61, s3, 6
 s_add_u32 s3, s62, 4
 s_and_b32 s3, s3, 3
 s_lshl_b32 s97, s3, 6
 v_mfma_f32_16x16x32_bf16 v[72:75], a[112:115], a[48:51], v[72:75]
 ds_read_b64_tr_b16 a[102:103], v15 offset:30976
 s_add_u32 m0, s39, 4096
 v_mfma_f32_16x16x32_bf16 v[68:71], a[112:115], a[40:43], v[68:71]
 buffer_load_dwordx4 v1, s[8:11], s37 offen lds
 v_mfma_f32_16x16x32_bf16 v[68:71], a[116:119], a[44:47], v[68:71]
 s_add_u32 m0, s47, 138240
 v_mfma_f32_16x16x32_bf16 v[64:67], a[116:119], a[36:39], v[64:67]
 buffer_load_dwordx4 v9, s[24:27], s33 offen lds
 v_mfma_f32_16x16x32_bf16 v[64:67], a[112:115], a[32:35], v[64:67]
 s_waitcnt lgkmcnt(4)
 v_mfma_f32_16x16x32_bf16 v[80:83], a[120:123], a[32:35], v[80:83]
 ds_read_b64_tr_b16 a[104:105], v14 offset:32768
 v_mfma_f32_16x16x32_bf16 v[80:83], a[124:127], a[36:39], v[80:83]
 ds_read_b64_tr_b16 a[106:107], v14 offset:33024
 v_mfma_f32_16x16x32_bf16 v[84:87], a[124:127], a[44:47], v[84:87]
 ds_read_b64_tr_b16 a[108:109], v14 offset:34816
 v_mfma_f32_16x16x32_bf16 v[84:87], a[120:123], a[40:43], v[84:87]
 ds_read_b64_tr_b16 a[110:111], v14 offset:35072
 s_add_u32 m0, s39, 5120
 v_mfma_f32_16x16x32_bf16 v[88:91], a[120:123], a[48:51], v[88:91]
 buffer_load_dwordx4 v2, s[8:11], s37 offen lds
 v_mfma_f32_16x16x32_bf16 v[88:91], a[124:127], a[52:55], v[88:91]
 s_add_u32 m0, s46, 73728
 v_mfma_f32_16x16x32_bf16 v[92:95], a[124:127], a[60:63], v[92:95]
 buffer_load_dwordx4 v5, s[12:15], s32 offen lds
 s_add_u32 s37, s31, 98304
 v_mfma_f32_16x16x32_bf16 v[92:95], a[120:123], a[56:59], v[92:95]
 s_waitcnt lgkmcnt(4)
 v_mfma_f32_16x16x32_bf16 v[108:111], a[96:99], a[56:59], v[108:111]
 ds_read_b64_tr_b16 a[112:113], v15 offset:32768
 v_mfma_f32_16x16x32_bf16 v[108:111], a[100:103], a[60:63], v[108:111]
 ds_read_b64_tr_b16 a[114:115], v15 offset:33024
 v_mfma_f32_16x16x32_bf16 v[104:107], a[100:103], a[52:55], v[104:107]
 ds_read_b64_tr_b16 a[116:117], v15 offset:34816
 v_mfma_f32_16x16x32_bf16 v[104:107], a[96:99], a[48:51], v[104:107]
 ds_read_b64_tr_b16 a[118:119], v15 offset:35072
 s_add_u32 m0, s39, 6144
 v_mfma_f32_16x16x32_bf16 v[100:103], a[96:99], a[40:43], v[100:103]
 buffer_load_dwordx4 v1, s[8:11], s37 offen lds
 v_mfma_f32_16x16x32_bf16 v[100:103], a[100:103], a[44:47], v[100:103]
 s_add_u32 m0, s39, 7168
 v_mfma_f32_16x16x32_bf16 v[96:99], a[100:103], a[36:39], v[96:99]
 buffer_load_dwordx4 v2, s[8:11], s37 offen lds
 s_and_b32 s99, s34, 12
 v_mfma_f32_16x16x32_bf16 v[96:99], a[96:99], a[32:35], v[96:99]
 s_xor_b32 s99, s99, 0
 s_waitcnt lgkmcnt(4)
 v_mfma_f32_16x16x32_bf16 v[112:115], a[32:35], a[104:107], v[112:115]
 ds_read_b64_tr_b16 a[120:121], v16 offset:16384
 v_mfma_f32_16x16x32_bf16 v[112:115], a[36:39], a[108:111], v[112:115]
 ds_read_b64_tr_b16 a[122:123], v16 offset:18176
 v_mfma_f32_16x16x32_bf16 v[116:119], a[44:47], a[108:111], v[116:119]
 ds_read_b64_tr_b16 a[124:125], v16 offset:23552
 v_mfma_f32_16x16x32_bf16 v[116:119], a[40:43], a[104:107], v[116:119]
 ds_read_b64_tr_b16 a[126:127], v16 offset:25344
 s_lshl_b32 s99, s99, 7
 v_mfma_f32_16x16x32_bf16 v[120:123], a[48:51], a[104:107], v[120:123]
 buffer_load_dwordx4 v[26:29], v47, s[8:11], s99 offen
 s_and_b32 s99, s34, 12
 v_mfma_f32_16x16x32_bf16 v[120:123], a[52:55], a[108:111], v[120:123]
 s_xor_b32 s99, s99, 4
 s_lshl_b32 s99, s99, 7
 v_mfma_f32_16x16x32_bf16 v[124:127], a[60:63], a[108:111], v[124:127]
 buffer_load_dwordx4 v[30:33], v47, s[8:11], s99 offen
 s_and_b32 s99, s34, 12
 v_mfma_f32_16x16x32_bf16 v[124:127], a[56:59], a[104:107], v[124:127]
 s_xor_b32 s99, s99, 8
 s_waitcnt lgkmcnt(4)
 v_mfma_f32_16x16x32_bf16 v[140:143], a[56:59], a[112:115], v[140:143]
 ds_read_b64_tr_b16 a[96:97], v16 offset:16416
 v_mfma_f32_16x16x32_bf16 v[140:143], a[60:63], a[116:119], v[140:143]
 ds_read_b64_tr_b16 a[98:99], v16 offset:18208
 v_mfma_f32_16x16x32_bf16 v[136:139], a[52:55], a[116:119], v[136:139]
 ds_read_b64_tr_b16 a[100:101], v16 offset:23584
 v_mfma_f32_16x16x32_bf16 v[136:139], a[48:51], a[112:115], v[136:139]
 ds_read_b64_tr_b16 a[102:103], v16 offset:25376
 s_lshl_b32 s99, s99, 7
 v_mfma_f32_16x16x32_bf16 v[132:135], a[40:43], a[112:115], v[132:135]
 buffer_load_dwordx4 v[34:37], v47, s[8:11], s99 offen
 s_and_b32 s99, s34, 12
 v_mfma_f32_16x16x32_bf16 v[132:135], a[44:47], a[116:119], v[132:135]
 s_xor_b32 s99, s99, 12
 s_lshl_b32 s99, s99, 7
 v_mfma_f32_16x16x32_bf16 v[128:131], a[36:39], a[116:119], v[128:131]
 buffer_load_dwordx4 v[38:41], v47, s[8:11], s99 offen
 v_mfma_f32_16x16x32_bf16 v[128:131], a[32:35], a[112:115], v[128:131]
 s_waitcnt lgkmcnt(4)
 v_mfma_f32_16x16x32_bf16 v[144:147], a[120:123], a[32:35], v[144:147]
 ds_read_b64_tr_b16 a[104:105], v16 offset:16448
 v_mfma_f32_16x16x32_bf16 v[144:147], a[124:127], a[36:39], v[144:147]
 ds_read_b64_tr_b16 a[106:107], v16 offset:18240
 v_mfma_f32_16x16x32_bf16 v[148:151], a[124:127], a[44:47], v[148:151]
 ds_read_b64_tr_b16 a[108:109], v16 offset:23616
 v_mfma_f32_16x16x32_bf16 v[148:151], a[120:123], a[40:43], v[148:151]
 ds_read_b64_tr_b16 a[110:111], v16 offset:25408
 v_mfma_f32_16x16x32_bf16 v[152:155], a[120:123], a[48:51], v[152:155]
 buffer_load_dwordx2 a[246:247], v42, s[48:51], s53 offen
 buffer_load_dwordx2 a[250:251], v42, s[48:51], s53 offen offset:32
 buffer_load_dword a254, v43, s[4:7], s52 offen
 v_mfma_f32_16x16x32_bf16 v[152:155], a[124:127], a[52:55], v[152:155]
 v_mfma_f32_16x16x32_bf16 v[156:159], a[124:127], a[60:63], v[156:159]
 buffer_load_dword a252, v24, s[20:23], 0 offen sc1
 buffer_load_dword a253, v24, s[20:23], s96 offen sc1
 buffer_load_dword a255, v25, s[20:23], 0 offen sc1
 v_mfma_f32_16x16x32_bf16 v[156:159], a[120:123], a[56:59], v[156:159]
 s_xor_b32 s38, s41, 0
 s_lshl_b32 s31, s38, 7
 s_waitcnt lgkmcnt(4)
 v_mfma_f32_16x16x32_bf16 v[172:175], a[96:99], a[56:59], v[172:175]
 ds_read_b64_tr_b16 a[112:113], v16 offset:16480
 s_mul_i32 s32, s38, 393216
 v_mfma_f32_16x16x32_bf16 v[172:175], a[100:103], a[60:63], v[172:175]
 ds_read_b64_tr_b16 a[114:115], v16 offset:18272
 s_mul_i32 s33, s38, 458752
 v_mfma_f32_16x16x32_bf16 v[168:171], a[100:103], a[52:55], v[168:171]
 ds_read_b64_tr_b16 a[116:117], v16 offset:23648
 v_mfma_f32_16x16x32_bf16 v[168:171], a[96:99], a[48:51], v[168:171]
 ds_read_b64_tr_b16 a[118:119], v16 offset:25440
 s_add_u32 m0, s46, 77824
 v_mfma_f32_16x16x32_bf16 v[164:167], a[96:99], a[40:43], v[164:167]
 buffer_load_dwordx4 v3, s[12:15], s32 offen lds
 v_mfma_f32_16x16x32_bf16 v[164:167], a[100:103], a[44:47], v[164:167]
L_pg1:
 s_cbranch_execz L_pg5
 s_add_u32 m0, s39, 32768
 v_mfma_f32_16x16x32_bf16 v[160:163], a[100:103], a[36:39], v[160:163]
 buffer_load_dwordx4 v1, s[8:11], s31 offen lds
 v_mfma_f32_16x16x32_bf16 v[160:163], a[96:99], a[32:35], v[160:163]
 s_waitcnt lgkmcnt(4)
 v_mfma_f32_16x16x32_bf16 v[176:179], a[104:107], a[32:35], v[176:179]
 ds_read_b64_tr_b16 a[120:121], v16 offset:16512
 v_mfma_f32_16x16x32_bf16 v[176:179], a[108:111], a[36:39], v[176:179]
 ds_read_b64_tr_b16 a[122:123], v16 offset:18304
 v_mfma_f32_16x16x32_bf16 v[180:183], a[108:111], a[44:47], v[180:183]
 ds_read_b64_tr_b16 a[124:125], v16 offset:23680
 v_mfma_f32_16x16x32_bf16 v[180:183], a[104:107], a[40:43], v[180:183]
 ds_read_b64_tr_b16 a[126:127], v16 offset:25472
 s_add_u32 m0, s47, 102400
 v_mfma_f32_16x16x32_bf16 v[184:187], a[104:107], a[48:51], v[184:187]
 buffer_load_dwordx4 v6, s[16:19], s33 offen lds
 v_mfma_f32_16x16x32_bf16 v[184:187], a[108:111], a[52:55], v[184:187]
 s_add_u32 m0, s39, 33792
 v_mfma_f32_16x16x32_bf16 v[188:191], a[108:111], a[60:63], v[188:191]
 buffer_load_dwordx4 v2, s[8:11], s31 offen lds
 v_mfma_f32_16x16x32_bf16 v[188:191], a[104:107], a[56:59], v[188:191]
 s_waitcnt lgkmcnt(4)
 v_mfma_f32_16x16x32_bf16 v[204:207], a[112:115], a[56:59], v[204:207]
 ds_read_b64_tr_b16 a[96:97], v16 offset:16544
 v_mfma_f32_16x16x32_bf16 v[204:207], a[116:119], a[60:63], v[204:207]
 ds_read_b64_tr_b16 a[98:99], v16 offset:18336
 v_mfma_f32_16x16x32_bf16 v[200:203], a[116:119], a[52:55], v[200:203]
 ds_read_b64_tr_b16 a[100:101], v16 offset:23712
 v_mfma_f32_16x16x32_bf16 v[200:203], a[112:115], a[48:51], v[200:203]
 ds_read_b64_tr_b16 a[102:103], v16 offset:25504
 s_add_u32 m0, s47, 103424
 v_mfma_f32_16x16x32_bf16 v[196:199], a[112:115], a[40:43], v[196:199]
 buffer_load_dwordx4 v7, s[16:19], s33 offen lds
 s_add_u32 s37, s31, 32768
 v_mfma_f32_16x16x32_bf16 v[196:199], a[116:119], a[44:47], v[196:199]
 s_add_u32 m0, s39, 34816
 v_mfma_f32_16x16x32_bf16 v[192:195], a[116:119], a[36:39], v[192:195]
 buffer_load_dwordx4 v1, s[8:11], s37 offen lds
 v_mfma_f32_16x16x32_bf16 v[192:195], a[112:115], a[32:35], v[192:195]
 s_waitcnt lgkmcnt(4)
 v_mfma_f32_16x16x32_bf16 v[208:211], a[120:123], a[32:35], v[208:211]
 ds_read_b64_tr_b16 a[104:105], v16 offset:16576
 v_mfma_f32_16x16x32_bf16 v[208:211], a[124:127], a[36:39], v[208:211]
 ds_read_b64_tr_b16 a[106:107], v16 offset:18368
 v_mfma_f32_16x16x32_bf16 v[212:215], a[124:127], a[44:47], v[212:215]
 ds_read_b64_tr_b16 a[108:109], v16 offset:23744
 v_mfma_f32_16x16x32_bf16 v[212:215], a[120:123], a[40:43], v[212:215]
 ds_read_b64_tr_b16 a[110:111], v16 offset:25536
 s_add_u32 m0, s46, 81920
 v_mfma_f32_16x16x32_bf16 v[216:219], a[120:123], a[48:51], v[216:219]
 buffer_load_dwordx4 v4, s[12:15], s32 offen lds
 v_mfma_f32_16x16x32_bf16 v[216:219], a[124:127], a[52:55], v[216:219]
 v_mfma_f32_16x16x32_bf16 v[220:223], a[124:127], a[60:63], v[220:223]
 v_mfma_f32_16x16x32_bf16 v[220:223], a[120:123], a[56:59], v[220:223]
 s_waitcnt vmcnt(17) lgkmcnt(0)
 s_barrier
 v_mfma_f32_16x16x32_bf16 v[236:239], a[96:99], a[56:59], v[236:239]
 ds_read_b64_tr_b16 a[112:113], v14 offset:0
 v_mfma_f32_16x16x32_bf16 v[236:239], a[100:103], a[60:63], v[236:239]
 ds_read_b64_tr_b16 a[114:115], v14 offset:256
 v_mfma_f32_16x16x32_bf16 v[232:235], a[100:103], a[52:55], v[232:235]
 ds_read_b64_tr_b16 a[116:117], v14 offset:2048
 v_mfma_f32_16x16x32_bf16 v[232:235], a[96:99], a[48:51], v[232:235]
 ds_read_b64_tr_b16 a[118:119], v14 offset:2304
 v_mfma_f32_16x16x32_bf16 v[228:231], a[96:99], a[40:43], v[228:231]
 ds_read_b128 a[64:67], v10 offset:0
 v_mfma_f32_16x16x32_bf16 v[228:231], a[100:103], a[44:47], v[228:231]
 ds_read_b128 a[68:71], v11 offset:0
 v_mfma_f32_16x16x32_bf16 v[224:227], a[100:103], a[36:39], v[224:227]
 ds_read_b128 a[76:79], v11 offset:2048
 v_mfma_f32_16x16x32_bf16 v[224:227], a[96:99], a[32:35], v[224:227]
 ds_read_b128 a[72:75], v10 offset:2048
 v_mfma_f32_16x16x32_bf16 v[240:243], a[104:107], a[32:35], v[240:243]
 ds_read_b64_tr_b16 a[120:121], v15 offset:0
 v_mfma_f32_16x16x32_bf16 v[240:243], a[108:111], a[36:39], v[240:243]
 ds_read_b64_tr_b16 a[122:123], v15 offset:256
 v_mfma_f32_16x16x32_bf16 v[244:247], a[108:111], a[44:47], v[244:247]
 ds_read_b64_tr_b16 a[124:125], v15 offset:2048
 v_mfma_f32_16x16x32_bf16 v[244:247], a[104:107], a[40:43], v[244:247]
 ds_read_b64_tr_b16 a[126:127], v15 offset:2304
 v_mfma_f32_16x16x32_bf16 v[248:251], a[104:107], a[48:51], v[248:251]
 ds_read_b128 a[80:83], v10 offset:4096
 v_mfma_f32_16x16x32_bf16 v[248:251], a[108:111], a[52:55], v[248:251]
 ds_read_b128 a[84:87], v11 offset:4096
 v_mfma_f32_16x16x32_bf16 v[252:255], a[108:111], a[60:63], v[252:255]
 ds_read_b128 a[92:95], v11 offset:6144
 v_mfma_f32_16x16x32_bf16 v[252:255], a[104:107], a[56:59], v[252:255]
 ds_read_b128 a[88:91], v10 offset:6144
 s_waitcnt lgkmcnt(8)
 v_mfma_f32_16x16x32_bf16 v[48:51], a[112:115], a[64:67], v[48:51]
 ds_read_b64_tr_b16 a[96:97], v14 offset:4096
 v_mfma_f32_16x16x32_bf16 v[48:51], a[116:119], a[68:71], v[48:51]
 ds_read_b64_tr_b16 a[98:99], v14 offset:4352
 v_mfma_f32_16x16x32_bf16 v[52:55], a[116:119], a[76:79], v[52:55]
 ds_read_b64_tr_b16 a[100:101], v14 offset:6144
 s_waitcnt vmcnt(16)
 v_lshlrev_b32 v43, 16, v26
 s_cmp_eq_u32 s70, 2
 s_cbranch_scc1 L_cap2
L_capb2:
 v_mfma_f32_16x16x32_bf16 v[52:55], a[112:115], a[72:75], v[52:55]
 ds_read_b64_tr_b16 a[102:103], v14 offset:6400
 s_add_u32 m0, s39, 35840
 s_waitcnt lgkmcnt(4)
 v_mfma_f32_16x16x32_bf16 v[56:59], a[112:115], a[80:83], v[56:59]
 buffer_load_dwordx4 v2, s[8:11], s37 offen lds
 v_and_b32 v18, 0xffff0000, v26
 v_mfma_f32_16x16x32_bf16 v[56:59], a[116:119], a[84:87], v[56:59]
 s_add_u32 m0, s47, 104448
 v_add_f32 v46, v43, v18
 v_lshlrev_b32 v43, 16, v27
 v_mfma_f32_16x16x32_bf16 v[60:63], a[116:119], a[92:95], v[60:63]
 buffer_load_dwordx4 v8, s[24:27], s33 offen lds
 s_add_u32 s37, s31, 65536
 v_mfma_f32_16x16x32_bf16 v[60:63], a[112:115], a[88:91], v[60:63]
 v_and_b32 v18, 0xffff0000, v27
 v_add_f32 v46, v46, v43
 v_mfma_f32_16x16x32_bf16 v[76:79], a[120:123], a[88:91], v[76:79]
 ds_read_b64_tr_b16 a[104:105], v15 offset:4096
 v_add_f32 v46, v46, v18
 v_mfma_f32_16x16x32_bf16 v[76:79], a[124:127], a[92:95], v[76:79]
 ds_read_b64_tr_b16 a[106:107], v15 offset:4352
 v_lshlrev_b32 v43, 16, v28
 v_mfma_f32_16x16x32_bf16 v[72:75], a[124:127], a[84:87], v[72:75]
 ds_read_b64_tr_b16 a[108:109], v15 offset:6144
 v_and_b32 v18, 0xffff0000, v28
 v_mfma_f32_16x16x32_bf16 v[72:75], a[120:123], a[80:83], v[72:75]
 ds_read_b64_tr_b16 a[110:111], v15 offset:6400
 s_add_u32 m0, s39, 36864
 v_mfma_f32_16x16x32_bf16 v[68:71], a[120:123], a[72:75], v[68:71]
 buffer_load_dwordx4 v1, s[8:11], s37 offen lds
 v_add_f32 v46, v46, v43
 v_mfma_f32_16x16x32_bf16 v[68:71], a[124:127], a[76:79], v[68:71]
 v_add_f32 v46, v46, v18
 v_lshlrev_b32 v43, 16, v29
 v_mfma_f32_16x16x32_bf16 v[64:67], a[124:127], a[68:71], v[64:67]
 v_and_b32 v18, 0xffff0000, v29
 v_add_f32 v46, v46, v43
 v_mfma_f32_16x16x32_bf16 v[64:67], a[120:123], a[64:67], v[64:67]
 s_waitcnt lgkmcnt(4)
 v_add_f32 v46, v46, v18
 s_waitcnt vmcnt(18)
 v_lshlrev_b32 v43, 16, v30
 v_mfma_f32_16x16x32_bf16 v[80:83], a[96:99], a[64:67], v[80:83]
 ds_read_b64_tr_b16 a[112:113], v14 offset:8192
 v_and_b32 v18, 0xffff0000, v30
 v_mfma_f32_16x16x32_bf16 v[80:83], a[100:103], a[68:71], v[80:83]
 ds_read_b64_tr_b16 a[114:115], v14 offset:8448
 v_add_f32 v46, v46, v43
 v_mfma_f32_16x16x32_bf16 v[84:87], a[100:103], a[76:79], v[84:87]
 ds_read_b64_tr_b16 a[116:117], v14 offset:10240
 v_add_f32 v46, v46, v18
 v_mfma_f32_16x16x32_bf16 v[84:87], a[96:99], a[72:75], v[84:87]
 ds_read_b64_tr_b16 a[118:119], v14 offset:10496
 s_add_u32 m0, s47, 105472
 v_mfma_f32_16x16x32_bf16 v[88:91], a[96:99], a[80:83], v[88:91]
 buffer_load_dwordx4 v9, s[24:27], s33 offen lds
 v_lshlrev_b32 v43, 16, v31
 v_mfma_f32_16x16x32_bf16 v[88:91], a[100:103], a[84:87], v[88:91]
 s_add_u32 m0, s39, 37888
 v_and_b32 v18, 0xffff0000, v31
 v_add_f32 v46, v46, v43
 v_mfma_f32_16x16x32_bf16 v[92:95], a[100:103], a[92:95], v[92:95]
 buffer_load_dwordx4 v2, s[8:11], s37 offen lds
 v_add_f32 v46, v46, v18
 v_mfma_f32_16x16x32_bf16 v[92:95], a[96:99], a[88:91], v[92:95]
 s_waitcnt lgkmcnt(4)
 v_lshlrev_b32 v43, 16, v32
 v_and_b32 v18, 0xffff0000, v32
 v_mfma_f32_16x16x32_bf16 v[108:111], a[104:107], a[88:91], v[108:111]
 ds_read_b64_tr_b16 a[120:121], v15 offset:8192
 v_add_f32 v46, v46, v43
 v_mfma_f32_16x16x32_bf16 v[108:111], a[108:111], a[92:95], v[108:111]
 ds_read_b64_tr_b16 a[122:123], v15 offset:8448
 v_add_f32 v46, v46, v18
 v_mfma_f32_16x16x32_bf16 v[104:107], a[108:111], a[84:87], v[104:107]
 ds_read_b64_tr_b16 a[124:125], v15 offset:10240
 v_lshlrev_b32 v43, 16, v33
 v_mfma_f32_16x16x32_bf16 v[104:107], a[104:107], a[80:83], v[104:107]
 ds_read_b64_tr_b16 a[126:127], v15 offset:10496
 v_and_b32 v18, 0xffff0000, v33
 v_mfma_f32_16x16x32_bf16 v[100:103], a[104:107], a[72:75], v[100:103]
 v_add_f32 v46, v46, v43
 v_add_f32 v46, v46, v18
 v_mfma_f32_16x16x32_bf16 v[100:103], a[108:111], a[76:79], v[100:103]
 s_add_u32 m0, s46, 86016
 s_waitcnt vmcnt(19)
 v_lshlrev_b32 v43, 16, v34
 v_and_b32 v18, 0xffff0000, v34
 v_mfma_f32_16x16x32_bf16 v[96:99], a[108:111], a[68:71], v[96:99]
 buffer_load_dwordx4 v5, s[12:15], s32 offen lds
 s_add_u32 s37, s31, 98304
 v_mfma_f32_16x16x32_bf16 v[96:99], a[104:107], a[64:67], v[96:99]
 s_waitcnt lgkmcnt(4)
 v_add_f32 v46, v46, v43
 v_add_f32 v46, v46, v18
 v_mfma_f32_16x16x32_bf16 v[112:115], a[64:67], a[112:115], v[112:115]
 ds_read_b64_tr_b16 a[96:97], v16 offset:32768
 v_lshlrev_b32 v43, 16, v35
 v_mfma_f32_16x16x32_bf16 v[112:115], a[68:71], a[116:119], v[112:115]
 ds_read_b64_tr_b16 a[98:99], v16 offset:34560
 v_and_b32 v18, 0xffff0000, v35
 v_mfma_f32_16x16x32_bf16 v[116:119], a[76:79], a[116:119], v[116:119]
 ds_read_b64_tr_b16 a[100:101], v16 offset:39936
 v_add_f32 v46, v46, v43
 v_mfma_f32_16x16x32_bf16 v[116:119], a[72:75], a[112:115], v[116:119]
 ds_read_b64_tr_b16 a[102:103], v16 offset:41728
 s_add_u32 m0, s39, 38912
 v_mfma_f32_16x16x32_bf16 v[120:123], a[80:83], a[112:115], v[120:123]
 buffer_load_dwordx4 v1, s[8:11], s37 offen lds
 v_add_f32 v46, v46, v18
 v_mfma_f32_16x16x32_bf16 v[120:123], a[84:87], a[116:119], v[120:123]
 v_lshlrev_b32 v43, 16, v36
 v_and_b32 v18, 0xffff0000, v36
 v_mfma_f32_16x16x32_bf16 v[124:127], a[92:95], a[116:119], v[124:127]
 v_add_f32 v46, v46, v43
 v_add_f32 v46, v46, v18
 v_mfma_f32_16x16x32_bf16 v[124:127], a[88:91], a[112:115], v[124:127]
 s_waitcnt lgkmcnt(4)
 v_lshlrev_b32 v43, 16, v37
 v_and_b32 v18, 0xffff0000, v37
 v_mfma_f32_16x16x32_bf16 v[140:143], a[88:91], a[120:123], v[140:143]
 ds_read_b64_tr_b16 a[104:105], v16 offset:32800
 v_add_f32 v46, v46, v43
 v_mfma_f32_16x16x32_bf16 v[140:143], a[92:95], a[124:127], v[140:143]
 ds_read_b64_tr_b16 a[106:107], v16 offset:34592
 v_add_f32 v46, v46, v18
 v_mfma_f32_16x16x32_bf16 v[136:139], a[84:87], a[124:127], v[136:139]
 ds_read_b64_tr_b16 a[108:109], v16 offset:39968
 s_waitcnt vmcnt(20)
 v_lshlrev_b32 v43, 16, v38
 v_mfma_f32_16x16x32_bf16 v[136:139], a[80:83], a[120:123], v[136:139]
 ds_read_b64_tr_b16 a[110:111], v16 offset:41760
 s_add_u32 m0, s39, 39936
 v_mfma_f32_16x16x32_bf16 v[132:135], a[72:75], a[120:123], v[132:135]
 buffer_load_dwordx4 v2, s[8:11], s37 offen lds
 s_xor_b32 s38, s34, 4
 v_mfma_f32_16x16x32_bf16 v[132:135], a[76:79], a[124:127], v[132:135]
 s_lshl_b32 s31, s38, 7
 s_mul_i32 s32, s38, 393216
 s_mul_i32 s33, s38, 458752
 s_add_u32 m0, s46, 90112
 v_mfma_f32_16x16x32_bf16 v[128:131], a[68:71], a[124:127], v[128:131]
 buffer_load_dwordx4 v3, s[12:15], s32 offen lds
 v_and_b32 v18, 0xffff0000, v38
 v_mfma_f32_16x16x32_bf16 v[128:131], a[64:67], a[120:123], v[128:131]
 s_waitcnt lgkmcnt(4)
 v_add_f32 v46, v46, v43
 v_add_f32 v46, v46, v18
 v_mfma_f32_16x16x32_bf16 v[144:147], a[96:99], a[64:67], v[144:147]
 ds_read_b64_tr_b16 a[112:113], v16 offset:32832
 v_lshlrev_b32 v43, 16, v39
 v_mfma_f32_16x16x32_bf16 v[144:147], a[100:103], a[68:71], v[144:147]
 ds_read_b64_tr_b16 a[114:115], v16 offset:34624
 v_and_b32 v18, 0xffff0000, v39
 v_mfma_f32_16x16x32_bf16 v[148:151], a[100:103], a[76:79], v[148:151]
 ds_read_b64_tr_b16 a[116:117], v16 offset:40000
 v_add_f32 v46, v46, v43
 v_mfma_f32_16x16x32_bf16 v[148:151], a[96:99], a[72:75], v[148:151]
 ds_read_b64_tr_b16 a[118:119], v16 offset:41792
 v_add_f32 v46, v46, v18
 v_mfma_f32_16x16x32_bf16 v[152:155], a[96:99], a[80:83], v[152:155]
 v_lshlrev_b32 v43, 16, v40
 v_and_b32 v18, 0xffff0000, v40
 v_mfma_f32_16x16x32_bf16 v[152:155], a[100:103], a[84:87], v[152:155]
 s_add_u32 m0, s47, 118784
 v_add_f32 v46, v46, v43
 v_add_f32 v46, v46, v18
 v_mfma_f32_16x16x32_bf16 v[156:159], a[100:103], a[92:95], v[156:159]
 buffer_load_dwordx4 v6, s[16:19], s33 offen lds
 v_lshlrev_b32 v43, 16, v41
 v_mfma_f32_16x16x32_bf16 v[156:159], a[96:99], a[88:91], v[156:159]
 s_waitcnt lgkmcnt(4)
 v_and_b32 v18, 0xffff0000, v41
 v_add_f32 v46, v46, v43
 v_mfma_f32_16x16x32_bf16 v[172:175], a[104:107], a[88:91], v[172:175]
 ds_read_b64_tr_b16 a[120:121], v16 offset:32864
 v_add_f32 v46, v46, v18
 v_mfma_f32_16x16x32_bf16 v[172:175], a[108:111], a[92:95], v[172:175]
 ds_read_b64_tr_b16 a[122:123], v16 offset:34656
 v_add_f32_dpp v46, v46, v46 quad_perm:[1,0,3,2] row_mask:0xf bank_mask:0xf
 v_mfma_f32_16x16x32_bf16 v[168:171], a[108:111], a[84:87], v[168:171]
 ds_read_b64_tr_b16 a[124:125], v16 offset:40032
 v_add_f32_dpp v46, v46, v46 quad_perm:[2,3,0,1] row_mask:0xf bank_mask:0xf
 v_mfma_f32_16x16x32_bf16 v[168:171], a[104:107], a[80:83], v[168:171]
 ds_read_b64_tr_b16 a[126:127], v16 offset:41824
 s_add_u32 m0, s47, 119808
 v_mfma_f32_16x16x32_bf16 v[164:167], a[104:107], a[72:75], v[164:167]
 buffer_load_dwordx4 v7, s[16:19], s33 offen lds
 v_add_f32_dpp v46, v46, v46 row_half_mirror row_mask:0xf bank_mask:0xf
 v_mfma_f32_16x16x32_bf16 v[164:167], a[108:111], a[76:79], v[164:167]
 s_nop 0
 v_add_f32_dpp v46, v46, v46 row_mirror row_mask:0xf bank_mask:0xf
 v_mov_b32 v43, v46
 v_mfma_f32_16x16x32_bf16 v[160:163], a[108:111], a[68:71], v[160:163]
 s_nop 0
 v_permlane16_swap_b32 v46, v43
 v_mfma_f32_16x16x32_bf16 v[160:163], a[104:107], a[64:67], v[160:163]
 s_waitcnt lgkmcnt(4)
 v_add_f32 v46, v46, v43
 v_mul_f32 v46, 0xba800000, v46
 v_mfma_f32_16x16x32_bf16 v[176:179], a[112:115], a[64:67], v[176:179]
 ds_read_b64_tr_b16 a[96:97], v16 offset:32896
 v_lshlrev_b32 v43, 16, v26
 v_mfma_f32_16x16x32_bf16 v[176:179], a[116:119], a[68:71], v[176:179]
 ds_read_b64_tr_b16 a[98:99], v16 offset:34688
 v_and_b32 v18, 0xffff0000, v26
 v_mfma_f32_16x16x32_bf16 v[180:183], a[116:119], a[76:79], v[180:183]
 ds_read_b64_tr_b16 a[100:101], v16 offset:40064
 v_add_f32 v43, v43, v46
 v_mfma_f32_16x16x32_bf16 v[180:183], a[112:115], a[72:75], v[180:183]
 ds_read_b64_tr_b16 a[102:103], v16 offset:41856
 s_add_u32 m0, s46, 94208
 v_mfma_f32_16x16x32_bf16 v[184:187], a[112:115], a[80:83], v[184:187]
 buffer_load_dwordx4 v4, s[12:15], s32 offen lds
 v_add_f32 v18, v18, v46
 v_mfma_f32_16x16x32_bf16 v[184:187], a[116:119], a[84:87], v[184:187]
 s_add_u32 m0, s47, 120832
 v_mul_f32 v42, v43, v43
 v_fmac_f32 v42, v18, v18
 v_mfma_f32_16x16x32_bf16 v[188:191], a[116:119], a[92:95], v[188:191]
 buffer_load_dwordx4 v8, s[24:27], s33 offen lds
 v_lshlrev_b32 v43, 16, v27
 v_mfma_f32_16x16x32_bf16 v[188:191], a[112:115], a[88:91], v[188:191]
 s_waitcnt lgkmcnt(4)
 v_and_b32 v18, 0xffff0000, v27
 v_add_f32 v43, v43, v46
 v_mfma_f32_16x16x32_bf16 v[204:207], a[120:123], a[88:91], v[204:207]
 ds_read_b64_tr_b16 a[104:105], v16 offset:32928
 v_add_f32 v18, v18, v46
 v_mfma_f32_16x16x32_bf16 v[204:207], a[124:127], a[92:95], v[204:207]
 ds_read_b64_tr_b16 a[106:107], v16 offset:34720
 v_fmac_f32 v42, v43, v43
 v_mfma_f32_16x16x32_bf16 v[200:203], a[124:127], a[84:87], v[200:203]
 ds_read_b64_tr_b16 a[108:109], v16 offset:40096
 v_fmac_f32 v42, v18, v18
 v_mfma_f32_16x16x32_bf16 v[200:203], a[120:123], a[80:83], v[200:203]
 ds_read_b64_tr_b16 a[110:111], v16 offset:41888
 v_lshlrev_b32 v43, 16, v28
 v_mfma_f32_16x16x32_bf16 v[196:199], a[120:123], a[72:75], v[196:199]
 v_and_b32 v18, 0xffff0000, v28
 v_add_f32 v43, v43, v46
 v_mfma_f32_16x16x32_bf16 v[196:199], a[124:127], a[76:79], v[196:199]
 s_add_u32 m0, s47, 121856
 v_add_f32 v18, v18, v46
 v_fmac_f32 v42, v43, v43
 v_mfma_f32_16x16x32_bf16 v[192:195], a[124:127], a[68:71], v[192:195]
 buffer_load_dwordx4 v9, s[24:27], s33 offen lds
 v_fmac_f32 v42, v18, v18
 v_mfma_f32_16x16x32_bf16 v[192:195], a[120:123], a[64:67], v[192:195]
 s_waitcnt lgkmcnt(4)
 v_lshlrev_b32 v43, 16, v29
 v_and_b32 v18, 0xffff0000, v29
 v_mfma_f32_16x16x32_bf16 v[208:211], a[96:99], a[64:67], v[208:211]
 ds_read_b64_tr_b16 a[112:113], v16 offset:32960
 v_add_f32 v43, v43, v46
 v_mfma_f32_16x16x32_bf16 v[208:211], a[100:103], a[68:71], v[208:211]
 ds_read_b64_tr_b16 a[114:115], v16 offset:34752
 v_add_f32 v18, v18, v46
 v_mfma_f32_16x16x32_bf16 v[212:215], a[100:103], a[76:79], v[212:215]
 ds_read_b64_tr_b16 a[116:117], v16 offset:40128
 v_fmac_f32 v42, v43, v43
 v_mfma_f32_16x16x32_bf16 v[212:215], a[96:99], a[72:75], v[212:215]
 ds_read_b64_tr_b16 a[118:119], v16 offset:41920
 s_add_u32 m0, s46, 98304
 v_mfma_f32_16x16x32_bf16 v[216:219], a[96:99], a[80:83], v[216:219]
 buffer_load_dwordx4 v5, s[12:15], s32 offen lds
 v_fmac_f32 v42, v18, v18
 v_mfma_f32_16x16x32_bf16 v[216:219], a[100:103], a[84:87], v[216:219]
 v_lshlrev_b32 v43, 16, v30
 v_and_b32 v18, 0xffff0000, v30
 v_mfma_f32_16x16x32_bf16 v[220:223], a[100:103], a[92:95], v[220:223]
 v_add_f32 v43, v43, v46
 v_add_f32 v18, v18, v46
 v_mfma_f32_16x16x32_bf16 v[220:223], a[96:99], a[88:91], v[220:223]
 s_waitcnt vmcnt(7) lgkmcnt(0)
 s_barrier
 v_mfma_f32_16x16x32_bf16 v[236:239], a[104:107], a[88:91], v[236:239]
 ds_read_b64_tr_b16 a[120:121], v14 offset:12288
 v_fmac_f32 v42, v43, v43
 v_mfma_f32_16x16x32_bf16 v[236:239], a[108:111], a[92:95], v[236:239]
 ds_read_b64_tr_b16 a[122:123], v14 offset:12544
 v_fmac_f32 v42, v18, v18
 v_mfma_f32_16x16x32_bf16 v[232:235], a[108:111], a[84:87], v[232:235]
 ds_read_b64_tr_b16 a[124:125], v14 offset:14336
 v_lshlrev_b32 v43, 16, v31
 v_mfma_f32_16x16x32_bf16 v[232:235], a[104:107], a[80:83], v[232:235]
 ds_read_b64_tr_b16 a[126:127], v14 offset:14592
 v_and_b32 v18, 0xffff0000, v31
 v_mfma_f32_16x16x32_bf16 v[228:231], a[104:107], a[72:75], v[228:231]
 ds_read_b128 a[0:3], v10 offset:32768
 v_add_f32 v43, v43, v46
 v_mfma_f32_16x16x32_bf16 v[228:231], a[108:111], a[76:79], v[228:231]
 ds_read_b128 a[4:7], v11 offset:32768
 v_add_f32 v18, v18, v46
 v_mfma_f32_16x16x32_bf16 v[224:227], a[108:111], a[68:71], v[224:227]
 ds_read_b128 a[12:15], v11 offset:34816
 v_fmac_f32 v42, v43, v43
 v_mfma_f32_16x16x32_bf16 v[224:227], a[104:107], a[64:67], v[224:227]
 ds_read_b128 a[8:11], v10 offset:34816
 v_mfma_f32_16x16x32_bf16 v[240:243], a[112:115], a[64:67], v[240:243]
 ds_read_b64_tr_b16 a[96:97], v15 offset:12288
 v_fmac_f32 v42, v18, v18
 v_mfma_f32_16x16x32_bf16 v[240:243], a[116:119], a[68:71], v[240:243]
 ds_read_b64_tr_b16 a[98:99], v15 offset:12544
 v_lshlrev_b32 v43, 16, v32
 v_mfma_f32_16x16x32_bf16 v[244:247], a[116:119], a[76:79], v[244:247]
 ds_read_b64_tr_b16 a[100:101], v15 offset:14336
 v_and_b32 v18, 0xffff0000, v32
 v_mfma_f32_16x16x32_bf16 v[244:247], a[112:115], a[72:75], v[244:247]
 ds_read_b64_tr_b16 a[102:103], v15 offset:14592
 v_add_f32 v43, v43, v46
 v_mfma_f32_16x16x32_bf16 v[248:251], a[112:115], a[80:83], v[248:251]
 ds_read_b128 a[16:19], v10 offset:36864
 v_add_f32 v18, v18, v46
 v_mfma_f32_16x16x32_bf16 v[248:251], a[116:119], a[84:87], v[248:251]
 ds_read_b128 a[20:23], v11 offset:36864
 v_fmac_f32 v42, v43, v43
 v_mfma_f32_16x16x32_bf16 v[252:255], a[116:119], a[92:95], v[252:255]
 ds_read_b128 a[28:31], v11 offset:38912
 v_fmac_f32 v42, v18, v18
 v_mfma_f32_16x16x32_bf16 v[252:255], a[112:115], a[88:91], v[252:255]
 ds_read_b128 a[24:27], v10 offset:38912
 s_waitcnt lgkmcnt(8)
 v_mfma_f32_16x16x32_bf16 v[48:51], a[120:123], a[0:3], v[48:51]
 ds_read_b64_tr_b16 a[104:105], v14 offset:16384
 v_lshlrev_b32 v43, 16, v33
 v_mfma_f32_16x16x32_bf16 v[48:51], a[124:127], a[4:7], v[48:51]
 ds_read_b64_tr_b16 a[106:107], v14 offset:16640
 v_and_b32 v18, 0xffff0000, v33
 v_mfma_f32_16x16x32_bf16 v[52:55], a[124:127], a[12:15], v[52:55]
 ds_read_b64_tr_b16 a[108:109], v14 offset:18432
 v_add_f32 v43, v43, v46
 s_cmp_eq_u32 s70, 3
 s_cbranch_scc1 L_cap3
L_capb3:
 v_mfma_f32_16x16x32_bf16 v[52:55], a[120:123], a[8:11], v[52:55]
 ds_read_b64_tr_b16 a[110:111], v14 offset:18688
 s_add_u32 m0, s39, 0
 s_waitcnt lgkmcnt(4)
 v_mfma_f32_16x16x32_bf16 v[56:59], a[120:123], a[16:19], v[56:59]
 buffer_load_dwordx4 v1, s[8:11], s31 offen lds
 v_add_f32 v18, v18, v46
 v_mfma_f32_16x16x32_bf16 v[56:59], a[124:127], a[20:23], v[56:59]
 s_add_u32 m0, s39, 1024
 v_fmac_f32 v42, v43, v43
 v_fmac_f32 v42, v18, v18
 v_mfma_f32_16x16x32_bf16 v[60:63], a[124:127], a[28:31], v[60:63]
 buffer_load_dwordx4 v2, s[8:11], s31 offen lds
 s_add_u32 s37, s31, 32768
 v_mfma_f32_16x16x32_bf16 v[60:63], a[120:123], a[24:27], v[60:63]
 v_lshlrev_b32 v43, 16, v34
 v_and_b32 v18, 0xffff0000, v34
 v_mfma_f32_16x16x32_bf16 v[76:79], a[96:99], a[24:27], v[76:79]
 ds_read_b64_tr_b16 a[112:113], v15 offset:16384
 v_add_f32 v43, v43, v46
 v_mfma_f32_16x16x32_bf16 v[76:79], a[100:103], a[28:31], v[76:79]
 ds_read_b64_tr_b16 a[114:115], v15 offset:16640
 v_add_f32 v18, v18, v46
 v_mfma_f32_16x16x32_bf16 v[72:75], a[100:103], a[20:23], v[72:75]
 ds_read_b64_tr_b16 a[116:117], v15 offset:18432
 v_fmac_f32 v42, v43, v43
 v_mfma_f32_16x16x32_bf16 v[72:75], a[96:99], a[16:19], v[72:75]
 ds_read_b64_tr_b16 a[118:119], v15 offset:18688
 s_add_u32 m0, s39, 2048
 v_mfma_f32_16x16x32_bf16 v[68:71], a[96:99], a[8:11], v[68:71]
 buffer_load_dwordx4 v1, s[8:11], s37 offen lds
 v_fmac_f32 v42, v18, v18
 v_mfma_f32_16x16x32_bf16 v[68:71], a[100:103], a[12:15], v[68:71]
 s_add_u32 m0, s39, 3072
 v_lshlrev_b32 v43, 16, v35
 v_and_b32 v18, 0xffff0000, v35
 v_mfma_f32_16x16x32_bf16 v[64:67], a[100:103], a[4:7], v[64:67]
 buffer_load_dwordx4 v2, s[8:11], s37 offen lds
 s_add_u32 s37, s31, 65536
 v_mfma_f32_16x16x32_bf16 v[64:67], a[96:99], a[0:3], v[64:67]
 s_waitcnt lgkmcnt(4)
 v_add_f32 v43, v43, v46
 v_add_f32 v18, v18, v46
 v_mfma_f32_16x16x32_bf16 v[80:83], a[104:107], a[0:3], v[80:83]
 ds_read_b64_tr_b16 a[120:121], v14 offset:20480
 v_fmac_f32 v42, v43, v43
 v_mfma_f32_16x16x32_bf16 v[80:83], a[108:111], a[4:7], v[80:83]
 ds_read_b64_tr_b16 a[122:123], v14 offset:20736
 v_fmac_f32 v42, v18, v18
 v_mfma_f32_16x16x32_bf16 v[84:87], a[108:111], a[12:15], v[84:87]
 ds_read_b64_tr_b16 a[124:125], v14 offset:22528
 v_lshlrev_b32 v43, 16, v36
 v_mfma_f32_16x16x32_bf16 v[84:87], a[104:107], a[8:11], v[84:87]
 ds_read_b64_tr_b16 a[126:127], v14 offset:22784
 v_and_b32 v18, 0xffff0000, v36
 v_mfma_f32_16x16x32_bf16 v[88:91], a[104:107], a[16:19], v[88:91]
 v_add_f32 v43, v43, v46
 v_add_f32 v18, v18, v46
 v_mfma_f32_16x16x32_bf16 v[88:91], a[108:111], a[20:23], v[88:91]
 s_add_u32 m0, s39, 4096
 v_fmac_f32 v42, v43, v43
 v_fmac_f32 v42, v18, v18
 v_mfma_f32_16x16x32_bf16 v[92:95], a[108:111], a[28:31], v[92:95]
 buffer_load_dwordx4 v1, s[8:11], s37 offen lds
 v_lshlrev_b32 v43, 16, v37
 v_mfma_f32_16x16x32_bf16 v[92:95], a[104:107], a[24:27], v[92:95]
 s_waitcnt lgkmcnt(4)
 v_and_b32 v18, 0xffff0000, v37
 v_add_f32 v43, v43, v46
 v_mfma_f32_16x16x32_bf16 v[108:111], a[112:115], a[24:27], v[108:111]
 ds_read_b64_tr_b16 a[96:97], v15 offset:20480
 v_add_f32 v18, v18, v46
 v_mfma_f32_16x16x32_bf16 v[108:111], a[116:119], a[28:31], v[108:111]
 ds_read_b64_tr_b16 a[98:99], v15 offset:20736
 v_fmac_f32 v42, v43, v43
 v_mfma_f32_16x16x32_bf16 v[104:107], a[116:119], a[20:23], v[104:107]
 ds_read_b64_tr_b16 a[100:101], v15 offset:22528
 v_fmac_f32 v42, v18, v18
 v_mfma_f32_16x16x32_bf16 v[104:107], a[112:115], a[16:19], v[104:107]
 ds_read_b64_tr_b16 a[102:103], v15 offset:22784
 s_add_u32 m0, s39, 5120
 v_mfma_f32_16x16x32_bf16 v[100:103], a[112:115], a[8:11], v[100:103]
 buffer_load_dwordx4 v2, s[8:11], s37 offen lds
 s_add_u32 s37, s31, 98304
 v_mfma_f32_16x16x32_bf16 v[100:103], a[116:119], a[12:15], v[100:103]
 s_add_u32 m0, s39, 6144
 v_lshlrev_b32 v43, 16, v38
 v_and_b32 v18, 0xffff0000, v38
 v_mfma_f32_16x16x32_bf16 v[96:99], a[116:119], a[4:7], v[96:99]
 buffer_load_dwordx4 v1, s[8:11], s37 offen lds
 v_add_f32 v43, v43, v46
 v_mfma_f32_16x16x32_bf16 v[96:99], a[112:115], a[0:3], v[96:99]
 s_waitcnt lgkmcnt(4)
 v_add_f32 v18, v18, v46
 v_fmac_f32 v42, v43, v43
 v_mfma_f32_16x16x32_bf16 v[112:115], a[0:3], a[120:123], v[112:115]
 ds_read_b64_tr_b16 a[104:105], v16 offset:0
 v_fmac_f32 v42, v18, v18
 v_mfma_f32_16x16x32_bf16 v[112:115], a[4:7], a[124:127], v[112:115]
 ds_read_b64_tr_b16 a[106:107], v16 offset:1792
 v_lshlrev_b32 v43, 16, v39
 v_mfma_f32_16x16x32_bf16 v[116:119], a[12:15], a[124:127], v[116:119]
 ds_read_b64_tr_b16 a[108:109], v16 offset:7168
 v_and_b32 v18, 0xffff0000, v39
 v_mfma_f32_16x16x32_bf16 v[116:119], a[8:11], a[120:123], v[116:119]
 ds_read_b64_tr_b16 a[110:111], v16 offset:8960
 v_add_f32 v43, v43, v46
 v_mfma_f32_16x16x32_bf16 v[120:123], a[16:19], a[120:123], v[120:123]
 v_add_f32 v18, v18, v46
 v_fmac_f32 v42, v43, v43
 v_mfma_f32_16x16x32_bf16 v[120:123], a[20:23], a[124:127], v[120:123]
 s_add_u32 m0, s39, 7168
 v_fmac_f32 v42, v18, v18
 v_lshlrev_b32 v43, 16, v40
 v_mfma_f32_16x16x32_bf16 v[124:127], a[28:31], a[124:127], v[124:127]
 buffer_load_dwordx4 v2, s[8:11], s37 offen lds
 s_xor_b32 s38, s35, 4
 v_mfma_f32_16x16x32_bf16 v[124:127], a[24:27], a[120:123], v[124:127]
 s_lshl_b32 s31, s38, 7
 s_mul_i32 s32, s38, 393216
 s_waitcnt lgkmcnt(4)
 v_mfma_f32_16x16x32_bf16 v[140:143], a[24:27], a[96:99], v[140:143]
 ds_read_b64_tr_b16 a[112:113], v16 offset:32
 s_mul_i32 s33, s38, 458752
 v_mfma_f32_16x16x32_bf16 v[140:143], a[28:31], a[100:103], v[140:143]
 ds_read_b64_tr_b16 a[114:115], v16 offset:1824
 v_and_b32 v18, 0xffff0000, v40
 v_mfma_f32_16x16x32_bf16 v[136:139], a[20:23], a[100:103], v[136:139]
 ds_read_b64_tr_b16 a[116:117], v16 offset:7200
 v_add_f32 v43, v43, v46
 v_mfma_f32_16x16x32_bf16 v[136:139], a[16:19], a[96:99], v[136:139]
 ds_read_b64_tr_b16 a[118:119], v16 offset:8992
 s_add_u32 m0, s46, 65536
 v_mfma_f32_16x16x32_bf16 v[132:135], a[8:11], a[96:99], v[132:135]
 buffer_load_dwordx4 v3, s[12:15], s32 offen lds
 v_add_f32 v18, v18, v46
 v_mfma_f32_16x16x32_bf16 v[132:135], a[12:15], a[100:103], v[132:135]
 s_add_u32 m0, s39, 32768
 v_fmac_f32 v42, v43, v43
 v_fmac_f32 v42, v18, v18
 v_mfma_f32_16x16x32_bf16 v[128:131], a[4:7], a[100:103], v[128:131]
 buffer_load_dwordx4 v1, s[8:11], s31 offen lds
 v_lshlrev_b32 v43, 16, v41
 v_mfma_f32_16x16x32_bf16 v[128:131], a[0:3], a[96:99], v[128:131]
 s_waitcnt lgkmcnt(4)
 v_and_b32 v18, 0xffff0000, v41
 v_add_f32 v43, v43, v46
 v_mfma_f32_16x16x32_bf16 v[144:147], a[104:107], a[0:3], v[144:147]
 ds_read_b64_tr_b16 a[120:121], v16 offset:64
 v_add_f32 v18, v18, v46
 v_mfma_f32_16x16x32_bf16 v[144:147], a[108:111], a[4:7], v[144:147]
 ds_read_b64_tr_b16 a[122:123], v16 offset:1856
 v_fmac_f32 v42, v43, v43
 v_mfma_f32_16x16x32_bf16 v[148:151], a[108:111], a[12:15], v[148:151]
 ds_read_b64_tr_b16 a[124:125], v16 offset:7232
 v_fmac_f32 v42, v18, v18
 v_mfma_f32_16x16x32_bf16 v[148:151], a[104:107], a[8:11], v[148:151]
 ds_read_b64_tr_b16 a[126:127], v16 offset:9024
 s_add_u32 m0, s47, 135168
 v_mfma_f32_16x16x32_bf16 v[152:155], a[104:107], a[16:19], v[152:155]
 buffer_load_dwordx4 v6, s[16:19], s33 offen lds
 v_add_f32_dpp v42, v42, v42 quad_perm:[1,0,3,2] row_mask:0xf bank_mask:0xf
 v_mfma_f32_16x16x32_bf16 v[152:155], a[108:111], a[20:23], v[152:155]
L_pg2:
 s_cbranch_execz L_pg6
 s_nop 0
 v_add_f32_dpp v42, v42, v42 quad_perm:[2,3,0,1] row_mask:0xf bank_mask:0xf
 v_mfma_f32_16x16x32_bf16 v[156:159], a[108:111], a[28:31], v[156:159]
 s_nop 0
 v_add_f32_dpp v42, v42, v42 row_half_mirror row_mask:0xf bank_mask:0xf
 v_mfma_f32_16x16x32_bf16 v[156:159], a[104:107], a[24:27], v[156:159]
 s_waitcnt lgkmcnt(4)
 v_add_f32_dpp v42, v42, v42 row_mirror row_mask:0xf bank_mask:0xf
 v_mov_b32 v43, v42
 v_mfma_f32_16x16x32_bf16 v[172:175], a[112:115], a[24:27], v[172:175]
 ds_read_b64_tr_b16 a[96:97], v16 offset:96
 v_mfma_f32_16x16x32_bf16 v[172:175], a[116:119], a[28:31], v[172:175]
 ds_read_b64_tr_b16 a[98:99], v16 offset:1888
 v_mfma_f32_16x16x32_bf16 v[168:171], a[116:119], a[20:23], v[168:171]
 ds_read_b64_tr_b16 a[100:101], v16 offset:7264
 v_mfma_f32_16x16x32_bf16 v[168:171], a[112:115], a[16:19], v[168:171]
 ds_read_b64_tr_b16 a[102:103], v16 offset:9056
 s_add_u32 m0, s39, 33792
 v_mfma_f32_16x16x32_bf16 v[164:167], a[112:115], a[8:11], v[164:167]
 buffer_load_dwordx4 v2, s[8:11], s31 offen lds
 v_mfma_f32_16x16x32_bf16 v[164:167], a[116:119], a[12:15], v[164:167]
 s_add_u32 m0, s47, 136192
 v_permlane16_swap_b32 v42, v43
 v_mfma_f32_16x16x32_bf16 v[160:163], a[116:119], a[4:7], v[160:163]
 buffer_load_dwordx4 v7, s[16:19], s33 offen lds
 s_add_u32 s37, s31, 32768
 v_mfma_f32_16x16x32_bf16 v[160:163], a[112:115], a[0:3], v[160:163]
 s_waitcnt lgkmcnt(4)
 v_add_f32 v42, v42, v43
 v_mul_f32 v42, 0x3a800000, v42
 v_mfma_f32_16x16x32_bf16 v[176:179], a[120:123], a[0:3], v[176:179]
 ds_read_b64_tr_b16 a[104:105], v16 offset:128
 v_cvt_pk_bf16_f32 v43, v46, v42
 v_mfma_f32_16x16x32_bf16 v[176:179], a[124:127], a[4:7], v[176:179]
 ds_read_b64_tr_b16 a[106:107], v16 offset:1920
 v_lshlrev_b32 v46, 16, v43
 v_mfma_f32_16x16x32_bf16 v[180:183], a[124:127], a[12:15], v[180:183]
 ds_read_b64_tr_b16 a[108:109], v16 offset:7296
 v_and_b32 v42, 0xffff0000, v43
 v_mfma_f32_16x16x32_bf16 v[180:183], a[120:123], a[8:11], v[180:183]
 ds_read_b64_tr_b16 a[110:111], v16 offset:9088
 s_add_u32 m0, s39, 34816
 v_mfma_f32_16x16x32_bf16 v[184:187], a[120:123], a[16:19], v[184:187]
 buffer_load_dwordx4 v1, s[8:11], s37 offen lds
 v_add_f32 v42, 0x3727c5ac, v42
 v_mfma_f32_16x16x32_bf16 v[184:187], a[124:127], a[20:23], v[184:187]
 buffer_store_dword v46, v24, s[20:23], s96 offen sc1
 v_cvt_pk_bf16_f32 v43, v42, v42
 v_mfma_f32_16x16x32_bf16 v[188:191], a[124:127], a[28:31], v[188:191]
 v_lshlrev_b32 v43, 16, v43
 v_mov_b32 v26, 0
 v_mfma_f32_16x16x32_bf16 v[188:191], a[120:123], a[24:27], v[188:191]
 s_waitcnt lgkmcnt(4)
 v_sqrt_f32 v43, v43
 v_mfma_f32_16x16x32_bf16 v[204:207], a[96:99], a[24:27], v[204:207]
 ds_read_b64_tr_b16 a[112:113], v16 offset:160
 v_cvt_pk_bf16_f32 v43, v43, v43
 v_mfma_f32_16x16x32_bf16 v[204:207], a[100:103], a[28:31], v[204:207]
 ds_read_b64_tr_b16 a[114:115], v16 offset:1952
 v_lshlrev_b32 v43, 16, v43
 v_mfma_f32_16x16x32_bf16 v[200:203], a[100:103], a[20:23], v[200:203]
 ds_read_b64_tr_b16 a[116:117], v16 offset:7328
 v_accvgpr_read_b32 v30, a254
 v_mfma_f32_16x16x32_bf16 v[200:203], a[96:99], a[16:19], v[200:203]
 ds_read_b64_tr_b16 a[118:119], v16 offset:9120
 s_add_u32 m0, s46, 69632
 v_mfma_f32_16x16x32_bf16 v[196:199], a[96:99], a[8:11], v[196:199]
 buffer_load_dwordx4 v4, s[12:15], s32 offen lds
 v_lshlrev_b32 v28, 16, v30
 v_mfma_f32_16x16x32_bf16 v[196:199], a[100:103], a[12:15], v[196:199]
 s_add_u32 m0, s39, 35840
 v_rcp_f32 v42, v43
 v_mfma_f32_16x16x32_bf16 v[192:195], a[100:103], a[4:7], v[192:195]
 buffer_load_dwordx4 v2, s[8:11], s37 offen lds
 v_and_b32 v29, 0xffff0000, v30
 v_mfma_f32_16x16x32_bf16 v[192:195], a[96:99], a[0:3], v[192:195]
 buffer_store_dword v42, v24, s[20:23], 0 offen sc1
 s_waitcnt lgkmcnt(4)
 v_mfma_f32_16x16x32_bf16 v[208:211], a[104:107], a[0:3], v[208:211]
 ds_read_b64_tr_b16 a[120:121], v16 offset:192
 v_lshlrev_b32 v27, 3, v0
 v_mfma_f32_16x16x32_bf16 v[208:211], a[108:111], a[4:7], v[208:211]
 ds_read_b64_tr_b16 a[122:123], v16 offset:1984
 v_add_u32 v27, 152448, v27
 v_mfma_f32_16x16x32_bf16 v[212:215], a[108:111], a[12:15], v[212:215]
 ds_read_b64_tr_b16 a[124:125], v16 offset:7360
 v_and_b32 v36, 15, v0
 v_mfma_f32_16x16x32_bf16 v[212:215], a[104:107], a[8:11], v[212:215]
 ds_read_b64_tr_b16 a[126:127], v16 offset:9152
 s_add_u32 m0, s47, 137216
 v_mfma_f32_16x16x32_bf16 v[216:219], a[104:107], a[16:19], v[216:219]
 buffer_load_dwordx4 v8, s[24:27], s33 offen lds
 s_add_u32 s37, s31, 65536
 v_mfma_f32_16x16x32_bf16 v[216:219], a[108:111], a[20:23], v[216:219]
 buffer_store_dword v26, v25, s[20:23], 0 offen sc1
 s_lshl_b32 s57, s30, 14
 v_mfma_f32_16x16x32_bf16 v[220:223], a[108:111], a[28:31], v[220:223]
 s_bfm_b64 exec, 56, 0
 ds_write_b64 v27, v[28:29]
 s_mov_b64 exec, -1
 v_mfma_f32_16x16x32_bf16 v[220:223], a[104:107], a[24:27], v[220:223]
 s_waitcnt vmcnt(12) lgkmcnt(0)
 s_barrier
 v_mfma_f32_16x16x32_bf16 v[236:239], a[112:115], a[24:27], v[236:239]
 ds_read_b64_tr_b16 a[96:97], v14 offset:24576
 s_add_u32 s57, s57, s47
 v_mfma_f32_16x16x32_bf16 v[236:239], a[116:119], a[28:31], v[236:239]
 ds_read_b64_tr_b16 a[98:99], v14 offset:24832
 s_add_u32 s57, s57, 25165824
 v_mfma_f32_16x16x32_bf16 v[232:235], a[116:119], a[20:23], v[232:235]
 ds_read_b64_tr_b16 a[100:101], v14 offset:26624
 s_lshl_b32 s52, s29, 7
 v_mfma_f32_16x16x32_bf16 v[232:235], a[112:115], a[16:19], v[232:235]
 ds_read_b64_tr_b16 a[102:103], v14 offset:26880
 s_add_u32 s52, s52, s57
 v_mfma_f32_16x16x32_bf16 v[228:231], a[112:115], a[8:11], v[228:231]
 ds_read_b128 a[32:35], v10 offset:0
 v_lshlrev_b32 v37, 4, v19
 v_mfma_f32_16x16x32_bf16 v[228:231], a[116:119], a[12:15], v[228:231]
 ds_read_b128 a[36:39], v11 offset:0
 v_cmp_gt_u32 vcc, 2, v36
 v_mfma_f32_16x16x32_bf16 v[224:227], a[116:119], a[4:7], v[224:227]
 ds_read_b128 a[44:47], v11 offset:2048
 v_lshl_add_u32 v34, v36, 6, v37
 v_mfma_f32_16x16x32_bf16 v[224:227], a[112:115], a[0:3], v[224:227]
 ds_read_b128 a[40:43], v10 offset:2048
 v_mfma_f32_16x16x32_bf16 v[240:243], a[120:123], a[0:3], v[240:243]
 ds_read_b64_tr_b16 a[104:105], v15 offset:24576
 v_bfrev_b32 v38, 1
 v_mfma_f32_16x16x32_bf16 v[240:243], a[124:127], a[4:7], v[240:243]
 ds_read_b64_tr_b16 a[106:107], v15 offset:24832
 v_cndmask_b32 v34, v38, v34, vcc
 v_mfma_f32_16x16x32_bf16 v[244:247], a[124:127], a[12:15], v[244:247]
 ds_read_b64_tr_b16 a[108:109], v15 offset:26624
 v_mfma_f32_16x16x32_bf16 v[244:247], a[120:123], a[8:11], v[244:247]
 ds_read_b64_tr_b16 a[110:111], v15 offset:26880
 v_mfma_f32_16x16x32_bf16 v[248:251], a[120:123], a[16:19], v[248:251]
 ds_read_b128 a[48:51], v10 offset:4096
 v_mfma_f32_16x16x32_bf16 v[248:251], a[124:127], a[20:23], v[248:251]
 ds_read_b128 a[52:55], v11 offset:4096
 v_mfma_f32_16x16x32_bf16 v[252:255], a[124:127], a[28:31], v[252:255]
 ds_read_b128 a[60:63], v11 offset:6144
 v_mfma_f32_16x16x32_bf16 v[252:255], a[120:123], a[24:27], v[252:255]
 ds_read_b128 a[56:59], v10 offset:6144
 s_waitcnt lgkmcnt(8)
 v_mfma_f32_16x16x32_bf16 v[48:51], a[96:99], a[32:35], v[48:51]
 ds_read_b64_tr_b16 a[112:113], v14 offset:28672
 v_mfma_f32_16x16x32_bf16 v[48:51], a[100:103], a[36:39], v[48:51]
 ds_read_b64_tr_b16 a[114:115], v14 offset:28928
 v_mfma_f32_16x16x32_bf16 v[52:55], a[100:103], a[44:47], v[52:55]
 ds_read_b64_tr_b16 a[116:117], v14 offset:30720
 s_cmp_eq_u32 s70, 4
 s_cbranch_scc1 L_cap4
L_capb4:
 v_mfma_f32_16x16x32_bf16 v[52:55], a[96:99], a[40:43], v[52:55]
 ds_read_b64_tr_b16 a[118:119], v14 offset:30976
 s_add_u32 m0, s39, 36864
 s_waitcnt lgkmcnt(4)
 v_mfma_f32_16x16x32_bf16 v[56:59], a[96:99], a[48:51], v[56:59]
 buffer_load_dwordx4 v1, s[8:11], s37 offen lds
 v_mfma_f32_16x16x32_bf16 v[56:59], a[100:103], a[52:55], v[56:59]
 ds_read_b64_tr_b16 a[136:137], v17 offset:24576
 s_add_u32 m0, s47, 138240
 v_mfma_f32_16x16x32_bf16 v[60:63], a[100:103], a[60:63], v[60:63]
 buffer_load_dwordx4 v9, s[24:27], s33 offen lds
 v_mfma_f32_16x16x32_bf16 v[60:63], a[96:99], a[56:59], v[60:63]
 ds_read_b64_tr_b16 a[138:139], v17 offset:24832
 v_mfma_f32_16x16x32_bf16 v[76:79], a[104:107], a[56:59], v[76:79]
 ds_read_b64_tr_b16 a[120:121], v15 offset:28672
 v_mfma_f32_16x16x32_bf16 v[76:79], a[108:111], a[60:63], v[76:79]
 ds_read_b64_tr_b16 a[122:123], v15 offset:28928
 v_mfma_f32_16x16x32_bf16 v[72:75], a[108:111], a[52:55], v[72:75]
 ds_read_b64_tr_b16 a[124:125], v15 offset:30720
 v_mfma_f32_16x16x32_bf16 v[72:75], a[104:107], a[48:51], v[72:75]
 ds_read_b64_tr_b16 a[126:127], v15 offset:30976
 s_add_u32 m0, s39, 37888
 v_mfma_f32_16x16x32_bf16 v[68:71], a[104:107], a[40:43], v[68:71]
 buffer_load_dwordx4 v2, s[8:11], s37 offen lds
 v_mfma_f32_16x16x32_bf16 v[68:71], a[108:111], a[44:47], v[68:71]
 ds_read_b64_tr_b16 a[140:141], v17 offset:26624
 s_add_u32 m0, s46, 73728
 v_mfma_f32_16x16x32_bf16 v[64:67], a[108:111], a[36:39], v[64:67]
 buffer_load_dwordx4 v5, s[12:15], s32 offen lds
 s_add_u32 s37, s31, 98304
 v_mfma_f32_16x16x32_bf16 v[64:67], a[104:107], a[32:35], v[64:67]
 ds_read_b64_tr_b16 a[142:143], v17 offset:26880
 s_waitcnt lgkmcnt(8)
 v_mfma_f32_16x16x32_bf16 v[80:83], a[112:115], a[32:35], v[80:83]
 ds_read_b64_tr_b16 a[96:97], v14 offset:32768
 v_mfma_f32_16x16x32_bf16 v[80:83], a[116:119], a[36:39], v[80:83]
 ds_read_b64_tr_b16 a[98:99], v14 offset:33024
 v_mfma_f32_16x16x32_bf16 v[84:87], a[116:119], a[44:47], v[84:87]
 ds_read_b64_tr_b16 a[100:101], v14 offset:34816
 v_mfma_f32_16x16x32_bf16 v[84:87], a[112:115], a[40:43], v[84:87]
 ds_read_b64_tr_b16 a[102:103], v14 offset:35072
 v_mfma_f32_16x16x32_bf16 v[88:91], a[112:115], a[48:51], v[88:91]
 v_mfma_f32_16x16x32_bf16 v[88:91], a[116:119], a[52:55], v[88:91]
 s_add_u32 m0, s39, 38912
 v_mfma_f32_16x16x32_bf16 v[92:95], a[116:119], a[60:63], v[92:95]
 buffer_load_dwordx4 v1, s[8:11], s37 offen lds
 v_mfma_f32_16x16x32_bf16 v[92:95], a[112:115], a[56:59], v[92:95]
 s_waitcnt lgkmcnt(6)
 v_mfma_f32_16x16x32_bf16 v[108:111], a[120:123], a[56:59], v[108:111]
 ds_read_b64_tr_b16 a[104:105], v15 offset:32768
 v_mfma_f32_16x16x32_bf16 v[108:111], a[124:127], a[60:63], v[108:111]
 ds_read_b64_tr_b16 a[106:107], v15 offset:33024
 v_mfma_f32_16x16x32_bf16 v[104:107], a[124:127], a[52:55], v[104:107]
 ds_read_b64_tr_b16 a[108:109], v15 offset:34816
 v_mfma_f32_16x16x32_bf16 v[104:107], a[120:123], a[48:51], v[104:107]
 ds_read_b64_tr_b16 a[110:111], v15 offset:35072
 s_add_u32 m0, s39, 39936
 v_mfma_f32_16x16x32_bf16 v[100:103], a[120:123], a[40:43], v[100:103]
 buffer_load_dwordx4 v2, s[8:11], s37 offen lds
 s_xor_b32 s38, s36, 4
 s_lshl_b32 s31, s38, 7
 v_mfma_f32_16x16x32_bf16 v[100:103], a[124:127], a[44:47], v[100:103]
 ds_read_b64_tr_b16 a[144:145], v22 offset:24576
 s_mul_i32 s32, s38, 393216
 s_mul_i32 s33, s38, 458752
 s_add_u32 m0, s46, 77824
 v_mfma_f32_16x16x32_bf16 v[96:99], a[124:127], a[36:39], v[96:99]
 buffer_load_dwordx4 v3, s[12:15], s32 offen lds
 v_mfma_f32_16x16x32_bf16 v[96:99], a[120:123], a[32:35], v[96:99]
 ds_read_b64_tr_b16 a[146:147], v22 offset:24832
 s_waitcnt lgkmcnt(6)
 v_mfma_f32_16x16x32_bf16 v[112:115], a[32:35], a[96:99], v[112:115]
 ds_read_b64_tr_b16 a[112:113], v16 offset:16384
 v_mfma_f32_16x16x32_bf16 v[112:115], a[36:39], a[100:103], v[112:115]
 ds_read_b64_tr_b16 a[114:115], v16 offset:18176
 v_mfma_f32_16x16x32_bf16 v[116:119], a[44:47], a[100:103], v[116:119]
 ds_read_b64_tr_b16 a[116:117], v16 offset:23552
 v_mfma_f32_16x16x32_bf16 v[116:119], a[40:43], a[96:99], v[116:119]
 ds_read_b64_tr_b16 a[118:119], v16 offset:25344
 v_mfma_f32_16x16x32_bf16 v[120:123], a[48:51], a[96:99], v[120:123]
 v_mfma_f32_16x16x32_bf16 v[120:123], a[52:55], a[100:103], v[120:123]
 ds_read_b64_tr_b16 a[148:149], v22 offset:26624
 s_add_u32 m0, s39, 0
 v_mfma_f32_16x16x32_bf16 v[124:127], a[60:63], a[100:103], v[124:127]
 buffer_load_dwordx4 v1, s[8:11], s31 offen lds
 v_mfma_f32_16x16x32_bf16 v[124:127], a[56:59], a[96:99], v[124:127]
 ds_read_b64_tr_b16 a[150:151], v22 offset:26880
 s_waitcnt lgkmcnt(8)
 v_mfma_f32_16x16x32_bf16 v[140:143], a[56:59], a[104:107], v[140:143]
 ds_read_b64_tr_b16 a[120:121], v16 offset:16416
 v_mfma_f32_16x16x32_bf16 v[140:143], a[60:63], a[108:111], v[140:143]
 ds_read_b64_tr_b16 a[122:123], v16 offset:18208
 v_mfma_f32_16x16x32_bf16 v[136:139], a[52:55], a[108:111], v[136:139]
 ds_read_b64_tr_b16 a[124:125], v16 offset:23584
 v_mfma_f32_16x16x32_bf16 v[136:139], a[48:51], a[104:107], v[136:139]
 ds_read_b64_tr_b16 a[126:127], v16 offset:25376
 s_add_u32 m0, s47, 102400
 v_mfma_f32_16x16x32_bf16 v[132:135], a[40:43], a[104:107], v[132:135]
 buffer_load_dwordx4 v6, s[16:19], s33 offen lds
 v_mfma_f32_16x16x32_bf16 v[132:135], a[44:47], a[108:111], v[132:135]
 ds_read_b64_tr_b16 a[152:153], v23 offset:16384
 s_add_u32 m0, s39, 1024
 v_mfma_f32_16x16x32_bf16 v[128:131], a[36:39], a[108:111], v[128:131]
 buffer_load_dwordx4 v2, s[8:11], s31 offen lds
 v_mfma_f32_16x16x32_bf16 v[128:131], a[32:35], a[104:107], v[128:131]
 ds_read_b64_tr_b16 a[154:155], v23 offset:18176
 s_waitcnt lgkmcnt(8)
 v_mfma_f32_16x16x32_bf16 v[144:147], a[112:115], a[32:35], v[144:147]
 ds_read_b64_tr_b16 a[96:97], v16 offset:16448
 v_mfma_f32_16x16x32_bf16 v[144:147], a[116:119], a[36:39], v[144:147]
 ds_read_b64_tr_b16 a[98:99], v16 offset:18240
 v_mfma_f32_16x16x32_bf16 v[148:151], a[116:119], a[44:47], v[148:151]
 ds_read_b64_tr_b16 a[100:101], v16 offset:23616
 v_mfma_f32_16x16x32_bf16 v[148:151], a[112:115], a[40:43], v[148:151]
 ds_read_b64_tr_b16 a[102:103], v16 offset:25408
 s_add_u32 m0, s47, 103424
 v_mfma_f32_16x16x32_bf16 v[152:155], a[112:115], a[48:51], v[152:155]
 buffer_load_dwordx4 v7, s[16:19], s33 offen lds
 s_add_u32 s37, s31, 32768
 v_mfma_f32_16x16x32_bf16 v[152:155], a[116:119], a[52:55], v[152:155]
 ds_read_b64_tr_b16 a[156:157], v23 offset:23552
 v_mfma_f32_16x16x32_bf16 v[156:159], a[116:119], a[60:63], v[156:159]
 v_mfma_f32_16x16x32_bf16 v[156:159], a[112:115], a[56:59], v[156:159]
 ds_read_b64_tr_b16 a[158:159], v23 offset:25344
 v_mfma_f32_16x16x32_bf16 a[172:175], a[144:147], a[188:191], a[172:175]
 s_waitcnt lgkmcnt(12)
 v_mfma_f32_16x16x32_bf16 a[172:175], a[148:151], a[188:191], a[172:175]
 s_waitcnt lgkmcnt(8)
 v_mfma_f32_16x16x32_bf16 v[172:175], a[120:123], a[56:59], v[172:175]
 ds_read_b64_tr_b16 a[104:105], v16 offset:16480
 v_mfma_f32_16x16x32_bf16 v[172:175], a[124:127], a[60:63], v[172:175]
 ds_read_b64_tr_b16 a[106:107], v16 offset:18272
 v_mfma_f32_16x16x32_bf16 v[168:171], a[124:127], a[52:55], v[168:171]
 ds_read_b64_tr_b16 a[108:109], v16 offset:23648
 v_mfma_f32_16x16x32_bf16 v[168:171], a[120:123], a[48:51], v[168:171]
 ds_read_b64_tr_b16 a[110:111], v16 offset:25440
 s_add_u32 m0, s39, 2048
 v_mfma_f32_16x16x32_bf16 v[164:167], a[120:123], a[40:43], v[164:167]
 buffer_load_dwordx4 v1, s[8:11], s37 offen lds
 v_mfma_f32_16x16x32_bf16 v[164:167], a[124:127], a[44:47], v[164:167]
 ds_read_b64_tr_b16 a[160:161], v23 offset:16416
 s_add_u32 m0, s46, 81920
 v_mfma_f32_16x16x32_bf16 v[160:163], a[124:127], a[36:39], v[160:163]
 buffer_load_dwordx4 v4, s[12:15], s32 offen lds
 v_mfma_f32_16x16x32_bf16 v[160:163], a[120:123], a[32:35], v[160:163]
 ds_read_b64_tr_b16 a[162:163], v23 offset:18208
 v_mfma_f32_16x16x32_bf16 a[176:179], a[136:139], a[188:191], a[176:179]
 v_mfma_f32_16x16x32_bf16 a[176:179], a[140:143], a[188:191], a[176:179]
 s_waitcnt lgkmcnt(8)
 v_mfma_f32_16x16x32_bf16 v[176:179], a[96:99], a[32:35], v[176:179]
 ds_read_b64_tr_b16 a[112:113], v16 offset:16512
 v_mfma_f32_16x16x32_bf16 v[176:179], a[100:103], a[36:39], v[176:179]
 ds_read_b64_tr_b16 a[114:115], v16 offset:18304
 v_mfma_f32_16x16x32_bf16 v[180:183], a[100:103], a[44:47], v[180:183]
 ds_read_b64_tr_b16 a[116:117], v16 offset:23680
 v_mfma_f32_16x16x32_bf16 v[180:183], a[96:99], a[40:43], v[180:183]
 ds_read_b64_tr_b16 a[118:119], v16 offset:25472
 s_add_u32 m0, s39, 3072
 v_mfma_f32_16x16x32_bf16 v[184:187], a[96:99], a[48:51], v[184:187]
 buffer_load_dwordx4 v2, s[8:11], s37 offen lds
 v_mfma_f32_16x16x32_bf16 v[184:187], a[100:103], a[52:55], v[184:187]
 ds_read_b64_tr_b16 a[164:165], v23 offset:23584
 v_mfma_f32_16x16x32_bf16 v[188:191], a[100:103], a[60:63], v[188:191]
 v_mfma_f32_16x16x32_bf16 v[188:191], a[96:99], a[56:59], v[188:191]
 ds_read_b64_tr_b16 a[166:167], v23 offset:25376
 v_mfma_f32_16x16x32_bf16 a[180:183], a[152:155], a[188:191], a[180:183]
 s_waitcnt lgkmcnt(12)
 v_mfma_f32_16x16x32_bf16 a[180:183], a[156:159], a[188:191], a[180:183]
 s_waitcnt lgkmcnt(8)
 v_mfma_f32_16x16x32_bf16 v[204:207], a[104:107], a[56:59], v[204:207]
 ds_read_b64_tr_b16 a[120:121], v16 offset:16544
 v_mfma_f32_16x16x32_bf16 v[204:207], a[108:111], a[60:63], v[204:207]
 ds_read_b64_tr_b16 a[122:123], v16 offset:18336
 v_mfma_f32_16x16x32_bf16 v[200:203], a[108:111], a[52:55], v[200:203]
 ds_read_b64_tr_b16 a[124:125], v16 offset:23712
 v_mfma_f32_16x16x32_bf16 v[200:203], a[104:107], a[48:51], v[200:203]
 ds_read_b64_tr_b16 a[126:127], v16 offset:25504
 s_add_u32 m0, s47, 104448
 v_mfma_f32_16x16x32_bf16 v[196:199], a[104:107], a[40:43], v[196:199]
 buffer_load_dwordx4 v8, s[24:27], s33 offen lds
 s_add_u32 s37, s31, 65536
 v_mfma_f32_16x16x32_bf16 v[196:199], a[108:111], a[44:47], v[196:199]
 s_add_u32 m0, s39, 4096
 v_mfma_f32_16x16x32_bf16 v[192:195], a[108:111], a[36:39], v[192:195]
 buffer_load_dwordx4 v1, s[8:11], s37 offen lds
 v_mfma_f32_16x16x32_bf16 v[192:195], a[104:107], a[32:35], v[192:195]
 s_waitcnt lgkmcnt(6)
 v_mfma_f32_16x16x32_bf16 v[208:211], a[112:115], a[32:35], v[208:211]
 ds_read_b64_tr_b16 a[96:97], v16 offset:16576
 v_mfma_f32_16x16x32_bf16 v[208:211], a[116:119], a[36:39], v[208:211]
 ds_read_b64_tr_b16 a[98:99], v16 offset:18368
 v_mfma_f32_16x16x32_bf16 v[212:215], a[116:119], a[44:47], v[212:215]
 ds_read_b64_tr_b16 a[100:101], v16 offset:23744
 v_mfma_f32_16x16x32_bf16 v[212:215], a[112:115], a[40:43], v[212:215]
 ds_read_b64_tr_b16 a[102:103], v16 offset:25536
 s_add_u32 m0, s47, 105472
 v_mfma_f32_16x16x32_bf16 v[216:219], a[112:115], a[48:51], v[216:219]
 buffer_load_dwordx4 v9, s[24:27], s33 offen lds
 v_mfma_f32_16x16x32_bf16 v[216:219], a[116:119], a[52:55], v[216:219]
 v_mfma_f32_16x16x32_bf16 v[220:223], a[116:119], a[60:63], v[220:223]
 v_mfma_f32_16x16x32_bf16 v[220:223], a[112:115], a[56:59], v[220:223]
 v_mfma_f32_16x16x32_bf16 a[184:187], a[160:163], a[188:191], a[184:187]
 s_waitcnt lgkmcnt(8)
 v_mfma_f32_16x16x32_bf16 a[184:187], a[164:167], a[188:191], a[184:187]
 s_waitcnt vmcnt(11) lgkmcnt(0)
 s_barrier
 v_mfma_f32_16x16x32_bf16 v[236:239], a[120:123], a[56:59], v[236:239]
 ds_read_b64_tr_b16 a[104:105], v14 offset:0
 v_mfma_f32_16x16x32_bf16 v[236:239], a[124:127], a[60:63], v[236:239]
 ds_read_b64_tr_b16 a[106:107], v14 offset:256
 v_mfma_f32_16x16x32_bf16 v[232:235], a[124:127], a[52:55], v[232:235]
 ds_read_b64_tr_b16 a[108:109], v14 offset:2048
 buffer_store_dwordx4 a[172:175], v34, s[20:23], s52 offen offset:0 sc1
 v_mfma_f32_16x16x32_bf16 v[232:235], a[120:123], a[48:51], v[232:235]
 ds_read_b64_tr_b16 a[110:111], v14 offset:2304
 v_mfma_f32_16x16x32_bf16 v[228:231], a[120:123], a[40:43], v[228:231]
 ds_read_b128 a[64:67], v10 offset:32768
 v_mfma_f32_16x16x32_bf16 v[228:231], a[124:127], a[44:47], v[228:231]
 ds_read_b128 a[68:71], v11 offset:32768
 buffer_store_dwordx4 a[176:179], v34, s[20:23], s52 offen offset:1024 sc1
 v_mfma_f32_16x16x32_bf16 v[224:227], a[124:127], a[36:39], v[224:227]
 ds_read_b128 a[76:79], v11 offset:34816
 v_mfma_f32_16x16x32_bf16 v[224:227], a[120:123], a[32:35], v[224:227]
 ds_read_b128 a[72:75], v10 offset:34816
 v_mfma_f32_16x16x32_bf16 v[240:243], a[96:99], a[32:35], v[240:243]
 ds_read_b64_tr_b16 a[112:113], v15 offset:0
 buffer_store_dwordx4 a[180:183], v34, s[20:23], s52 offen offset:2048 sc1
 v_mfma_f32_16x16x32_bf16 v[240:243], a[100:103], a[36:39], v[240:243]
 ds_read_b64_tr_b16 a[114:115], v15 offset:256
 v_mfma_f32_16x16x32_bf16 v[244:247], a[100:103], a[44:47], v[244:247]
 ds_read_b64_tr_b16 a[116:117], v15 offset:2048
 v_mfma_f32_16x16x32_bf16 v[244:247], a[96:99], a[40:43], v[244:247]
 ds_read_b64_tr_b16 a[118:119], v15 offset:2304
 buffer_store_dwordx4 a[184:187], v34, s[20:23], s52 offen offset:3072 sc1
 v_mfma_f32_16x16x32_bf16 v[248:251], a[96:99], a[48:51], v[248:251]
 ds_read_b128 a[80:83], v10 offset:36864
 v_mfma_f32_16x16x32_bf16 v[248:251], a[100:103], a[52:55], v[248:251]
 ds_read_b128 a[84:87], v11 offset:36864
 s_mov_b32 s48, s82
 v_mfma_f32_16x16x32_bf16 v[252:255], a[100:103], a[60:63], v[252:255]
 ds_read_b128 a[92:95], v11 offset:38912
 s_and_b32 s49, s83, 0xffff
 v_mfma_f32_16x16x32_bf16 v[252:255], a[96:99], a[56:59], v[252:255]
 ds_read_b128 a[88:91], v10 offset:38912
 s_waitcnt lgkmcnt(8)
 v_mfma_f32_16x16x32_bf16 v[48:51], a[104:107], a[64:67], v[48:51]
 ds_read_b64_tr_b16 a[120:121], v14 offset:4096
 s_mov_b32 s50, 0x0
 v_mfma_f32_16x16x32_bf16 v[48:51], a[108:111], a[68:71], v[48:51]
 ds_read_b64_tr_b16 a[122:123], v14 offset:4352
 s_bfe_u32 s98, s2, 0x20003
 v_mfma_f32_16x16x32_bf16 v[52:55], a[108:111], a[76:79], v[52:55]
 ds_read_b64_tr_b16 a[124:125], v14 offset:6144
 s_mul_i32 s96, s28, 640
 s_cmp_eq_u32 s70, 5
 s_cbranch_scc1 L_cap5
L_capb5:
 v_mfma_f32_16x16x32_bf16 v[52:55], a[104:107], a[72:75], v[52:55]
 ds_read_b64_tr_b16 a[126:127], v14 offset:6400
 s_add_u32 m0, s39, 5120
 s_waitcnt lgkmcnt(4)
 v_mfma_f32_16x16x32_bf16 v[56:59], a[104:107], a[80:83], v[56:59]
 buffer_load_dwordx4 v2, s[8:11], s37 offen lds
 v_mov_b32 v23, 1
 v_mfma_f32_16x16x32_bf16 v[56:59], a[108:111], a[84:87], v[56:59]
 s_add_u32 m0, s46, 86016
 v_accvgpr_read_b32 v24, a128
 v_mfma_f32_16x16x32_bf16 v[60:63], a[108:111], a[92:95], v[60:63]
 buffer_load_dwordx4 v5, s[12:15], s32 offen lds
 s_add_u32 s37, s31, 98304
 v_mfma_f32_16x16x32_bf16 v[60:63], a[104:107], a[88:91], v[60:63]
 v_accvgpr_read_b32 v18, a129
 v_mfma_f32_16x16x32_bf16 v[76:79], a[112:115], a[88:91], v[76:79]
 ds_read_b64_tr_b16 a[96:97], v15 offset:4096
 v_accvgpr_read_b32 v35, a130
 v_mfma_f32_16x16x32_bf16 v[76:79], a[116:119], a[92:95], v[76:79]
 ds_read_b64_tr_b16 a[98:99], v15 offset:4352
 v_accvgpr_read_b32 v34, a131
 v_mfma_f32_16x16x32_bf16 v[72:75], a[116:119], a[84:87], v[72:75]
 ds_read_b64_tr_b16 a[100:101], v15 offset:6144
 v_accvgpr_read_b32 v22, a132
 v_mfma_f32_16x16x32_bf16 v[72:75], a[112:115], a[80:83], v[72:75]
 ds_read_b64_tr_b16 a[102:103], v15 offset:6400
 s_add_u32 m0, s39, 6144
 v_mfma_f32_16x16x32_bf16 v[68:71], a[112:115], a[72:75], v[68:71]
 buffer_load_dwordx4 v1, s[8:11], s37 offen lds
 v_accvgpr_read_b32 v25, a133
 v_mfma_f32_16x16x32_bf16 v[68:71], a[116:119], a[76:79], v[68:71]
 s_add_u32 m0, s39, 7168
 s_add_u32 s96, s96, 152896
 s_mov_b32 s78, 0xc0135761
 v_mfma_f32_16x16x32_bf16 v[64:67], a[116:119], a[68:71], v[64:67]
 buffer_load_dwordx4 v2, s[8:11], s37 offen lds
 s_xor_b32 s38, s41, 4
 v_mfma_f32_16x16x32_bf16 v[64:67], a[112:115], a[64:67], v[64:67]
 s_lshl_b32 s31, s38, 7
 s_mul_i32 s32, s38, 393216
 s_waitcnt lgkmcnt(4)
 v_mfma_f32_16x16x32_bf16 v[80:83], a[120:123], a[64:67], v[80:83]
 ds_read_b64_tr_b16 a[104:105], v14 offset:8192
 s_mul_i32 s33, s38, 458752
 v_mfma_f32_16x16x32_bf16 v[80:83], a[124:127], a[68:71], v[80:83]
 ds_read_b64_tr_b16 a[106:107], v14 offset:8448
 s_mov_b32 s79, 0xbdd2d3e8
 v_mfma_f32_16x16x32_bf16 v[84:87], a[124:127], a[76:79], v[84:87]
 ds_read_b64_tr_b16 a[108:109], v14 offset:10240
 s_add_u32 s99, s63, s65
 v_mfma_f32_16x16x32_bf16 v[84:87], a[120:123], a[72:75], v[84:87]
 ds_read_b64_tr_b16 a[110:111], v14 offset:10496
 s_and_b32 s99, s99, 7
 v_mfma_f32_16x16x32_bf16 v[88:91], a[120:123], a[80:83], v[88:91]
 s_mul_i32 s99, s99, s64
 s_add_u32 s66, s99, s43
 s_mul_i32 s99, s63, 229376
 v_mfma_f32_16x16x32_bf16 v[88:91], a[124:127], a[84:87], v[88:91]
 s_add_u32 m0, s46, 90112
 s_add_u32 s67, s99, s59
 v_mfma_f32_16x16x32_bf16 v[92:95], a[124:127], a[92:95], v[92:95]
 buffer_load_dwordx4 v3, s[12:15], s32 offen lds
 v_mfma_f32_16x16x32_bf16 v[92:95], a[120:123], a[88:91], v[92:95]
 s_cmp_le_u32 s63, 0
 s_addc_u32 s99, 0, 0
 s_waitcnt lgkmcnt(4)
 v_mfma_f32_16x16x32_bf16 v[108:111], a[96:99], a[88:91], v[108:111]
 ds_read_b64_tr_b16 a[112:113], v15 offset:8192
 s_add_u32 s99, s99, s65
 v_mfma_f32_16x16x32_bf16 v[108:111], a[100:103], a[92:95], v[108:111]
 ds_read_b64_tr_b16 a[114:115], v15 offset:8448
 s_and_b32 s99, s99, 7
 v_mfma_f32_16x16x32_bf16 v[104:107], a[100:103], a[84:87], v[104:107]
 ds_read_b64_tr_b16 a[116:117], v15 offset:10240
 s_mul_i32 s99, s99, s64
 v_mfma_f32_16x16x32_bf16 v[104:107], a[96:99], a[80:83], v[104:107]
 ds_read_b64_tr_b16 a[118:119], v15 offset:10496
 s_add_u32 m0, s39, 32768
 v_mfma_f32_16x16x32_bf16 v[100:103], a[96:99], a[72:75], v[100:103]
 buffer_load_dwordx4 v1, s[8:11], s31 offen lds
 s_add_u32 s72, s99, s43
 v_mfma_f32_16x16x32_bf16 v[100:103], a[100:103], a[76:79], v[100:103]
 s_add_u32 m0, s47, 118784
 s_cmp_le_u32 s63, 1
 s_addc_u32 s99, 1, 0
 v_mfma_f32_16x16x32_bf16 v[96:99], a[100:103], a[68:71], v[96:99]
 buffer_load_dwordx4 v6, s[16:19], s33 offen lds
 s_add_u32 s99, s99, s65
 v_mfma_f32_16x16x32_bf16 v[96:99], a[96:99], a[64:67], v[96:99]
 s_and_b32 s99, s99, 7
 s_mul_i32 s99, s99, s64
 s_waitcnt lgkmcnt(4)
 v_mfma_f32_16x16x32_bf16 v[112:115], a[64:67], a[104:107], v[112:115]
 ds_read_b64_tr_b16 a[120:121], v16 offset:32768
 s_add_u32 s73, s99, s43
 v_mfma_f32_16x16x32_bf16 v[112:115], a[68:71], a[108:111], v[112:115]
 ds_read_b64_tr_b16 a[122:123], v16 offset:34560
 v_mfma_f32_16x16x32_bf16 v[116:119], a[76:79], a[108:111], v[116:119]
 ds_read_b64_tr_b16 a[124:125], v16 offset:39936
 v_mfma_f32_16x16x32_bf16 v[116:119], a[72:75], a[104:107], v[116:119]
 ds_read_b64_tr_b16 a[126:127], v16 offset:41728
 v_mfma_f32_16x16x32_bf16 v[120:123], a[80:83], a[104:107], v[120:123]
 s_cmp_le_u32 s63, 2
 s_addc_u32 s99, 2, 0
 s_add_u32 s99, s99, s65
 v_mfma_f32_16x16x32_bf16 v[120:123], a[84:87], a[108:111], v[120:123]
 s_add_u32 m0, s39, 33792
 s_and_b32 s99, s99, 7
 s_mul_i32 s99, s99, s64
 v_mfma_f32_16x16x32_bf16 v[124:127], a[92:95], a[108:111], v[124:127]
 buffer_load_dwordx4 v2, s[8:11], s31 offen lds
 s_add_u32 s74, s99, s43
 v_mfma_f32_16x16x32_bf16 v[124:127], a[88:91], a[104:107], v[124:127]
 s_cmp_le_u32 s63, 3
 s_addc_u32 s99, 3, 0
 s_waitcnt lgkmcnt(4)
 v_mfma_f32_16x16x32_bf16 v[140:143], a[88:91], a[112:115], v[140:143]
 ds_read_b64_tr_b16 a[96:97], v16 offset:32800
 s_add_u32 s99, s99, s65
 v_mfma_f32_16x16x32_bf16 v[140:143], a[92:95], a[116:119], v[140:143]
 ds_read_b64_tr_b16 a[98:99], v16 offset:34592
 s_and_b32 s99, s99, 7
 v_mfma_f32_16x16x32_bf16 v[136:139], a[84:87], a[116:119], v[136:139]
 ds_read_b64_tr_b16 a[100:101], v16 offset:39968
 s_mul_i32 s99, s99, s64
 v_mfma_f32_16x16x32_bf16 v[136:139], a[80:83], a[112:115], v[136:139]
 ds_read_b64_tr_b16 a[102:103], v16 offset:41760
 s_add_u32 m0, s47, 119808
 v_mfma_f32_16x16x32_bf16 v[132:135], a[72:75], a[112:115], v[132:135]
 buffer_load_dwordx4 v7, s[16:19], s33 offen lds
 s_add_u32 s37, s31, 32768
 v_mfma_f32_16x16x32_bf16 v[132:135], a[76:79], a[116:119], v[132:135]
 s_add_u32 m0, s39, 34816
 s_add_u32 s75, s99, s43
 v_mfma_f32_16x16x32_bf16 v[128:131], a[68:71], a[116:119], v[128:131]
 buffer_load_dwordx4 v1, s[8:11], s37 offen lds
 v_mfma_f32_16x16x32_bf16 v[128:131], a[64:67], a[112:115], v[128:131]
 s_waitcnt lgkmcnt(4)
 v_mfma_f32_16x16x32_bf16 v[144:147], a[120:123], a[64:67], v[144:147]
 ds_read_b64_tr_b16 a[104:105], v16 offset:32832
 v_mfma_f32_16x16x32_bf16 v[144:147], a[124:127], a[68:71], v[144:147]
 ds_read_b64_tr_b16 a[106:107], v16 offset:34624
 v_mfma_f32_16x16x32_bf16 v[148:151], a[124:127], a[76:79], v[148:151]
 ds_read_b64_tr_b16 a[108:109], v16 offset:40000
 v_mfma_f32_16x16x32_bf16 v[148:151], a[120:123], a[72:75], v[148:151]
 ds_read_b64_tr_b16 a[110:111], v16 offset:41792
 s_add_u32 m0, s46, 94208
 v_mfma_f32_16x16x32_bf16 v[152:155], a[120:123], a[80:83], v[152:155]
 buffer_load_dwordx4 v4, s[12:15], s32 offen lds
 v_mfma_f32_16x16x32_bf16 v[152:155], a[124:127], a[84:87], v[152:155]
L_pg3:
 s_cbranch_execz L_pg7
 v_mfma_f32_16x16x32_bf16 v[156:159], a[124:127], a[92:95], v[156:159]
 v_mfma_f32_16x16x32_bf16 v[156:159], a[120:123], a[88:91], v[156:159]
 s_waitcnt lgkmcnt(4)
 v_mfma_f32_16x16x32_bf16 v[172:175], a[96:99], a[88:91], v[172:175]
 ds_read_b64_tr_b16 a[112:113], v16 offset:32864
 v_mfma_f32_16x16x32_bf16 v[172:175], a[100:103], a[92:95], v[172:175]
 ds_read_b64_tr_b16 a[114:115], v16 offset:34656
 v_mfma_f32_16x16x32_bf16 v[168:171], a[100:103], a[84:87], v[168:171]
 ds_read_b64_tr_b16 a[116:117], v16 offset:40032
 v_mfma_f32_16x16x32_bf16 v[168:171], a[96:99], a[80:83], v[168:171]
 ds_read_b64_tr_b16 a[118:119], v16 offset:41824
 s_add_u32 m0, s39, 35840
 v_mfma_f32_16x16x32_bf16 v[164:167], a[96:99], a[72:75], v[164:167]
 buffer_load_dwordx4 v2, s[8:11], s37 offen lds
 v_mfma_f32_16x16x32_bf16 v[164:167], a[100:103], a[76:79], v[164:167]
 s_add_u32 m0, s47, 120832
 v_mfma_f32_16x16x32_bf16 v[160:163], a[100:103], a[68:71], v[160:163]
 buffer_load_dwordx4 v8, s[24:27], s33 offen lds
 s_add_u32 s37, s31, 65536
 v_mfma_f32_16x16x32_bf16 v[160:163], a[96:99], a[64:67], v[160:163]
 s_waitcnt lgkmcnt(4)
 v_mfma_f32_16x16x32_bf16 v[176:179], a[104:107], a[64:67], v[176:179]
 ds_read_b64_tr_b16 a[120:121], v16 offset:32896
 v_mfma_f32_16x16x32_bf16 v[176:179], a[108:111], a[68:71], v[176:179]
 ds_read_b64_tr_b16 a[122:123], v16 offset:34688
 v_mfma_f32_16x16x32_bf16 v[180:183], a[108:111], a[76:79], v[180:183]
 ds_read_b64_tr_b16 a[124:125], v16 offset:40064
 v_mfma_f32_16x16x32_bf16 v[180:183], a[104:107], a[72:75], v[180:183]
 ds_read_b64_tr_b16 a[126:127], v16 offset:41856
 s_add_u32 m0, s39, 36864
 v_mfma_f32_16x16x32_bf16 v[184:187], a[104:107], a[80:83], v[184:187]
 buffer_load_dwordx4 v1, s[8:11], s37 offen lds
 v_mfma_f32_16x16x32_bf16 v[184:187], a[108:111], a[84:87], v[184:187]
 v_mfma_f32_16x16x32_bf16 v[188:191], a[108:111], a[92:95], v[188:191]
 v_mfma_f32_16x16x32_bf16 v[188:191], a[104:107], a[88:91], v[188:191]
 s_waitcnt lgkmcnt(4)
 v_mfma_f32_16x16x32_bf16 v[204:207], a[112:115], a[88:91], v[204:207]
 ds_read_b64_tr_b16 a[96:97], v16 offset:32928
 v_mfma_f32_16x16x32_bf16 v[204:207], a[116:119], a[92:95], v[204:207]
 ds_read_b64_tr_b16 a[98:99], v16 offset:34720
 v_mfma_f32_16x16x32_bf16 v[200:203], a[116:119], a[84:87], v[200:203]
 ds_read_b64_tr_b16 a[100:101], v16 offset:40096
 v_mfma_f32_16x16x32_bf16 v[200:203], a[112:115], a[80:83], v[200:203]
 ds_read_b64_tr_b16 a[102:103], v16 offset:41888
 s_add_u32 m0, s47, 121856
 v_mfma_f32_16x16x32_bf16 v[196:199], a[112:115], a[72:75], v[196:199]
 buffer_load_dwordx4 v9, s[24:27], s33 offen lds
 v_mfma_f32_16x16x32_bf16 v[196:199], a[116:119], a[76:79], v[196:199]
 s_add_u32 m0, s39, 37888
 v_mfma_f32_16x16x32_bf16 v[192:195], a[116:119], a[68:71], v[192:195]
 buffer_load_dwordx4 v2, s[8:11], s37 offen lds
 v_mfma_f32_16x16x32_bf16 v[192:195], a[112:115], a[64:67], v[192:195]
 s_waitcnt lgkmcnt(4)
 v_mfma_f32_16x16x32_bf16 v[208:211], a[120:123], a[64:67], v[208:211]
 ds_read_b64_tr_b16 a[104:105], v16 offset:32960
 v_mfma_f32_16x16x32_bf16 v[208:211], a[124:127], a[68:71], v[208:211]
 ds_read_b64_tr_b16 a[106:107], v16 offset:34752
 v_mfma_f32_16x16x32_bf16 v[212:215], a[124:127], a[76:79], v[212:215]
 ds_read_b64_tr_b16 a[108:109], v16 offset:40128
 v_mfma_f32_16x16x32_bf16 v[212:215], a[120:123], a[72:75], v[212:215]
 ds_read_b64_tr_b16 a[110:111], v16 offset:41920
 s_add_u32 m0, s46, 98304
 v_mfma_f32_16x16x32_bf16 v[216:219], a[120:123], a[80:83], v[216:219]
 buffer_load_dwordx4 v5, s[12:15], s32 offen lds
 s_add_u32 s37, s31, 98304
 v_mfma_f32_16x16x32_bf16 v[216:219], a[124:127], a[84:87], v[216:219]
 v_mfma_f32_16x16x32_bf16 v[220:223], a[124:127], a[92:95], v[220:223]
 v_mfma_f32_16x16x32_bf16 v[220:223], a[120:123], a[88:91], v[220:223]
 s_waitcnt vmcnt(17)
 s_waitcnt vmcnt(13) lgkmcnt(0)
 s_barrier
 v_mfma_f32_16x16x32_bf16 v[236:239], a[96:99], a[88:91], v[236:239]
 ds_read_b64_tr_b16 a[112:113], v14 offset:12288
 v_mfma_f32_16x16x32_bf16 v[236:239], a[100:103], a[92:95], v[236:239]
 ds_read_b64_tr_b16 a[114:115], v14 offset:12544
 v_mfma_f32_16x16x32_bf16 v[232:235], a[100:103], a[84:87], v[232:235]
 ds_read_b64_tr_b16 a[116:117], v14 offset:14336
 v_mfma_f32_16x16x32_bf16 v[232:235], a[96:99], a[80:83], v[232:235]
 ds_read_b64_tr_b16 a[118:119], v14 offset:14592
 v_mfma_f32_16x16x32_bf16 v[228:231], a[96:99], a[72:75], v[228:231]
 ds_read_b128 a[0:3], v10 offset:0
 v_mfma_f32_16x16x32_bf16 v[228:231], a[100:103], a[76:79], v[228:231]
 ds_read_b128 a[4:7], v11 offset:0
 v_mfma_f32_16x16x32_bf16 v[224:227], a[100:103], a[68:71], v[224:227]
 ds_read_b128 a[12:15], v11 offset:2048
 v_mfma_f32_16x16x32_bf16 v[224:227], a[96:99], a[64:67], v[224:227]
 ds_read_b128 a[8:11], v10 offset:2048
 v_mfma_f32_16x16x32_bf16 v[240:243], a[104:107], a[64:67], v[240:243]
 ds_read_b64_tr_b16 a[120:121], v15 offset:12288
 v_mfma_f32_16x16x32_bf16 v[240:243], a[108:111], a[68:71], v[240:243]
 ds_read_b64_tr_b16 a[122:123], v15 offset:12544
 v_mfma_f32_16x16x32_bf16 v[244:247], a[108:111], a[76:79], v[244:247]
 ds_read_b64_tr_b16 a[124:125], v15 offset:14336
 v_mfma_f32_16x16x32_bf16 v[244:247], a[104:107], a[72:75], v[244:247]
 ds_read_b64_tr_b16 a[126:127], v15 offset:14592
 v_mfma_f32_16x16x32_bf16 v[248:251], a[104:107], a[80:83], v[248:251]
 ds_read_b128 a[16:19], v10 offset:4096
 v_mfma_f32_16x16x32_bf16 v[248:251], a[108:111], a[84:87], v[248:251]
 ds_read_b128 a[20:23], v11 offset:4096
 v_mfma_f32_16x16x32_bf16 v[252:255], a[108:111], a[92:95], v[252:255]
 ds_read_b128 a[28:31], v11 offset:6144
 v_mfma_f32_16x16x32_bf16 v[252:255], a[104:107], a[88:91], v[252:255]
 ds_read_b128 a[24:27], v10 offset:6144
 s_waitcnt lgkmcnt(8)
 v_mfma_f32_16x16x32_bf16 v[48:51], a[112:115], a[0:3], v[48:51]
 ds_read_b64_tr_b16 a[96:97], v14 offset:16384
 v_mfma_f32_16x16x32_bf16 v[48:51], a[116:119], a[4:7], v[48:51]
 ds_read_b64_tr_b16 a[98:99], v14 offset:16640
 v_mfma_f32_16x16x32_bf16 v[52:55], a[116:119], a[12:15], v[52:55]
 ds_read_b64_tr_b16 a[100:101], v14 offset:18432
 s_cmp_eq_u32 s70, 6
 s_cbranch_scc1 L_cap6
L_capb6:
 v_mfma_f32_16x16x32_bf16 v[52:55], a[112:115], a[8:11], v[52:55]
 ds_read_b64_tr_b16 a[102:103], v14 offset:18688
 s_add_u32 m0, s39, 38912
 s_waitcnt lgkmcnt(4)
 v_mfma_f32_16x16x32_bf16 v[56:59], a[112:115], a[16:19], v[56:59]
 buffer_load_dwordx4 v1, s[8:11], s37 offen lds
 v_mfma_f32_16x16x32_bf16 v[56:59], a[116:119], a[20:23], v[56:59]
 s_add_u32 m0, s39, 39936
 v_mfma_f32_16x16x32_bf16 v[60:63], a[116:119], a[28:31], v[60:63]
 buffer_load_dwordx4 v2, s[8:11], s37 offen lds
 s_and_b32 s38, s34, 12
 v_mfma_f32_16x16x32_bf16 v[60:63], a[112:115], a[24:27], v[60:63]
 s_xor_b32 s38, s38, 8
 s_lshl_b32 s31, s38, 7
 v_mfma_f32_16x16x32_bf16 v[76:79], a[120:123], a[24:27], v[76:79]
 ds_read_b64_tr_b16 a[104:105], v15 offset:16384
 s_mul_i32 s32, s38, 393216
 v_mfma_f32_16x16x32_bf16 v[76:79], a[124:127], a[28:31], v[76:79]
 ds_read_b64_tr_b16 a[106:107], v15 offset:16640
 s_mul_i32 s33, s38, 458752
 v_mfma_f32_16x16x32_bf16 v[72:75], a[124:127], a[20:23], v[72:75]
 ds_read_b64_tr_b16 a[108:109], v15 offset:18432
 v_mfma_f32_16x16x32_bf16 v[72:75], a[120:123], a[16:19], v[72:75]
 ds_read_b64_tr_b16 a[110:111], v15 offset:18688
 s_add_u32 m0, s46, 65536
 v_mfma_f32_16x16x32_bf16 v[68:71], a[120:123], a[8:11], v[68:71]
 buffer_load_dwordx4 v3, s[12:15], s32 offen lds
 v_mfma_f32_16x16x32_bf16 v[68:71], a[124:127], a[12:15], v[68:71]
 s_cmp_eq_u32 s98, 0
 s_cselect_b32 s50, 256, 0
 v_mfma_f32_16x16x32_bf16 v[64:67], a[124:127], a[4:7], v[64:67]
 buffer_atomic_add v23, v24, s[48:51], 0 offen sc1
 v_mfma_f32_16x16x32_bf16 v[64:67], a[120:123], a[0:3], v[64:67]
 s_waitcnt lgkmcnt(4)
 v_mfma_f32_16x16x32_bf16 v[80:83], a[96:99], a[0:3], v[80:83]
 ds_read_b64_tr_b16 a[112:113], v14 offset:20480
 v_mfma_f32_16x16x32_bf16 v[80:83], a[100:103], a[4:7], v[80:83]
 ds_read_b64_tr_b16 a[114:115], v14 offset:20736
 v_mfma_f32_16x16x32_bf16 v[84:87], a[100:103], a[12:15], v[84:87]
 ds_read_b64_tr_b16 a[116:117], v14 offset:22528
 v_mfma_f32_16x16x32_bf16 v[84:87], a[96:99], a[8:11], v[84:87]
 ds_read_b64_tr_b16 a[118:119], v14 offset:22784
 s_add_u32 m0, s39, 0
 v_mfma_f32_16x16x32_bf16 v[88:91], a[96:99], a[16:19], v[88:91]
 buffer_load_dwordx4 v1, s[8:11], s31 offen lds
 v_mfma_f32_16x16x32_bf16 v[88:91], a[100:103], a[20:23], v[88:91]
 s_add_u32 m0, s47, 135168
 v_mfma_f32_16x16x32_bf16 v[92:95], a[100:103], a[28:31], v[92:95]
 buffer_load_dwordx4 v6, s[16:19], s33 offen lds
 v_mfma_f32_16x16x32_bf16 v[92:95], a[96:99], a[24:27], v[92:95]
 s_waitcnt lgkmcnt(4)
 v_mfma_f32_16x16x32_bf16 v[108:111], a[104:107], a[24:27], v[108:111]
 ds_read_b64_tr_b16 a[120:121], v15 offset:20480
 v_mfma_f32_16x16x32_bf16 v[108:111], a[108:111], a[28:31], v[108:111]
 ds_read_b64_tr_b16 a[122:123], v15 offset:20736
 v_mfma_f32_16x16x32_bf16 v[104:107], a[108:111], a[20:23], v[104:107]
 ds_read_b64_tr_b16 a[124:125], v15 offset:22528
 v_mfma_f32_16x16x32_bf16 v[104:107], a[104:107], a[16:19], v[104:107]
 ds_read_b64_tr_b16 a[126:127], v15 offset:22784
 v_mfma_f32_16x16x32_bf16 v[100:103], a[104:107], a[8:11], v[100:103]
 v_mfma_f32_16x16x32_bf16 v[100:103], a[108:111], a[12:15], v[100:103]
 s_add_u32 m0, s39, 1024
 v_mfma_f32_16x16x32_bf16 v[96:99], a[108:111], a[4:7], v[96:99]
 buffer_load_dwordx4 v2, s[8:11], s31 offen lds
 v_mfma_f32_16x16x32_bf16 v[96:99], a[104:107], a[0:3], v[96:99]
 s_waitcnt lgkmcnt(4)
 v_mfma_f32_16x16x32_bf16 v[112:115], a[0:3], a[112:115], v[112:115]
 ds_read_b64_tr_b16 a[96:97], v16 offset:0
 v_mfma_f32_16x16x32_bf16 v[112:115], a[4:7], a[116:119], v[112:115]
 ds_read_b64_tr_b16 a[98:99], v16 offset:1792
 v_mfma_f32_16x16x32_bf16 v[116:119], a[12:15], a[116:119], v[116:119]
 ds_read_b64_tr_b16 a[100:101], v16 offset:7168
 v_mfma_f32_16x16x32_bf16 v[116:119], a[8:11], a[112:115], v[116:119]
 ds_read_b64_tr_b16 a[102:103], v16 offset:8960
 s_add_u32 m0, s47, 136192
 v_mfma_f32_16x16x32_bf16 v[120:123], a[16:19], a[112:115], v[120:123]
 buffer_load_dwordx4 v7, s[16:19], s33 offen lds
 s_add_u32 s37, s31, 32768
 v_mfma_f32_16x16x32_bf16 v[120:123], a[20:23], a[116:119], v[120:123]
 v_mfma_f32_16x16x32_bf16 v[124:127], a[28:31], a[116:119], v[124:127]
 v_mfma_f32_16x16x32_bf16 v[124:127], a[24:27], a[112:115], v[124:127]
 s_waitcnt lgkmcnt(4)
 v_mfma_f32_16x16x32_bf16 v[140:143], a[24:27], a[120:123], v[140:143]
 ds_read_b64_tr_b16 a[104:105], v16 offset:32
 v_mfma_f32_16x16x32_bf16 v[140:143], a[28:31], a[124:127], v[140:143]
 ds_read_b64_tr_b16 a[106:107], v16 offset:1824
 v_mfma_f32_16x16x32_bf16 v[136:139], a[20:23], a[124:127], v[136:139]
 ds_read_b64_tr_b16 a[108:109], v16 offset:7200
 v_mfma_f32_16x16x32_bf16 v[136:139], a[16:19], a[120:123], v[136:139]
 ds_read_b64_tr_b16 a[110:111], v16 offset:8992
 s_add_u32 m0, s39, 2048
 v_mfma_f32_16x16x32_bf16 v[132:135], a[8:11], a[120:123], v[132:135]
 buffer_load_dwordx4 v1, s[8:11], s37 offen lds
 v_mfma_f32_16x16x32_bf16 v[132:135], a[12:15], a[124:127], v[132:135]
 s_add_u32 m0, s46, 69632
 v_mfma_f32_16x16x32_bf16 v[128:131], a[4:7], a[124:127], v[128:131]
 buffer_load_dwordx4 v4, s[12:15], s32 offen lds
 v_mfma_f32_16x16x32_bf16 v[128:131], a[0:3], a[120:123], v[128:131]
 s_waitcnt lgkmcnt(4)
 v_mfma_f32_16x16x32_bf16 v[144:147], a[96:99], a[0:3], v[144:147]
 ds_read_b64_tr_b16 a[112:113], v16 offset:64
 v_mfma_f32_16x16x32_bf16 v[144:147], a[100:103], a[4:7], v[144:147]
 ds_read_b64_tr_b16 a[114:115], v16 offset:1856
 v_mfma_f32_16x16x32_bf16 v[148:151], a[100:103], a[12:15], v[148:151]
 ds_read_b64_tr_b16 a[116:117], v16 offset:7232
 v_mfma_f32_16x16x32_bf16 v[148:151], a[96:99], a[8:11], v[148:151]
 ds_read_b64_tr_b16 a[118:119], v16 offset:9024
 v_mfma_f32_16x16x32_bf16 v[152:155], a[96:99], a[16:19], v[152:155]
 v_mfma_f32_16x16x32_bf16 v[152:155], a[100:103], a[20:23], v[152:155]
 s_add_u32 m0, s39, 3072
 v_mfma_f32_16x16x32_bf16 v[156:159], a[100:103], a[28:31], v[156:159]
 buffer_load_dwordx4 v2, s[8:11], s37 offen lds
 v_mfma_f32_16x16x32_bf16 v[156:159], a[96:99], a[24:27], v[156:159]
 s_waitcnt lgkmcnt(4)
 v_mfma_f32_16x16x32_bf16 v[172:175], a[104:107], a[24:27], v[172:175]
 ds_read_b64_tr_b16 a[120:121], v16 offset:96
 v_mfma_f32_16x16x32_bf16 v[172:175], a[108:111], a[28:31], v[172:175]
 ds_read_b64_tr_b16 a[122:123], v16 offset:1888
 v_mfma_f32_16x16x32_bf16 v[168:171], a[108:111], a[20:23], v[168:171]
 ds_read_b64_tr_b16 a[124:125], v16 offset:7264
 v_mfma_f32_16x16x32_bf16 v[168:171], a[104:107], a[16:19], v[168:171]
 ds_read_b64_tr_b16 a[126:127], v16 offset:9056
 s_add_u32 m0, s47, 137216
 v_mfma_f32_16x16x32_bf16 v[164:167], a[104:107], a[8:11], v[164:167]
 buffer_load_dwordx4 v8, s[24:27], s33 offen lds
 s_add_u32 s37, s31, 65536
 v_mfma_f32_16x16x32_bf16 v[164:167], a[108:111], a[12:15], v[164:167]
 v_mfma_f32_16x16x32_bf16 v[160:163], a[108:111], a[4:7], v[160:163]
 v_mfma_f32_16x16x32_bf16 v[160:163], a[104:107], a[0:3], v[160:163]
 s_waitcnt lgkmcnt(4)
 v_mfma_f32_16x16x32_bf16 v[176:179], a[112:115], a[0:3], v[176:179]
 ds_read_b64_tr_b16 a[96:97], v16 offset:128
 v_mfma_f32_16x16x32_bf16 v[176:179], a[116:119], a[4:7], v[176:179]
 ds_read_b64_tr_b16 a[98:99], v16 offset:1920
 v_mfma_f32_16x16x32_bf16 v[180:183], a[116:119], a[12:15], v[180:183]
 ds_read_b64_tr_b16 a[100:101], v16 offset:7296
 v_mfma_f32_16x16x32_bf16 v[180:183], a[112:115], a[8:11], v[180:183]
 ds_read_b64_tr_b16 a[102:103], v16 offset:9088
 s_add_u32 m0, s39, 4096
 v_mfma_f32_16x16x32_bf16 v[184:187], a[112:115], a[16:19], v[184:187]
 buffer_load_dwordx4 v1, s[8:11], s37 offen lds
 v_mfma_f32_16x16x32_bf16 v[184:187], a[116:119], a[20:23], v[184:187]
 s_add_u32 m0, s47, 138240
 v_mfma_f32_16x16x32_bf16 v[188:191], a[116:119], a[28:31], v[188:191]
 buffer_load_dwordx4 v9, s[24:27], s33 offen lds
 v_mfma_f32_16x16x32_bf16 v[188:191], a[112:115], a[24:27], v[188:191]
 s_cmp_eq_u32 s98, 1
 s_cselect_b32 s50, 256, 0
 s_waitcnt lgkmcnt(4)
 v_mfma_f32_16x16x32_bf16 v[204:207], a[120:123], a[24:27], v[204:207]
 ds_read_b64_tr_b16 a[104:105], v16 offset:160
 v_mfma_f32_16x16x32_bf16 v[204:207], a[124:127], a[28:31], v[204:207]
 ds_read_b64_tr_b16 a[106:107], v16 offset:1952
 v_mfma_f32_16x16x32_bf16 v[200:203], a[124:127], a[20:23], v[200:203]
 ds_read_b64_tr_b16 a[108:109], v16 offset:7328
 v_mfma_f32_16x16x32_bf16 v[200:203], a[120:123], a[16:19], v[200:203]
 ds_read_b64_tr_b16 a[110:111], v16 offset:9120
 v_mfma_f32_16x16x32_bf16 v[196:199], a[120:123], a[8:11], v[196:199]
 buffer_atomic_add v23, v24, s[48:51], 0 offen sc1
 v_mfma_f32_16x16x32_bf16 v[196:199], a[124:127], a[12:15], v[196:199]
 s_add_u32 m0, s39, 5120
 v_mfma_f32_16x16x32_bf16 v[192:195], a[124:127], a[4:7], v[192:195]
 buffer_load_dwordx4 v2, s[8:11], s37 offen lds
 v_mfma_f32_16x16x32_bf16 v[192:195], a[120:123], a[0:3], v[192:195]
 s_waitcnt lgkmcnt(4)
 v_mfma_f32_16x16x32_bf16 v[208:211], a[96:99], a[0:3], v[208:211]
 ds_read_b64_tr_b16 a[112:113], v16 offset:192
 v_mfma_f32_16x16x32_bf16 v[208:211], a[100:103], a[4:7], v[208:211]
 ds_read_b64_tr_b16 a[114:115], v16 offset:1984
 v_mfma_f32_16x16x32_bf16 v[212:215], a[100:103], a[12:15], v[212:215]
 ds_read_b64_tr_b16 a[116:117], v16 offset:7360
 v_mfma_f32_16x16x32_bf16 v[212:215], a[96:99], a[8:11], v[212:215]
 ds_read_b64_tr_b16 a[118:119], v16 offset:9152
 s_add_u32 m0, s46, 73728
 v_mfma_f32_16x16x32_bf16 v[216:219], a[96:99], a[16:19], v[216:219]
 buffer_load_dwordx4 v5, s[12:15], s32 offen lds
 s_add_u32 s37, s31, 98304
 v_mfma_f32_16x16x32_bf16 v[216:219], a[100:103], a[20:23], v[216:219]
 v_mfma_f32_16x16x32_bf16 v[220:223], a[100:103], a[28:31], v[220:223]
 v_mfma_f32_16x16x32_bf16 v[220:223], a[96:99], a[24:27], v[220:223]
 s_waitcnt vmcnt(15) lgkmcnt(0)
 s_barrier
 v_mfma_f32_16x16x32_bf16 v[236:239], a[104:107], a[24:27], v[236:239]
 ds_read_b64_tr_b16 a[120:121], v14 offset:24576
 v_mfma_f32_16x16x32_bf16 v[236:239], a[108:111], a[28:31], v[236:239]
 ds_read_b64_tr_b16 a[122:123], v14 offset:24832
 v_mfma_f32_16x16x32_bf16 v[232:235], a[108:111], a[20:23], v[232:235]
 ds_read_b64_tr_b16 a[124:125], v14 offset:26624
 v_mfma_f32_16x16x32_bf16 v[232:235], a[104:107], a[16:19], v[232:235]
 ds_read_b64_tr_b16 a[126:127], v14 offset:26880
 v_mfma_f32_16x16x32_bf16 v[228:231], a[104:107], a[8:11], v[228:231]
 ds_read_b128 a[32:35], v10 offset:32768
 v_mfma_f32_16x16x32_bf16 v[228:231], a[108:111], a[12:15], v[228:231]
 ds_read_b128 a[36:39], v11 offset:32768
 v_mfma_f32_16x16x32_bf16 v[224:227], a[108:111], a[4:7], v[224:227]
 ds_read_b128 a[44:47], v11 offset:34816
 v_mfma_f32_16x16x32_bf16 v[224:227], a[104:107], a[0:3], v[224:227]
 ds_read_b128 a[40:43], v10 offset:34816
 v_mfma_f32_16x16x32_bf16 v[240:243], a[112:115], a[0:3], v[240:243]
 ds_read_b64_tr_b16 a[96:97], v15 offset:24576
 v_mfma_f32_16x16x32_bf16 v[240:243], a[116:119], a[4:7], v[240:243]
 ds_read_b64_tr_b16 a[98:99], v15 offset:24832
 v_mfma_f32_16x16x32_bf16 v[244:247], a[116:119], a[12:15], v[244:247]
 ds_read_b64_tr_b16 a[100:101], v15 offset:26624
 v_mfma_f32_16x16x32_bf16 v[244:247], a[112:115], a[8:11], v[244:247]
 ds_read_b64_tr_b16 a[102:103], v15 offset:26880
 v_mfma_f32_16x16x32_bf16 v[248:251], a[112:115], a[16:19], v[248:251]
 ds_read_b128 a[48:51], v10 offset:36864
 v_mfma_f32_16x16x32_bf16 v[248:251], a[116:119], a[20:23], v[248:251]
 ds_read_b128 a[52:55], v11 offset:36864
 v_mfma_f32_16x16x32_bf16 v[252:255], a[116:119], a[28:31], v[252:255]
 ds_read_b128 a[60:63], v11 offset:38912
 v_mfma_f32_16x16x32_bf16 v[252:255], a[112:115], a[24:27], v[252:255]
 ds_read_b128 a[56:59], v10 offset:38912
 s_waitcnt lgkmcnt(8)
 v_mfma_f32_16x16x32_bf16 v[48:51], a[120:123], a[32:35], v[48:51]
 ds_read_b64_tr_b16 a[104:105], v14 offset:28672
 v_mfma_f32_16x16x32_bf16 v[48:51], a[124:127], a[36:39], v[48:51]
 ds_read_b64_tr_b16 a[106:107], v14 offset:28928
 v_mfma_f32_16x16x32_bf16 v[52:55], a[124:127], a[44:47], v[52:55]
 ds_read_b64_tr_b16 a[108:109], v14 offset:30720
 s_cmp_eq_u32 s70, 7
 s_cbranch_scc1 L_cap7
L_capb7:
 v_mfma_f32_16x16x32_bf16 v[52:55], a[120:123], a[40:43], v[52:55]
 ds_read_b64_tr_b16 a[110:111], v14 offset:30976
 s_add_u32 m0, s39, 6144
 s_waitcnt lgkmcnt(4)
 v_mfma_f32_16x16x32_bf16 v[56:59], a[120:123], a[48:51], v[56:59]
 buffer_load_dwordx4 v1, s[8:11], s37 offen lds
 v_mfma_f32_16x16x32_bf16 v[56:59], a[124:127], a[52:55], v[56:59]
 s_add_u32 m0, s39, 7168
 v_mfma_f32_16x16x32_bf16 v[60:63], a[124:127], a[60:63], v[60:63]
 buffer_load_dwordx4 v2, s[8:11], s37 offen lds
 s_and_b32 s38, s34, 12
 v_mfma_f32_16x16x32_bf16 v[60:63], a[120:123], a[56:59], v[60:63]
 s_xor_b32 s38, s38, 9
 s_lshl_b32 s31, s38, 7
 v_mfma_f32_16x16x32_bf16 v[76:79], a[96:99], a[56:59], v[76:79]
 ds_read_b64_tr_b16 a[112:113], v15 offset:28672
 s_mul_i32 s32, s38, 393216
 v_mfma_f32_16x16x32_bf16 v[76:79], a[100:103], a[60:63], v[76:79]
 ds_read_b64_tr_b16 a[114:115], v15 offset:28928
 s_mul_i32 s33, s38, 458752
 v_mfma_f32_16x16x32_bf16 v[72:75], a[100:103], a[52:55], v[72:75]
 ds_read_b64_tr_b16 a[116:117], v15 offset:30720
 v_mfma_f32_16x16x32_bf16 v[72:75], a[96:99], a[48:51], v[72:75]
 ds_read_b64_tr_b16 a[118:119], v15 offset:30976
 s_add_u32 m0, s46, 77824
 v_mfma_f32_16x16x32_bf16 v[68:71], a[96:99], a[40:43], v[68:71]
 buffer_load_dwordx4 v3, s[12:15], s32 offen lds
 v_mfma_f32_16x16x32_bf16 v[68:71], a[100:103], a[44:47], v[68:71]
 v_mfma_f32_16x16x32_bf16 v[64:67], a[100:103], a[36:39], v[64:67]
 v_mfma_f32_16x16x32_bf16 v[64:67], a[96:99], a[32:35], v[64:67]
 s_waitcnt lgkmcnt(4)
 v_mfma_f32_16x16x32_bf16 v[80:83], a[104:107], a[32:35], v[80:83]
 ds_read_b64_tr_b16 a[120:121], v14 offset:32768
 v_mfma_f32_16x16x32_bf16 v[80:83], a[108:111], a[36:39], v[80:83]
 ds_read_b64_tr_b16 a[122:123], v14 offset:33024
 v_mfma_f32_16x16x32_bf16 v[84:87], a[108:111], a[44:47], v[84:87]
 ds_read_b64_tr_b16 a[124:125], v14 offset:34816
 v_mfma_f32_16x16x32_bf16 v[84:87], a[104:107], a[40:43], v[84:87]
 ds_read_b64_tr_b16 a[126:127], v14 offset:35072
 s_add_u32 m0, s39, 32768
 v_mfma_f32_16x16x32_bf16 v[88:91], a[104:107], a[48:51], v[88:91]
 buffer_load_dwordx4 v1, s[8:11], s31 offen lds
 v_mfma_f32_16x16x32_bf16 v[88:91], a[108:111], a[52:55], v[88:91]
 s_add_u32 m0, s47, 102400
 v_mfma_f32_16x16x32_bf16 v[92:95], a[108:111], a[60:63], v[92:95]
 buffer_load_dwordx4 v6, s[16:19], s33 offen lds
 v_mfma_f32_16x16x32_bf16 v[92:95], a[104:107], a[56:59], v[92:95]
 s_waitcnt lgkmcnt(4)
 v_mfma_f32_16x16x32_bf16 v[108:111], a[112:115], a[56:59], v[108:111]
 ds_read_b64_tr_b16 a[96:97], v15 offset:32768
 v_mfma_f32_16x16x32_bf16 v[108:111], a[116:119], a[60:63], v[108:111]
 ds_read_b64_tr_b16 a[98:99], v15 offset:33024
 v_mfma_f32_16x16x32_bf16 v[104:107], a[116:119], a[52:55], v[104:107]
 ds_read_b64_tr_b16 a[100:101], v15 offset:34816
 v_mfma_f32_16x16x32_bf16 v[104:107], a[112:115], a[48:51], v[104:107]
 ds_read_b64_tr_b16 a[102:103], v15 offset:35072
 s_add_u32 m0, s39, 33792
 v_mfma_f32_16x16x32_bf16 v[100:103], a[112:115], a[40:43], v[100:103]
 buffer_load_dwordx4 v2, s[8:11], s31 offen lds
 v_mfma_f32_16x16x32_bf16 v[100:103], a[116:119], a[44:47], v[100:103]
 s_cmp_eq_u32 s98, 2
 s_cselect_b32 s50, 256, 0
 v_mfma_f32_16x16x32_bf16 v[96:99], a[116:119], a[36:39], v[96:99]
 buffer_atomic_add v23, v24, s[48:51], 0 offen sc1
 v_mfma_f32_16x16x32_bf16 v[96:99], a[112:115], a[32:35], v[96:99]
 s_waitcnt lgkmcnt(4)
 v_mfma_f32_16x16x32_bf16 v[112:115], a[32:35], a[120:123], v[112:115]
 ds_read_b64_tr_b16 a[104:105], v16 offset:16384
 v_mfma_f32_16x16x32_bf16 v[112:115], a[36:39], a[124:127], v[112:115]
 ds_read_b64_tr_b16 a[106:107], v16 offset:18176
 v_mfma_f32_16x16x32_bf16 v[116:119], a[44:47], a[124:127], v[116:119]
 ds_read_b64_tr_b16 a[108:109], v16 offset:23552
 v_mfma_f32_16x16x32_bf16 v[116:119], a[40:43], a[120:123], v[116:119]
 ds_read_b64_tr_b16 a[110:111], v16 offset:25344
 s_add_u32 m0, s47, 103424
 v_mfma_f32_16x16x32_bf16 v[120:123], a[48:51], a[120:123], v[120:123]
 buffer_load_dwordx4 v7, s[16:19], s33 offen lds
 s_add_u32 s37, s31, 32768
 v_mfma_f32_16x16x32_bf16 v[120:123], a[52:55], a[124:127], v[120:123]
 s_add_u32 m0, s39, 34816
 v_mfma_f32_16x16x32_bf16 v[124:127], a[60:63], a[124:127], v[124:127]
 buffer_load_dwordx4 v1, s[8:11], s37 offen lds
 v_mfma_f32_16x16x32_bf16 v[124:127], a[56:59], a[120:123], v[124:127]
 s_waitcnt lgkmcnt(4)
 v_mfma_f32_16x16x32_bf16 v[140:143], a[56:59], a[96:99], v[140:143]
 ds_read_b64_tr_b16 a[112:113], v16 offset:16416
 v_mfma_f32_16x16x32_bf16 v[140:143], a[60:63], a[100:103], v[140:143]
 ds_read_b64_tr_b16 a[114:115], v16 offset:18208
 v_mfma_f32_16x16x32_bf16 v[136:139], a[52:55], a[100:103], v[136:139]
 ds_read_b64_tr_b16 a[116:117], v16 offset:23584
 v_mfma_f32_16x16x32_bf16 v[136:139], a[48:51], a[96:99], v[136:139]
 ds_read_b64_tr_b16 a[118:119], v16 offset:25376
 v_mfma_f32_16x16x32_bf16 v[132:135], a[40:43], a[96:99], v[132:135]
 v_mfma_f32_16x16x32_bf16 v[132:135], a[44:47], a[100:103], v[132:135]
 s_add_u32 m0, s46, 81920
 v_mfma_f32_16x16x32_bf16 v[128:131], a[36:39], a[100:103], v[128:131]
 buffer_load_dwordx4 v4, s[12:15], s32 offen lds
 v_mfma_f32_16x16x32_bf16 v[128:131], a[32:35], a[96:99], v[128:131]
 s_waitcnt lgkmcnt(4)
 v_mfma_f32_16x16x32_bf16 v[144:147], a[104:107], a[32:35], v[144:147]
 ds_read_b64_tr_b16 a[120:121], v16 offset:16448
 v_mfma_f32_16x16x32_bf16 v[144:147], a[108:111], a[36:39], v[144:147]
 ds_read_b64_tr_b16 a[122:123], v16 offset:18240
 v_mfma_f32_16x16x32_bf16 v[148:151], a[108:111], a[44:47], v[148:151]
 ds_read_b64_tr_b16 a[124:125], v16 offset:23616
 v_mfma_f32_16x16x32_bf16 v[148:151], a[104:107], a[40:43], v[148:151]
 ds_read_b64_tr_b16 a[126:127], v16 offset:25408
 s_add_u32 m0, s39, 35840
 v_mfma_f32_16x16x32_bf16 v[152:155], a[104:107], a[48:51], v[152:155]
 buffer_load_dwordx4 v2, s[8:11], s37 offen lds
 v_mfma_f32_16x16x32_bf16 v[152:155], a[108:111], a[52:55], v[152:155]
 s_add_u32 m0, s47, 104448
 v_mfma_f32_16x16x32_bf16 v[156:159], a[108:111], a[60:63], v[156:159]
 buffer_load_dwordx4 v8, s[24:27], s33 offen lds
 s_add_u32 s37, s31, 65536
 v_mfma_f32_16x16x32_bf16 v[156:159], a[104:107], a[56:59], v[156:159]
 s_waitcnt lgkmcnt(4)
 v_mfma_f32_16x16x32_bf16 v[172:175], a[112:115], a[56:59], v[172:175]
 ds_read_b64_tr_b16 a[96:97], v16 offset:16480
 v_mfma_f32_16x16x32_bf16 v[172:175], a[116:119], a[60:63], v[172:175]
 ds_read_b64_tr_b16 a[98:99], v16 offset:18272
 v_mfma_f32_16x16x32_bf16 v[168:171], a[116:119], a[52:55], v[168:171]
 ds_read_b64_tr_b16 a[100:101], v16 offset:23648
 v_mfma_f32_16x16x32_bf16 v[168:171], a[112:115], a[48:51], v[168:171]
 ds_read_b64_tr_b16 a[102:103], v16 offset:25440
 v_mfma_f32_16x16x32_bf16 v[164:167], a[112:115], a[40:43], v[164:167]
 v_mfma_f32_16x16x32_bf16 v[164:167], a[116:119], a[44:47], v[164:167]
 s_add_u32 m0, s39, 36864
 v_mfma_f32_16x16x32_bf16 v[160:163], a[116:119], a[36:39], v[160:163]
 buffer_load_dwordx4 v1, s[8:11], s37 offen lds
 v_mfma_f32_16x16x32_bf16 v[160:163], a[112:115], a[32:35], v[160:163]
 s_waitcnt lgkmcnt(4)
 v_mfma_f32_16x16x32_bf16 v[176:179], a[120:123], a[32:35], v[176:179]
 ds_read_b64_tr_b16 a[104:105], v16 offset:16512
 v_mfma_f32_16x16x32_bf16 v[176:179], a[124:127], a[36:39], v[176:179]
 ds_read_b64_tr_b16 a[106:107], v16 offset:18304
 v_mfma_f32_16x16x32_bf16 v[180:183], a[124:127], a[44:47], v[180:183]
 ds_read_b64_tr_b16 a[108:109], v16 offset:23680
 v_mfma_f32_16x16x32_bf16 v[180:183], a[120:123], a[40:43], v[180:183]
 ds_read_b64_tr_b16 a[110:111], v16 offset:25472
 s_add_u32 m0, s47, 105472
 v_mfma_f32_16x16x32_bf16 v[184:187], a[120:123], a[48:51], v[184:187]
 buffer_load_dwordx4 v9, s[24:27], s33 offen lds
 v_mfma_f32_16x16x32_bf16 v[184:187], a[124:127], a[52:55], v[184:187]
 s_add_u32 m0, s39, 37888
 v_mfma_f32_16x16x32_bf16 v[188:191], a[124:127], a[60:63], v[188:191]
 buffer_load_dwordx4 v2, s[8:11], s37 offen lds
 v_mfma_f32_16x16x32_bf16 v[188:191], a[120:123], a[56:59], v[188:191]
 s_waitcnt lgkmcnt(4)
 v_mfma_f32_16x16x32_bf16 v[204:207], a[96:99], a[56:59], v[204:207]
 ds_read_b64_tr_b16 a[112:113], v16 offset:16544
 v_mfma_f32_16x16x32_bf16 v[204:207], a[100:103], a[60:63], v[204:207]
 ds_read_b64_tr_b16 a[114:115], v16 offset:18336
 v_mfma_f32_16x16x32_bf16 v[200:203], a[100:103], a[52:55], v[200:203]
 ds_read_b64_tr_b16 a[116:117], v16 offset:23712
 v_mfma_f32_16x16x32_bf16 v[200:203], a[96:99], a[48:51], v[200:203]
 ds_read_b64_tr_b16 a[118:119], v16 offset:25504
 v_mfma_f32_16x16x32_bf16 v[196:199], a[96:99], a[40:43], v[196:199]
 v_mfma_f32_16x16x32_bf16 v[196:199], a[100:103], a[44:47], v[196:199]
 s_add_u32 m0, s46, 86016
 v_mfma_f32_16x16x32_bf16 v[192:195], a[100:103], a[36:39], v[192:195]
 buffer_load_dwordx4 v5, s[12:15], s32 offen lds
 s_add_u32 s37, s31, 98304
 v_mfma_f32_16x16x32_bf16 v[192:195], a[96:99], a[32:35], v[192:195]
 s_waitcnt lgkmcnt(4)
 v_mfma_f32_16x16x32_bf16 v[208:211], a[104:107], a[32:35], v[208:211]
 ds_read_b64_tr_b16 a[120:121], v16 offset:16576
 v_mfma_f32_16x16x32_bf16 v[208:211], a[108:111], a[36:39], v[208:211]
 ds_read_b64_tr_b16 a[122:123], v16 offset:18368
 v_mfma_f32_16x16x32_bf16 v[212:215], a[108:111], a[44:47], v[212:215]
 ds_read_b64_tr_b16 a[124:125], v16 offset:23744
 v_mfma_f32_16x16x32_bf16 v[212:215], a[104:107], a[40:43], v[212:215]
 ds_read_b64_tr_b16 a[126:127], v16 offset:25536
 s_add_u32 m0, s39, 38912
 v_mfma_f32_16x16x32_bf16 v[216:219], a[104:107], a[48:51], v[216:219]
 buffer_load_dwordx4 v1, s[8:11], s37 offen lds
 v_mfma_f32_16x16x32_bf16 v[216:219], a[108:111], a[52:55], v[216:219]
 v_mfma_f32_16x16x32_bf16 v[220:223], a[108:111], a[60:63], v[220:223]
 v_mfma_f32_16x16x32_bf16 v[220:223], a[104:107], a[56:59], v[220:223]
 s_waitcnt vmcnt(15) lgkmcnt(0)
 s_barrier
 v_mfma_f32_16x16x32_bf16 v[236:239], a[112:115], a[56:59], v[236:239]
 ds_read_b64_tr_b16 a[96:97], v14 offset:0
 v_mfma_f32_16x16x32_bf16 v[236:239], a[116:119], a[60:63], v[236:239]
 ds_read_b64_tr_b16 a[98:99], v14 offset:256
 v_mfma_f32_16x16x32_bf16 v[232:235], a[116:119], a[52:55], v[232:235]
 ds_read_b64_tr_b16 a[100:101], v14 offset:2048
 v_mfma_f32_16x16x32_bf16 v[232:235], a[112:115], a[48:51], v[232:235]
 ds_read_b64_tr_b16 a[102:103], v14 offset:2304
 v_mfma_f32_16x16x32_bf16 v[228:231], a[112:115], a[40:43], v[228:231]
 ds_read_b128 a[64:67], v10 offset:0
 v_mfma_f32_16x16x32_bf16 v[228:231], a[116:119], a[44:47], v[228:231]
 ds_read_b128 a[68:71], v11 offset:0
 v_mfma_f32_16x16x32_bf16 v[224:227], a[116:119], a[36:39], v[224:227]
L_pg4:
 s_cbranch_execz L_pg8
 ds_read_b128 a[76:79], v11 offset:2048
 v_mfma_f32_16x16x32_bf16 v[224:227], a[112:115], a[32:35], v[224:227]
 ds_read_b128 a[72:75], v10 offset:2048
 v_mfma_f32_16x16x32_bf16 v[240:243], a[120:123], a[32:35], v[240:243]
 ds_read_b64_tr_b16 a[104:105], v15 offset:0
 v_mfma_f32_16x16x32_bf16 v[240:243], a[124:127], a[36:39], v[240:243]
 ds_read_b64_tr_b16 a[106:107], v15 offset:256
 v_mfma_f32_16x16x32_bf16 v[244:247], a[124:127], a[44:47], v[244:247]
 ds_read_b64_tr_b16 a[108:109], v15 offset:2048
 v_mfma_f32_16x16x32_bf16 v[244:247], a[120:123], a[40:43], v[244:247]
 ds_read_b64_tr_b16 a[110:111], v15 offset:2304
 v_mfma_f32_16x16x32_bf16 v[248:251], a[120:123], a[48:51], v[248:251]
 ds_read_b128 a[80:83], v10 offset:4096
 v_mfma_f32_16x16x32_bf16 v[248:251], a[124:127], a[52:55], v[248:251]
 ds_read_b128 a[84:87], v11 offset:4096
 v_mfma_f32_16x16x32_bf16 v[252:255], a[124:127], a[60:63], v[252:255]
 ds_read_b128 a[92:95], v11 offset:6144
 v_mfma_f32_16x16x32_bf16 v[252:255], a[120:123], a[56:59], v[252:255]
 ds_read_b128 a[88:91], v10 offset:6144
 s_waitcnt lgkmcnt(8)
 v_mfma_f32_16x16x32_bf16 v[48:51], a[96:99], a[64:67], v[48:51]
 ds_read_b64_tr_b16 a[112:113], v14 offset:4096
 v_mfma_f32_16x16x32_bf16 v[48:51], a[100:103], a[68:71], v[48:51]
 ds_read_b64_tr_b16 a[114:115], v14 offset:4352
 v_mfma_f32_16x16x32_bf16 v[52:55], a[100:103], a[76:79], v[52:55]
 ds_read_b64_tr_b16 a[116:117], v14 offset:6144
 s_cmp_eq_u32 s70, 8
 s_cbranch_scc1 L_cap8
L_capb8:
 v_mfma_f32_16x16x32_bf16 v[52:55], a[96:99], a[72:75], v[52:55]
 ds_read_b64_tr_b16 a[118:119], v14 offset:6400
 s_add_u32 m0, s39, 39936
 s_waitcnt lgkmcnt(4)
 v_mfma_f32_16x16x32_bf16 v[56:59], a[96:99], a[80:83], v[56:59]
 buffer_load_dwordx4 v2, s[8:11], s37 offen lds
 s_and_b32 s38, s34, 12
 v_mfma_f32_16x16x32_bf16 v[56:59], a[100:103], a[84:87], v[56:59]
 s_xor_b32 s38, s38, 10
 s_lshl_b32 s31, s38, 7
 s_mul_i32 s32, s38, 393216
 s_mul_i32 s33, s38, 458752
 s_add_u32 m0, s46, 90112
 v_mfma_f32_16x16x32_bf16 v[60:63], a[100:103], a[92:95], v[60:63]
 buffer_load_dwordx4 v3, s[12:15], s32 offen lds
 v_mfma_f32_16x16x32_bf16 v[60:63], a[96:99], a[88:91], v[60:63]
 s_cmp_eq_u32 s98, 3
 s_cselect_b32 s50, 256, 0
 v_mfma_f32_16x16x32_bf16 v[76:79], a[104:107], a[88:91], v[76:79]
 ds_read_b64_tr_b16 a[120:121], v15 offset:4096
 v_mfma_f32_16x16x32_bf16 v[76:79], a[108:111], a[92:95], v[76:79]
 ds_read_b64_tr_b16 a[122:123], v15 offset:4352
 v_mfma_f32_16x16x32_bf16 v[72:75], a[108:111], a[84:87], v[72:75]
 ds_read_b64_tr_b16 a[124:125], v15 offset:6144
 v_mfma_f32_16x16x32_bf16 v[72:75], a[104:107], a[80:83], v[72:75]
 ds_read_b64_tr_b16 a[126:127], v15 offset:6400
 s_add_u32 m0, s39, 0
 v_mfma_f32_16x16x32_bf16 v[68:71], a[104:107], a[72:75], v[68:71]
 buffer_load_dwordx4 v1, s[8:11], s31 offen lds
 v_mfma_f32_16x16x32_bf16 v[68:71], a[108:111], a[76:79], v[68:71]
 buffer_atomic_add v23, v24, s[48:51], 0 offen sc1
 v_mfma_f32_16x16x32_bf16 v[64:67], a[108:111], a[68:71], v[64:67]
 v_mfma_f32_16x16x32_bf16 v[64:67], a[104:107], a[64:67], v[64:67]
 s_waitcnt lgkmcnt(4)
 v_mfma_f32_16x16x32_bf16 v[80:83], a[112:115], a[64:67], v[80:83]
 ds_read_b64_tr_b16 a[96:97], v14 offset:8192
 v_mfma_f32_16x16x32_bf16 v[80:83], a[116:119], a[68:71], v[80:83]
 ds_read_b64_tr_b16 a[98:99], v14 offset:8448
 v_mfma_f32_16x16x32_bf16 v[84:87], a[116:119], a[76:79], v[84:87]
 ds_read_b64_tr_b16 a[100:101], v14 offset:10240
 v_mfma_f32_16x16x32_bf16 v[84:87], a[112:115], a[72:75], v[84:87]
 ds_read_b64_tr_b16 a[102:103], v14 offset:10496
 s_add_u32 m0, s47, 118784
 v_mfma_f32_16x16x32_bf16 v[88:91], a[112:115], a[80:83], v[88:91]
 buffer_load_dwordx4 v6, s[16:19], s33 offen lds
 v_mfma_f32_16x16x32_bf16 v[88:91], a[116:119], a[84:87], v[88:91]
 s_add_u32 m0, s39, 1024
 v_mfma_f32_16x16x32_bf16 v[92:95], a[116:119], a[92:95], v[92:95]
 buffer_load_dwordx4 v2, s[8:11], s31 offen lds
 v_mfma_f32_16x16x32_bf16 v[92:95], a[112:115], a[88:91], v[92:95]
 s_waitcnt lgkmcnt(4)
 v_mfma_f32_16x16x32_bf16 v[108:111], a[120:123], a[88:91], v[108:111]
 ds_read_b64_tr_b16 a[104:105], v15 offset:8192
 v_mfma_f32_16x16x32_bf16 v[108:111], a[124:127], a[92:95], v[108:111]
 ds_read_b64_tr_b16 a[106:107], v15 offset:8448
 v_mfma_f32_16x16x32_bf16 v[104:107], a[124:127], a[84:87], v[104:107]
 ds_read_b64_tr_b16 a[108:109], v15 offset:10240
 v_mfma_f32_16x16x32_bf16 v[104:107], a[120:123], a[80:83], v[104:107]
 ds_read_b64_tr_b16 a[110:111], v15 offset:10496
 s_add_u32 m0, s47, 119808
 v_mfma_f32_16x16x32_bf16 v[100:103], a[120:123], a[72:75], v[100:103]
 buffer_load_dwordx4 v7, s[16:19], s33 offen lds
 s_add_u32 s37, s31, 32768
 v_mfma_f32_16x16x32_bf16 v[100:103], a[124:127], a[76:79], v[100:103]
 v_mfma_f32_16x16x32_bf16 v[96:99], a[124:127], a[68:71], v[96:99]
 v_mfma_f32_16x16x32_bf16 v[96:99], a[120:123], a[64:67], v[96:99]
 s_waitcnt lgkmcnt(4)
 v_mfma_f32_16x16x32_bf16 v[112:115], a[64:67], a[96:99], v[112:115]
 ds_read_b64_tr_b16 a[112:113], v16 offset:32768
 v_mfma_f32_16x16x32_bf16 v[112:115], a[68:71], a[100:103], v[112:115]
 ds_read_b64_tr_b16 a[114:115], v16 offset:34560
 v_mfma_f32_16x16x32_bf16 v[116:119], a[76:79], a[100:103], v[116:119]
 ds_read_b64_tr_b16 a[116:117], v16 offset:39936
 v_mfma_f32_16x16x32_bf16 v[116:119], a[72:75], a[96:99], v[116:119]
 ds_read_b64_tr_b16 a[118:119], v16 offset:41728
 s_add_u32 m0, s39, 2048
 v_mfma_f32_16x16x32_bf16 v[120:123], a[80:83], a[96:99], v[120:123]
 buffer_load_dwordx4 v1, s[8:11], s37 offen lds
 v_mfma_f32_16x16x32_bf16 v[120:123], a[84:87], a[100:103], v[120:123]
 s_add_u32 m0, s46, 94208
 v_mfma_f32_16x16x32_bf16 v[124:127], a[92:95], a[100:103], v[124:127]
 buffer_load_dwordx4 v4, s[12:15], s32 offen lds
 v_mfma_f32_16x16x32_bf16 v[124:127], a[88:91], a[96:99], v[124:127]
 s_waitcnt lgkmcnt(4)
 v_mfma_f32_16x16x32_bf16 v[140:143], a[88:91], a[104:107], v[140:143]
 ds_read_b64_tr_b16 a[120:121], v16 offset:32800
 v_mfma_f32_16x16x32_bf16 v[140:143], a[92:95], a[108:111], v[140:143]
 ds_read_b64_tr_b16 a[122:123], v16 offset:34592
 v_mfma_f32_16x16x32_bf16 v[136:139], a[84:87], a[108:111], v[136:139]
 ds_read_b64_tr_b16 a[124:125], v16 offset:39968
 v_mfma_f32_16x16x32_bf16 v[136:139], a[80:83], a[104:107], v[136:139]
 ds_read_b64_tr_b16 a[126:127], v16 offset:41760
 v_mfma_f32_16x16x32_bf16 v[132:135], a[72:75], a[104:107], v[132:135]
 v_mfma_f32_16x16x32_bf16 v[132:135], a[76:79], a[108:111], v[132:135]
 s_add_u32 m0, s39, 3072
 v_mfma_f32_16x16x32_bf16 v[128:131], a[68:71], a[108:111], v[128:131]
 buffer_load_dwordx4 v2, s[8:11], s37 offen lds
 v_mfma_f32_16x16x32_bf16 v[128:131], a[64:67], a[104:107], v[128:131]
 s_waitcnt lgkmcnt(4)
 v_mfma_f32_16x16x32_bf16 v[144:147], a[112:115], a[64:67], v[144:147]
 ds_read_b64_tr_b16 a[96:97], v16 offset:32832
 v_mfma_f32_16x16x32_bf16 v[144:147], a[116:119], a[68:71], v[144:147]
 ds_read_b64_tr_b16 a[98:99], v16 offset:34624
 v_mfma_f32_16x16x32_bf16 v[148:151], a[116:119], a[76:79], v[148:151]
 ds_read_b64_tr_b16 a[100:101], v16 offset:40000
 v_mfma_f32_16x16x32_bf16 v[148:151], a[112:115], a[72:75], v[148:151]
 ds_read_b64_tr_b16 a[102:103], v16 offset:41792
 s_add_u32 m0, s47, 120832
 v_mfma_f32_16x16x32_bf16 v[152:155], a[112:115], a[80:83], v[152:155]
 buffer_load_dwordx4 v8, s[24:27], s33 offen lds
 s_add_u32 s37, s31, 65536
 v_mfma_f32_16x16x32_bf16 v[152:155], a[116:119], a[84:87], v[152:155]
 s_add_u32 m0, s39, 4096
 v_mfma_f32_16x16x32_bf16 v[156:159], a[116:119], a[92:95], v[156:159]
 buffer_load_dwordx4 v1, s[8:11], s37 offen lds
 v_mfma_f32_16x16x32_bf16 v[156:159], a[112:115], a[88:91], v[156:159]
 s_waitcnt lgkmcnt(4)
 v_mfma_f32_16x16x32_bf16 v[172:175], a[120:123], a[88:91], v[172:175]
 ds_read_b64_tr_b16 a[104:105], v16 offset:32864
 v_mfma_f32_16x16x32_bf16 v[172:175], a[124:127], a[92:95], v[172:175]
 ds_read_b64_tr_b16 a[106:107], v16 offset:34656
 v_mfma_f32_16x16x32_bf16 v[168:171], a[124:127], a[84:87], v[168:171]
 ds_read_b64_tr_b16 a[108:109], v16 offset:40032
 v_mfma_f32_16x16x32_bf16 v[168:171], a[120:123], a[80:83], v[168:171]
 ds_read_b64_tr_b16 a[110:111], v16 offset:41824
 v_mfma_f32_16x16x32_bf16 v[164:167], a[120:123], a[72:75], v[164:167]
 v_mfma_f32_16x16x32_bf16 v[164:167], a[124:127], a[76:79], v[164:167]
 s_add_u32 m0, s47, 121856
 v_mfma_f32_16x16x32_bf16 v[160:163], a[124:127], a[68:71], v[160:163]
 buffer_load_dwordx4 v9, s[24:27], s33 offen lds
 v_mfma_f32_16x16x32_bf16 v[160:163], a[120:123], a[64:67], v[160:163]
 s_waitcnt lgkmcnt(4)
 v_mfma_f32_16x16x32_bf16 v[176:179], a[96:99], a[64:67], v[176:179]
 ds_read_b64_tr_b16 a[112:113], v16 offset:32896
 v_mfma_f32_16x16x32_bf16 v[176:179], a[100:103], a[68:71], v[176:179]
 ds_read_b64_tr_b16 a[114:115], v16 offset:34688
 v_mfma_f32_16x16x32_bf16 v[180:183], a[100:103], a[76:79], v[180:183]
 ds_read_b64_tr_b16 a[116:117], v16 offset:40064
 v_mfma_f32_16x16x32_bf16 v[180:183], a[96:99], a[72:75], v[180:183]
 ds_read_b64_tr_b16 a[118:119], v16 offset:41856
 s_add_u32 m0, s39, 5120
 v_mfma_f32_16x16x32_bf16 v[184:187], a[96:99], a[80:83], v[184:187]
 buffer_load_dwordx4 v2, s[8:11], s37 offen lds
 v_mfma_f32_16x16x32_bf16 v[184:187], a[100:103], a[84:87], v[184:187]
 s_add_u32 m0, s46, 98304
 v_mfma_f32_16x16x32_bf16 v[188:191], a[100:103], a[92:95], v[188:191]
 buffer_load_dwordx4 v5, s[12:15], s32 offen lds
 s_add_u32 s37, s31, 98304
 v_mfma_f32_16x16x32_bf16 v[188:191], a[96:99], a[88:91], v[188:191]
 s_waitcnt lgkmcnt(4)
 v_mfma_f32_16x16x32_bf16 v[204:207], a[104:107], a[88:91], v[204:207]
 ds_read_b64_tr_b16 a[120:121], v16 offset:32928
 v_mfma_f32_16x16x32_bf16 v[204:207], a[108:111], a[92:95], v[204:207]
 ds_read_b64_tr_b16 a[122:123], v16 offset:34720
 v_mfma_f32_16x16x32_bf16 v[200:203], a[108:111], a[84:87], v[200:203]
 ds_read_b64_tr_b16 a[124:125], v16 offset:40096
 v_mfma_f32_16x16x32_bf16 v[200:203], a[104:107], a[80:83], v[200:203]
 ds_read_b64_tr_b16 a[126:127], v16 offset:41888
 v_mfma_f32_16x16x32_bf16 v[196:199], a[104:107], a[72:75], v[196:199]
 v_mfma_f32_16x16x32_bf16 v[196:199], a[108:111], a[76:79], v[196:199]
 s_add_u32 m0, s39, 6144
 v_mfma_f32_16x16x32_bf16 v[192:195], a[108:111], a[68:71], v[192:195]
 buffer_load_dwordx4 v1, s[8:11], s37 offen lds
 v_mfma_f32_16x16x32_bf16 v[192:195], a[104:107], a[64:67], v[192:195]
 s_waitcnt lgkmcnt(4)
 v_mfma_f32_16x16x32_bf16 v[208:211], a[112:115], a[64:67], v[208:211]
 ds_read_b64_tr_b16 a[96:97], v16 offset:32960
 v_mfma_f32_16x16x32_bf16 v[208:211], a[116:119], a[68:71], v[208:211]
 ds_read_b64_tr_b16 a[98:99], v16 offset:34752
 v_mfma_f32_16x16x32_bf16 v[212:215], a[116:119], a[76:79], v[212:215]
 ds_read_b64_tr_b16 a[100:101], v16 offset:40128
 v_mfma_f32_16x16x32_bf16 v[212:215], a[112:115], a[72:75], v[212:215]
 ds_read_b64_tr_b16 a[102:103], v16 offset:41920
 s_add_u32 m0, s39, 7168
 v_mfma_f32_16x16x32_bf16 v[216:219], a[112:115], a[80:83], v[216:219]
 buffer_load_dwordx4 v2, s[8:11], s37 offen lds
 s_and_b32 s38, s34, 12
 v_mfma_f32_16x16x32_bf16 v[216:219], a[116:119], a[84:87], v[216:219]
 s_xor_b32 s38, s38, 11
 s_lshl_b32 s31, s38, 7
 s_mul_i32 s32, s38, 393216
 v_mfma_f32_16x16x32_bf16 v[220:223], a[116:119], a[92:95], v[220:223]
 s_mul_i32 s33, s38, 458752
 v_mfma_f32_16x16x32_bf16 v[220:223], a[112:115], a[88:91], v[220:223]
 s_waitcnt vmcnt(16) lgkmcnt(0)
 s_barrier
 v_mfma_f32_16x16x32_bf16 v[236:239], a[120:123], a[88:91], v[236:239]
 ds_read_b64_tr_b16 a[104:105], v14 offset:12288
 v_mfma_f32_16x16x32_bf16 v[236:239], a[124:127], a[92:95], v[236:239]
 ds_read_b64_tr_b16 a[106:107], v14 offset:12544
 v_mfma_f32_16x16x32_bf16 v[232:235], a[124:127], a[84:87], v[232:235]
 ds_read_b64_tr_b16 a[108:109], v14 offset:14336
 v_mfma_f32_16x16x32_bf16 v[232:235], a[120:123], a[80:83], v[232:235]
 ds_read_b64_tr_b16 a[110:111], v14 offset:14592
 v_mfma_f32_16x16x32_bf16 v[228:231], a[120:123], a[72:75], v[228:231]
 ds_read_b128 a[0:3], v10 offset:32768
 v_mfma_f32_16x16x32_bf16 v[228:231], a[124:127], a[76:79], v[228:231]
 ds_read_b128 a[4:7], v11 offset:32768
 v_mfma_f32_16x16x32_bf16 v[224:227], a[124:127], a[68:71], v[224:227]
 ds_read_b128 a[12:15], v11 offset:34816
 v_mfma_f32_16x16x32_bf16 v[224:227], a[120:123], a[64:67], v[224:227]
 ds_read_b128 a[8:11], v10 offset:34816
 v_mfma_f32_16x16x32_bf16 v[240:243], a[96:99], a[64:67], v[240:243]
 ds_read_b64_tr_b16 a[112:113], v15 offset:12288
 v_mfma_f32_16x16x32_bf16 v[240:243], a[100:103], a[68:71], v[240:243]
 ds_read_b64_tr_b16 a[114:115], v15 offset:12544
 v_mfma_f32_16x16x32_bf16 v[244:247], a[100:103], a[76:79], v[244:247]
 ds_read_b64_tr_b16 a[116:117], v15 offset:14336
 v_mfma_f32_16x16x32_bf16 v[244:247], a[96:99], a[72:75], v[244:247]
 ds_read_b64_tr_b16 a[118:119], v15 offset:14592
 v_mfma_f32_16x16x32_bf16 v[248:251], a[96:99], a[80:83], v[248:251]
 ds_read_b128 a[16:19], v10 offset:36864
 v_mfma_f32_16x16x32_bf16 v[248:251], a[100:103], a[84:87], v[248:251]
 ds_read_b128 a[20:23], v11 offset:36864
 v_mfma_f32_16x16x32_bf16 v[252:255], a[100:103], a[92:95], v[252:255]
 ds_read_b128 a[28:31], v11 offset:38912
 v_mfma_f32_16x16x32_bf16 v[252:255], a[96:99], a[88:91], v[252:255]
 ds_read_b128 a[24:27], v10 offset:38912
 s_waitcnt lgkmcnt(8)
 v_mfma_f32_16x16x32_bf16 v[48:51], a[104:107], a[0:3], v[48:51]
 ds_read_b64_tr_b16 a[120:121], v14 offset:16384
 v_mfma_f32_16x16x32_bf16 v[48:51], a[108:111], a[4:7], v[48:51]
 ds_read_b64_tr_b16 a[122:123], v14 offset:16640
 v_mfma_f32_16x16x32_bf16 v[52:55], a[108:111], a[12:15], v[52:55]
 ds_read_b64_tr_b16 a[124:125], v14 offset:18432
 s_cmp_eq_u32 s70, 9
 s_cbranch_scc1 L_cap9
L_capb9:
 v_mfma_f32_16x16x32_bf16 v[52:55], a[104:107], a[8:11], v[52:55]
 ds_read_b64_tr_b16 a[126:127], v14 offset:18688
 s_add_u32 m0, s46, 65536
 s_waitcnt lgkmcnt(4)
 v_mfma_f32_16x16x32_bf16 v[56:59], a[104:107], a[16:19], v[56:59]
 buffer_load_dwordx4 v3, s[12:15], s32 offen lds
 v_mfma_f32_16x16x32_bf16 v[56:59], a[108:111], a[20:23], v[56:59]
 s_add_u32 m0, s39, 32768
 v_mfma_f32_16x16x32_bf16 v[60:63], a[108:111], a[28:31], v[60:63]
 buffer_load_dwordx4 v1, s[8:11], s31 offen lds
 v_mfma_f32_16x16x32_bf16 v[60:63], a[104:107], a[24:27], v[60:63]
 v_mfma_f32_16x16x32_bf16 v[76:79], a[112:115], a[24:27], v[76:79]
 ds_read_b64_tr_b16 a[96:97], v15 offset:16384
 v_mfma_f32_16x16x32_bf16 v[76:79], a[116:119], a[28:31], v[76:79]
 ds_read_b64_tr_b16 a[98:99], v15 offset:16640
 v_mfma_f32_16x16x32_bf16 v[72:75], a[116:119], a[20:23], v[72:75]
 ds_read_b64_tr_b16 a[100:101], v15 offset:18432
 v_mfma_f32_16x16x32_bf16 v[72:75], a[112:115], a[16:19], v[72:75]
 ds_read_b64_tr_b16 a[102:103], v15 offset:18688
 s_add_u32 m0, s47, 135168
 v_mfma_f32_16x16x32_bf16 v[68:71], a[112:115], a[8:11], v[68:71]
 buffer_load_dwordx4 v6, s[16:19], s33 offen lds
 v_mfma_f32_16x16x32_bf16 v[68:71], a[116:119], a[12:15], v[68:71]
 v_mfma_f32_16x16x32_bf16 v[64:67], a[116:119], a[4:7], v[64:67]
 v_mfma_f32_16x16x32_bf16 v[64:67], a[112:115], a[0:3], v[64:67]
 s_waitcnt lgkmcnt(4)
 v_mfma_f32_16x16x32_bf16 v[80:83], a[120:123], a[0:3], v[80:83]
 ds_read_b64_tr_b16 a[104:105], v14 offset:20480
 v_mfma_f32_16x16x32_bf16 v[80:83], a[124:127], a[4:7], v[80:83]
 ds_read_b64_tr_b16 a[106:107], v14 offset:20736
 v_mfma_f32_16x16x32_bf16 v[84:87], a[124:127], a[12:15], v[84:87]
 ds_read_b64_tr_b16 a[108:109], v14 offset:22528
 v_mfma_f32_16x16x32_bf16 v[84:87], a[120:123], a[8:11], v[84:87]
 ds_read_b64_tr_b16 a[110:111], v14 offset:22784
 s_add_u32 m0, s39, 33792
 v_mfma_f32_16x16x32_bf16 v[88:91], a[120:123], a[16:19], v[88:91]
 buffer_load_dwordx4 v2, s[8:11], s31 offen lds
 v_mfma_f32_16x16x32_bf16 v[88:91], a[124:127], a[20:23], v[88:91]
 s_add_u32 m0, s47, 136192
 v_mfma_f32_16x16x32_bf16 v[92:95], a[124:127], a[28:31], v[92:95]
 buffer_load_dwordx4 v7, s[16:19], s33 offen lds
 s_add_u32 s37, s31, 32768
 v_mfma_f32_16x16x32_bf16 v[92:95], a[120:123], a[24:27], v[92:95]
 s_waitcnt lgkmcnt(4)
 v_mfma_f32_16x16x32_bf16 v[108:111], a[96:99], a[24:27], v[108:111]
 ds_read_b64_tr_b16 a[112:113], v15 offset:20480
 v_mfma_f32_16x16x32_bf16 v[108:111], a[100:103], a[28:31], v[108:111]
 ds_read_b64_tr_b16 a[114:115], v15 offset:20736
 v_mfma_f32_16x16x32_bf16 v[104:107], a[100:103], a[20:23], v[104:107]
 ds_read_b64_tr_b16 a[116:117], v15 offset:22528
 v_mfma_f32_16x16x32_bf16 v[104:107], a[96:99], a[16:19], v[104:107]
 ds_read_b64_tr_b16 a[118:119], v15 offset:22784
 v_mfma_f32_16x16x32_bf16 v[100:103], a[96:99], a[8:11], v[100:103]
 v_mfma_f32_16x16x32_bf16 v[100:103], a[100:103], a[12:15], v[100:103]
 s_add_u32 m0, s39, 34816
 v_mfma_f32_16x16x32_bf16 v[96:99], a[100:103], a[4:7], v[96:99]
 buffer_load_dwordx4 v1, s[8:11], s37 offen lds
 v_mfma_f32_16x16x32_bf16 v[96:99], a[96:99], a[0:3], v[96:99]
 s_waitcnt lgkmcnt(4)
 v_mfma_f32_16x16x32_bf16 v[112:115], a[0:3], a[104:107], v[112:115]
 ds_read_b64_tr_b16 a[120:121], v16 offset:0
 v_mfma_f32_16x16x32_bf16 v[112:115], a[4:7], a[108:111], v[112:115]
 ds_read_b64_tr_b16 a[122:123], v16 offset:1792
 v_mfma_f32_16x16x32_bf16 v[116:119], a[12:15], a[108:111], v[116:119]
 ds_read_b64_tr_b16 a[124:125], v16 offset:7168
 v_mfma_f32_16x16x32_bf16 v[116:119], a[8:11], a[104:107], v[116:119]
 ds_read_b64_tr_b16 a[126:127], v16 offset:8960
 s_add_u32 m0, s46, 69632
 v_mfma_f32_16x16x32_bf16 v[120:123], a[16:19], a[104:107], v[120:123]
 buffer_load_dwordx4 v4, s[12:15], s32 offen lds
 v_mfma_f32_16x16x32_bf16 v[120:123], a[20:23], a[108:111], v[120:123]
 v_mfma_f32_16x16x32_bf16 v[124:127], a[28:31], a[108:111], v[124:127]
 v_mfma_f32_16x16x32_bf16 v[124:127], a[24:27], a[104:107], v[124:127]
 s_waitcnt lgkmcnt(4)
 v_mfma_f32_16x16x32_bf16 v[140:143], a[24:27], a[112:115], v[140:143]
 ds_read_b64_tr_b16 a[96:97], v16 offset:32
 v_mfma_f32_16x16x32_bf16 v[140:143], a[28:31], a[116:119], v[140:143]
 ds_read_b64_tr_b16 a[98:99], v16 offset:1824
 v_mfma_f32_16x16x32_bf16 v[136:139], a[20:23], a[116:119], v[136:139]
 ds_read_b64_tr_b16 a[100:101], v16 offset:7200
 v_mfma_f32_16x16x32_bf16 v[136:139], a[16:19], a[112:115], v[136:139]
 ds_read_b64_tr_b16 a[102:103], v16 offset:8992
 s_add_u32 m0, s39, 35840
 v_mfma_f32_16x16x32_bf16 v[132:135], a[8:11], a[112:115], v[132:135]
 buffer_load_dwordx4 v2, s[8:11], s37 offen lds
 v_mfma_f32_16x16x32_bf16 v[132:135], a[12:15], a[116:119], v[132:135]
 s_add_u32 m0, s47, 137216
 v_mfma_f32_16x16x32_bf16 v[128:131], a[4:7], a[116:119], v[128:131]
 buffer_load_dwordx4 v8, s[24:27], s33 offen lds
 s_add_u32 s37, s31, 65536
 v_mfma_f32_16x16x32_bf16 v[128:131], a[0:3], a[112:115], v[128:131]
 s_waitcnt lgkmcnt(4)
 v_mfma_f32_16x16x32_bf16 v[144:147], a[120:123], a[0:3], v[144:147]
 ds_read_b64_tr_b16 a[104:105], v16 offset:64
 v_mfma_f32_16x16x32_bf16 v[144:147], a[124:127], a[4:7], v[144:147]
 ds_read_b64_tr_b16 a[106:107], v16 offset:1856
 v_mfma_f32_16x16x32_bf16 v[148:151], a[124:127], a[12:15], v[148:151]
 ds_read_b64_tr_b16 a[108:109], v16 offset:7232
 v_mfma_f32_16x16x32_bf16 v[148:151], a[120:123], a[8:11], v[148:151]
 ds_read_b64_tr_b16 a[110:111], v16 offset:9024
 v_mfma_f32_16x16x32_bf16 v[152:155], a[120:123], a[16:19], v[152:155]
 v_mfma_f32_16x16x32_bf16 v[152:155], a[124:127], a[20:23], v[152:155]
 s_add_u32 m0, s39, 36864
 v_mfma_f32_16x16x32_bf16 v[156:159], a[124:127], a[28:31], v[156:159]
 buffer_load_dwordx4 v1, s[8:11], s37 offen lds
 v_mfma_f32_16x16x32_bf16 v[156:159], a[120:123], a[24:27], v[156:159]
 s_waitcnt lgkmcnt(4)
 v_mfma_f32_16x16x32_bf16 v[172:175], a[96:99], a[24:27], v[172:175]
 ds_read_b64_tr_b16 a[112:113], v16 offset:96
 v_mfma_f32_16x16x32_bf16 v[172:175], a[100:103], a[28:31], v[172:175]
 ds_read_b64_tr_b16 a[114:115], v16 offset:1888
 v_mfma_f32_16x16x32_bf16 v[168:171], a[100:103], a[20:23], v[168:171]
 ds_read_b64_tr_b16 a[116:117], v16 offset:7264
 v_mfma_f32_16x16x32_bf16 v[168:171], a[96:99], a[16:19], v[168:171]
 ds_read_b64_tr_b16 a[118:119], v16 offset:9056
 s_add_u32 m0, s47, 138240
 v_mfma_f32_16x16x32_bf16 v[164:167], a[96:99], a[8:11], v[164:167]
 buffer_load_dwordx4 v9, s[24:27], s33 offen lds
 v_mfma_f32_16x16x32_bf16 v[164:167], a[100:103], a[12:15], v[164:167]
 v_mfma_f32_16x16x32_bf16 v[160:163], a[100:103], a[4:7], v[160:163]
 v_mfma_f32_16x16x32_bf16 v[160:163], a[96:99], a[0:3], v[160:163]
 s_waitcnt lgkmcnt(4)
 v_mfma_f32_16x16x32_bf16 v[176:179], a[104:107], a[0:3], v[176:179]
 ds_read_b64_tr_b16 a[120:121], v16 offset:128
 v_mfma_f32_16x16x32_bf16 v[176:179], a[108:111], a[4:7], v[176:179]
 ds_read_b64_tr_b16 a[122:123], v16 offset:1920
 v_mfma_f32_16x16x32_bf16 v[180:183], a[108:111], a[12:15], v[180:183]
 ds_read_b64_tr_b16 a[124:125], v16 offset:7296
 v_mfma_f32_16x16x32_bf16 v[180:183], a[104:107], a[8:11], v[180:183]
 ds_read_b64_tr_b16 a[126:127], v16 offset:9088
 s_add_u32 m0, s39, 37888
 v_mfma_f32_16x16x32_bf16 v[184:187], a[104:107], a[16:19], v[184:187]
 buffer_load_dwordx4 v2, s[8:11], s37 offen lds
 v_mfma_f32_16x16x32_bf16 v[184:187], a[108:111], a[20:23], v[184:187]
 s_add_u32 m0, s46, 73728
 v_mfma_f32_16x16x32_bf16 v[188:191], a[108:111], a[28:31], v[188:191]
 buffer_load_dwordx4 v5, s[12:15], s32 offen lds
 s_add_u32 s37, s31, 98304
 v_mfma_f32_16x16x32_bf16 v[188:191], a[104:107], a[24:27], v[188:191]
 s_waitcnt lgkmcnt(4)
 v_mfma_f32_16x16x32_bf16 v[204:207], a[112:115], a[24:27], v[204:207]
 ds_read_b64_tr_b16 a[96:97], v16 offset:160
 v_mfma_f32_16x16x32_bf16 v[204:207], a[116:119], a[28:31], v[204:207]
 ds_read_b64_tr_b16 a[98:99], v16 offset:1952
 v_mfma_f32_16x16x32_bf16 v[200:203], a[116:119], a[20:23], v[200:203]
 ds_read_b64_tr_b16 a[100:101], v16 offset:7328
 v_mfma_f32_16x16x32_bf16 v[200:203], a[112:115], a[16:19], v[200:203]
 ds_read_b64_tr_b16 a[102:103], v16 offset:9120
 v_mfma_f32_16x16x32_bf16 v[196:199], a[112:115], a[8:11], v[196:199]
 global_load_dword a252, v[44:45], off
 v_mfma_f32_16x16x32_bf16 v[196:199], a[116:119], a[12:15], v[196:199]
 s_add_u32 m0, s39, 38912
 v_mfma_f32_16x16x32_bf16 v[192:195], a[116:119], a[4:7], v[192:195]
 buffer_load_dwordx4 v1, s[8:11], s37 offen lds
 v_mfma_f32_16x16x32_bf16 v[192:195], a[112:115], a[0:3], v[192:195]
 s_waitcnt lgkmcnt(4)
 v_mfma_f32_16x16x32_bf16 v[208:211], a[120:123], a[0:3], v[208:211]
 ds_read_b64_tr_b16 a[104:105], v16 offset:192
 v_mfma_f32_16x16x32_bf16 v[208:211], a[124:127], a[4:7], v[208:211]
 ds_read_b64_tr_b16 a[106:107], v16 offset:1984
 v_mfma_f32_16x16x32_bf16 v[212:215], a[124:127], a[12:15], v[212:215]
 ds_read_b64_tr_b16 a[108:109], v16 offset:7360
 v_mfma_f32_16x16x32_bf16 v[212:215], a[120:123], a[8:11], v[212:215]
 ds_read_b64_tr_b16 a[110:111], v16 offset:9152
 s_add_u32 m0, s39, 39936
 v_mfma_f32_16x16x32_bf16 v[216:219], a[120:123], a[16:19], v[216:219]
 buffer_load_dwordx4 v2, s[8:11], s37 offen lds
 s_and_b32 s38, s34, 12
 v_mfma_f32_16x16x32_bf16 v[216:219], a[124:127], a[20:23], v[216:219]
 s_xor_b32 s38, s38, 12
 s_lshl_b32 s31, s38, 7
 s_mul_i32 s32, s38, 393216
 v_mfma_f32_16x16x32_bf16 v[220:223], a[124:127], a[28:31], v[220:223]
 s_mul_i32 s33, s38, 458752
 v_mfma_f32_16x16x32_bf16 v[220:223], a[120:123], a[24:27], v[220:223]
 s_waitcnt vmcnt(16) lgkmcnt(0)
 s_barrier
 v_mfma_f32_16x16x32_bf16 v[236:239], a[96:99], a[24:27], v[236:239]
 ds_read_b64_tr_b16 a[112:113], v14 offset:24576
 v_mfma_f32_16x16x32_bf16 v[236:239], a[100:103], a[28:31], v[236:239]
 ds_read_b64_tr_b16 a[114:115], v14 offset:24832
 v_mfma_f32_16x16x32_bf16 v[232:235], a[100:103], a[20:23], v[232:235]
 ds_read_b64_tr_b16 a[116:117], v14 offset:26624
 v_mfma_f32_16x16x32_bf16 v[232:235], a[96:99], a[16:19], v[232:235]
 ds_read_b64_tr_b16 a[118:119], v14 offset:26880
 v_mfma_f32_16x16x32_bf16 v[228:231], a[96:99], a[8:11], v[228:231]
 ds_read_b128 a[32:35], v10 offset:0
 v_mfma_f32_16x16x32_bf16 v[228:231], a[100:103], a[12:15], v[228:231]
 ds_read_b128 a[36:39], v11 offset:0
 v_mfma_f32_16x16x32_bf16 v[224:227], a[100:103], a[4:7], v[224:227]
 ds_read_b128 a[44:47], v11 offset:2048
 v_mfma_f32_16x16x32_bf16 v[224:227], a[96:99], a[0:3], v[224:227]
 ds_read_b128 a[40:43], v10 offset:2048
 v_mfma_f32_16x16x32_bf16 v[240:243], a[104:107], a[0:3], v[240:243]
 ds_read_b64_tr_b16 a[120:121], v15 offset:24576
 v_mfma_f32_16x16x32_bf16 v[240:243], a[108:111], a[4:7], v[240:243]
 ds_read_b64_tr_b16 a[122:123], v15 offset:24832
 v_mfma_f32_16x16x32_bf16 v[244:247], a[108:111], a[12:15], v[244:247]
 ds_read_b64_tr_b16 a[124:125], v15 offset:26624
 v_mfma_f32_16x16x32_bf16 v[244:247], a[104:107], a[8:11], v[244:247]
 ds_read_b64_tr_b16 a[126:127], v15 offset:26880
 v_mfma_f32_16x16x32_bf16 v[248:251], a[104:107], a[16:19], v[248:251]
 ds_read_b128 a[48:51], v10 offset:4096
 v_mfma_f32_16x16x32_bf16 v[248:251], a[108:111], a[20:23], v[248:251]
 ds_read_b128 a[52:55], v11 offset:4096
 v_mfma_f32_16x16x32_bf16 v[252:255], a[108:111], a[28:31], v[252:255]
 ds_read_b128 a[60:63], v11 offset:6144
 v_mfma_f32_16x16x32_bf16 v[252:255], a[104:107], a[24:27], v[252:255]
 ds_read_b128 a[56:59], v10 offset:6144
 s_waitcnt lgkmcnt(8)
 v_mfma_f32_16x16x32_bf16 v[48:51], a[112:115], a[32:35], v[48:51]
 ds_read_b64_tr_b16 a[96:97], v14 offset:28672
 v_mfma_f32_16x16x32_bf16 v[48:51], a[116:119], a[36:39], v[48:51]
 ds_read_b64_tr_b16 a[98:99], v14 offset:28928
 v_mfma_f32_16x16x32_bf16 v[52:55], a[116:119], a[44:47], v[52:55]
 ds_read_b64_tr_b16 a[100:101], v14 offset:30720
 s_cmp_eq_u32 s70, 10
 s_cbranch_scc1 L_cap10
L_capb10:
 v_mfma_f32_16x16x32_bf16 v[52:55], a[112:115], a[40:43], v[52:55]
 ds_read_b64_tr_b16 a[102:103], v14 offset:30976
 s_add_u32 m0, s46, 77824
 s_waitcnt lgkmcnt(4)
 v_mfma_f32_16x16x32_bf16 v[56:59], a[112:115], a[48:51], v[56:59]
 buffer_load_dwordx4 v3, s[12:15], s32 offen lds
 v_mfma_f32_16x16x32_bf16 v[56:59], a[116:119], a[52:55], v[56:59]
 s_add_u32 m0, s39, 0
 v_mfma_f32_16x16x32_bf16 v[60:63], a[116:119], a[60:63], v[60:63]
 buffer_load_dwordx4 v1, s[8:11], s31 offen lds
 v_mfma_f32_16x16x32_bf16 v[60:63], a[112:115], a[56:59], v[60:63]
 v_mfma_f32_16x16x32_bf16 v[76:79], a[120:123], a[56:59], v[76:79]
 ds_read_b64_tr_b16 a[104:105], v15 offset:28672
 v_mfma_f32_16x16x32_bf16 v[76:79], a[124:127], a[60:63], v[76:79]
 ds_read_b64_tr_b16 a[106:107], v15 offset:28928
 v_mfma_f32_16x16x32_bf16 v[72:75], a[124:127], a[52:55], v[72:75]
 ds_read_b64_tr_b16 a[108:109], v15 offset:30720
 v_mfma_f32_16x16x32_bf16 v[72:75], a[120:123], a[48:51], v[72:75]
 ds_read_b64_tr_b16 a[110:111], v15 offset:30976
 s_add_u32 m0, s47, 102400
 v_mfma_f32_16x16x32_bf16 v[68:71], a[120:123], a[40:43], v[68:71]
 buffer_load_dwordx4 v6, s[16:19], s33 offen lds
 v_mfma_f32_16x16x32_bf16 v[68:71], a[124:127], a[44:47], v[68:71]
 v_mfma_f32_16x16x32_bf16 v[64:67], a[124:127], a[36:39], v[64:67]
 v_mfma_f32_16x16x32_bf16 v[64:67], a[120:123], a[32:35], v[64:67]
 s_waitcnt lgkmcnt(4)
 v_mfma_f32_16x16x32_bf16 v[80:83], a[96:99], a[32:35], v[80:83]
 ds_read_b64_tr_b16 a[112:113], v14 offset:32768
 v_mfma_f32_16x16x32_bf16 v[80:83], a[100:103], a[36:39], v[80:83]
 ds_read_b64_tr_b16 a[114:115], v14 offset:33024
 v_mfma_f32_16x16x32_bf16 v[84:87], a[100:103], a[44:47], v[84:87]
 ds_read_b64_tr_b16 a[116:117], v14 offset:34816
 v_mfma_f32_16x16x32_bf16 v[84:87], a[96:99], a[40:43], v[84:87]
 ds_read_b64_tr_b16 a[118:119], v14 offset:35072
 s_add_u32 m0, s39, 1024
 v_mfma_f32_16x16x32_bf16 v[88:91], a[96:99], a[48:51], v[88:91]
 buffer_load_dwordx4 v2, s[8:11], s31 offen lds
 v_mfma_f32_16x16x32_bf16 v[88:91], a[100:103], a[52:55], v[88:91]
 s_add_u32 m0, s47, 103424
 v_mfma_f32_16x16x32_bf16 v[92:95], a[100:103], a[60:63], v[92:95]
 buffer_load_dwordx4 v7, s[16:19], s33 offen lds
 s_add_u32 s37, s31, 32768
 v_mfma_f32_16x16x32_bf16 v[92:95], a[96:99], a[56:59], v[92:95]
 s_waitcnt lgkmcnt(4)
 v_mfma_f32_16x16x32_bf16 v[108:111], a[104:107], a[56:59], v[108:111]
 ds_read_b64_tr_b16 a[120:121], v15 offset:32768
 v_mfma_f32_16x16x32_bf16 v[108:111], a[108:111], a[60:63], v[108:111]
 ds_read_b64_tr_b16 a[122:123], v15 offset:33024
 v_mfma_f32_16x16x32_bf16 v[104:107], a[108:111], a[52:55], v[104:107]
 ds_read_b64_tr_b16 a[124:125], v15 offset:34816
 v_mfma_f32_16x16x32_bf16 v[104:107], a[104:107], a[48:51], v[104:107]
 ds_read_b64_tr_b16 a[126:127], v15 offset:35072
 v_mfma_f32_16x16x32_bf16 v[100:103], a[104:107], a[40:43], v[100:103]
 v_mfma_f32_16x16x32_bf16 v[100:103], a[108:111], a[44:47], v[100:103]
 s_add_u32 m0, s39, 2048
 v_mfma_f32_16x16x32_bf16 v[96:99], a[108:111], a[36:39], v[96:99]
 buffer_load_dwordx4 v1, s[8:11], s37 offen lds
 v_mfma_f32_16x16x32_bf16 v[96:99], a[104:107], a[32:35], v[96:99]
 s_waitcnt lgkmcnt(4)
 v_mfma_f32_16x16x32_bf16 v[112:115], a[32:35], a[112:115], v[112:115]
 ds_read_b64_tr_b16 a[96:97], v16 offset:16384
 v_mfma_f32_16x16x32_bf16 v[112:115], a[36:39], a[116:119], v[112:115]
L_pg5:
 s_cbranch_execz L_pg9
 ds_read_b64_tr_b16 a[98:99], v16 offset:18176
 v_mfma_f32_16x16x32_bf16 v[116:119], a[44:47], a[116:119], v[116:119]
 ds_read_b64_tr_b16 a[100:101], v16 offset:23552
 v_mfma_f32_16x16x32_bf16 v[116:119], a[40:43], a[112:115], v[116:119]
 ds_read_b64_tr_b16 a[102:103], v16 offset:25344
 s_add_u32 m0, s46, 81920
 v_mfma_f32_16x16x32_bf16 v[120:123], a[48:51], a[112:115], v[120:123]
 buffer_load_dwordx4 v4, s[12:15], s32 offen lds
 v_mfma_f32_16x16x32_bf16 v[120:123], a[52:55], a[116:119], v[120:123]
 v_mfma_f32_16x16x32_bf16 v[124:127], a[60:63], a[116:119], v[124:127]
 v_mfma_f32_16x16x32_bf16 v[124:127], a[56:59], a[112:115], v[124:127]
 s_waitcnt lgkmcnt(4)
 v_mfma_f32_16x16x32_bf16 v[140:143], a[56:59], a[120:123], v[140:143]
 ds_read_b64_tr_b16 a[104:105], v16 offset:16416
 v_mfma_f32_16x16x32_bf16 v[140:143], a[60:63], a[124:127], v[140:143]
 ds_read_b64_tr_b16 a[106:107], v16 offset:18208
 v_mfma_f32_16x16x32_bf16 v[136:139], a[52:55], a[124:127], v[136:139]
 ds_read_b64_tr_b16 a[108:109], v16 offset:23584
 v_mfma_f32_16x16x32_bf16 v[136:139], a[48:51], a[120:123], v[136:139]
 ds_read_b64_tr_b16 a[110:111], v16 offset:25376
 s_add_u32 m0, s39, 3072
 v_mfma_f32_16x16x32_bf16 v[132:135], a[40:43], a[120:123], v[132:135]
 buffer_load_dwordx4 v2, s[8:11], s37 offen lds
 v_mfma_f32_16x16x32_bf16 v[132:135], a[44:47], a[124:127], v[132:135]
 s_add_u32 m0, s47, 104448
 v_mfma_f32_16x16x32_bf16 v[128:131], a[36:39], a[124:127], v[128:131]
 buffer_load_dwordx4 v8, s[24:27], s33 offen lds
 s_add_u32 s37, s31, 65536
 v_mfma_f32_16x16x32_bf16 v[128:131], a[32:35], a[120:123], v[128:131]
 s_waitcnt lgkmcnt(4)
 v_mfma_f32_16x16x32_bf16 v[144:147], a[96:99], a[32:35], v[144:147]
 ds_read_b64_tr_b16 a[112:113], v16 offset:16448
 v_mfma_f32_16x16x32_bf16 v[144:147], a[100:103], a[36:39], v[144:147]
 ds_read_b64_tr_b16 a[114:115], v16 offset:18240
 v_mfma_f32_16x16x32_bf16 v[148:151], a[100:103], a[44:47], v[148:151]
 ds_read_b64_tr_b16 a[116:117], v16 offset:23616
 v_mfma_f32_16x16x32_bf16 v[148:151], a[96:99], a[40:43], v[148:151]
 ds_read_b64_tr_b16 a[118:119], v16 offset:25408
 v_mfma_f32_16x16x32_bf16 v[152:155], a[96:99], a[48:51], v[152:155]
 v_mfma_f32_16x16x32_bf16 v[152:155], a[100:103], a[52:55], v[152:155]
 s_add_u32 m0, s39, 4096
 v_mfma_f32_16x16x32_bf16 v[156:159], a[100:103], a[60:63], v[156:159]
 buffer_load_dwordx4 v1, s[8:11], s37 offen lds
 v_mfma_f32_16x16x32_bf16 v[156:159], a[96:99], a[56:59], v[156:159]
 s_waitcnt lgkmcnt(4)
 v_mfma_f32_16x16x32_bf16 v[172:175], a[104:107], a[56:59], v[172:175]
 ds_read_b64_tr_b16 a[120:121], v16 offset:16480
 v_mfma_f32_16x16x32_bf16 v[172:175], a[108:111], a[60:63], v[172:175]
 ds_read_b64_tr_b16 a[122:123], v16 offset:18272
 v_mfma_f32_16x16x32_bf16 v[168:171], a[108:111], a[52:55], v[168:171]
 ds_read_b64_tr_b16 a[124:125], v16 offset:23648
 v_mfma_f32_16x16x32_bf16 v[168:171], a[104:107], a[48:51], v[168:171]
 ds_read_b64_tr_b16 a[126:127], v16 offset:25440
 s_add_u32 m0, s47, 105472
 v_mfma_f32_16x16x32_bf16 v[164:167], a[104:107], a[40:43], v[164:167]
 buffer_load_dwordx4 v9, s[24:27], s33 offen lds
 v_mfma_f32_16x16x32_bf16 v[164:167], a[108:111], a[44:47], v[164:167]
 v_mfma_f32_16x16x32_bf16 v[160:163], a[108:111], a[36:39], v[160:163]
 v_mfma_f32_16x16x32_bf16 v[160:163], a[104:107], a[32:35], v[160:163]
 s_waitcnt lgkmcnt(4)
 v_mfma_f32_16x16x32_bf16 v[176:179], a[112:115], a[32:35], v[176:179]
 ds_read_b64_tr_b16 a[96:97], v16 offset:16512
 v_mfma_f32_16x16x32_bf16 v[176:179], a[116:119], a[36:39], v[176:179]
 ds_read_b64_tr_b16 a[98:99], v16 offset:18304
 v_mfma_f32_16x16x32_bf16 v[180:183], a[116:119], a[44:47], v[180:183]
 ds_read_b64_tr_b16 a[100:101], v16 offset:23680
 v_mfma_f32_16x16x32_bf16 v[180:183], a[112:115], a[40:43], v[180:183]
 ds_read_b64_tr_b16 a[102:103], v16 offset:25472
 s_add_u32 m0, s39, 5120
 v_mfma_f32_16x16x32_bf16 v[184:187], a[112:115], a[48:51], v[184:187]
 buffer_load_dwordx4 v2, s[8:11], s37 offen lds
 v_mfma_f32_16x16x32_bf16 v[184:187], a[116:119], a[52:55], v[184:187]
 s_add_u32 m0, s46, 86016
 v_mfma_f32_16x16x32_bf16 v[188:191], a[116:119], a[60:63], v[188:191]
 buffer_load_dwordx4 v5, s[12:15], s32 offen lds
 s_add_u32 s37, s31, 98304
 v_mfma_f32_16x16x32_bf16 v[188:191], a[112:115], a[56:59], v[188:191]
 s_waitcnt lgkmcnt(4)
 v_mfma_f32_16x16x32_bf16 v[204:207], a[120:123], a[56:59], v[204:207]
 ds_read_b64_tr_b16 a[104:105], v16 offset:16544
 v_mfma_f32_16x16x32_bf16 v[204:207], a[124:127], a[60:63], v[204:207]
 ds_read_b64_tr_b16 a[106:107], v16 offset:18336
 v_mfma_f32_16x16x32_bf16 v[200:203], a[124:127], a[52:55], v[200:203]
 ds_read_b64_tr_b16 a[108:109], v16 offset:23712
 v_mfma_f32_16x16x32_bf16 v[200:203], a[120:123], a[48:51], v[200:203]
 ds_read_b64_tr_b16 a[110:111], v16 offset:25504
 v_mfma_f32_16x16x32_bf16 v[196:199], a[120:123], a[40:43], v[196:199]
 v_mfma_f32_16x16x32_bf16 v[196:199], a[124:127], a[44:47], v[196:199]
 s_add_u32 m0, s39, 6144
 v_mfma_f32_16x16x32_bf16 v[192:195], a[124:127], a[36:39], v[192:195]
 buffer_load_dwordx4 v1, s[8:11], s37 offen lds
 v_mfma_f32_16x16x32_bf16 v[192:195], a[120:123], a[32:35], v[192:195]
 s_waitcnt lgkmcnt(4)
 v_mfma_f32_16x16x32_bf16 v[208:211], a[96:99], a[32:35], v[208:211]
 ds_read_b64_tr_b16 a[112:113], v16 offset:16576
 v_mfma_f32_16x16x32_bf16 v[208:211], a[100:103], a[36:39], v[208:211]
 ds_read_b64_tr_b16 a[114:115], v16 offset:18368
 v_mfma_f32_16x16x32_bf16 v[212:215], a[100:103], a[44:47], v[212:215]
 ds_read_b64_tr_b16 a[116:117], v16 offset:23744
 v_mfma_f32_16x16x32_bf16 v[212:215], a[96:99], a[40:43], v[212:215]
 ds_read_b64_tr_b16 a[118:119], v16 offset:25536
 s_add_u32 m0, s39, 7168
 v_mfma_f32_16x16x32_bf16 v[216:219], a[96:99], a[48:51], v[216:219]
 buffer_load_dwordx4 v2, s[8:11], s37 offen lds
 s_and_b32 s38, s34, 12
 v_mfma_f32_16x16x32_bf16 v[216:219], a[100:103], a[52:55], v[216:219]
 s_xor_b32 s38, s38, 13
 s_lshl_b32 s31, s38, 7
 s_mul_i32 s32, s38, 393216
 v_mfma_f32_16x16x32_bf16 v[220:223], a[100:103], a[60:63], v[220:223]
 s_mul_i32 s33, s38, 458752
 v_mfma_f32_16x16x32_bf16 v[220:223], a[96:99], a[56:59], v[220:223]
 s_waitcnt vmcnt(15) lgkmcnt(0)
 s_barrier
 v_mfma_f32_16x16x32_bf16 v[236:239], a[104:107], a[56:59], v[236:239]
 ds_read_b64_tr_b16 a[120:121], v14 offset:0
 v_mfma_f32_16x16x32_bf16 v[236:239], a[108:111], a[60:63], v[236:239]
 ds_read_b64_tr_b16 a[122:123], v14 offset:256
 v_mfma_f32_16x16x32_bf16 v[232:235], a[108:111], a[52:55], v[232:235]
 ds_read_b64_tr_b16 a[124:125], v14 offset:2048
 v_mfma_f32_16x16x32_bf16 v[232:235], a[104:107], a[48:51], v[232:235]
 ds_read_b64_tr_b16 a[126:127], v14 offset:2304
 v_mfma_f32_16x16x32_bf16 v[228:231], a[104:107], a[40:43], v[228:231]
 ds_read_b128 a[64:67], v10 offset:32768
 v_mfma_f32_16x16x32_bf16 v[228:231], a[108:111], a[44:47], v[228:231]
 ds_read_b128 a[68:71], v11 offset:32768
 v_mfma_f32_16x16x32_bf16 v[224:227], a[108:111], a[36:39], v[224:227]
 ds_read_b128 a[76:79], v11 offset:34816
 v_mfma_f32_16x16x32_bf16 v[224:227], a[104:107], a[32:35], v[224:227]
 ds_read_b128 a[72:75], v10 offset:34816
 v_mfma_f32_16x16x32_bf16 v[240:243], a[112:115], a[32:35], v[240:243]
 ds_read_b64_tr_b16 a[96:97], v15 offset:0
 v_mfma_f32_16x16x32_bf16 v[240:243], a[116:119], a[36:39], v[240:243]
 ds_read_b64_tr_b16 a[98:99], v15 offset:256
 v_mfma_f32_16x16x32_bf16 v[244:247], a[116:119], a[44:47], v[244:247]
 ds_read_b64_tr_b16 a[100:101], v15 offset:2048
 v_mfma_f32_16x16x32_bf16 v[244:247], a[112:115], a[40:43], v[244:247]
 ds_read_b64_tr_b16 a[102:103], v15 offset:2304
 v_mfma_f32_16x16x32_bf16 v[248:251], a[112:115], a[48:51], v[248:251]
 ds_read_b128 a[80:83], v10 offset:36864
 v_mfma_f32_16x16x32_bf16 v[248:251], a[116:119], a[52:55], v[248:251]
 ds_read_b128 a[84:87], v11 offset:36864
 v_mfma_f32_16x16x32_bf16 v[252:255], a[116:119], a[60:63], v[252:255]
 ds_read_b128 a[92:95], v11 offset:38912
 v_mfma_f32_16x16x32_bf16 v[252:255], a[112:115], a[56:59], v[252:255]
 ds_read_b128 a[88:91], v10 offset:38912
 s_waitcnt lgkmcnt(8)
 v_mfma_f32_16x16x32_bf16 v[48:51], a[120:123], a[64:67], v[48:51]
 ds_read_b64_tr_b16 a[104:105], v14 offset:4096
 v_mfma_f32_16x16x32_bf16 v[48:51], a[124:127], a[68:71], v[48:51]
 ds_read_b64_tr_b16 a[106:107], v14 offset:4352
 v_mfma_f32_16x16x32_bf16 v[52:55], a[124:127], a[76:79], v[52:55]
 ds_read_b64_tr_b16 a[108:109], v14 offset:6144
 s_cmp_eq_u32 s70, 11
 s_cbranch_scc1 L_cap11
L_capb11:
 v_mfma_f32_16x16x32_bf16 v[52:55], a[120:123], a[72:75], v[52:55]
 ds_read_b64_tr_b16 a[110:111], v14 offset:6400
 s_add_u32 m0, s46, 90112
 s_waitcnt lgkmcnt(4)
 v_mfma_f32_16x16x32_bf16 v[56:59], a[120:123], a[80:83], v[56:59]
 buffer_load_dwordx4 v3, s[12:15], s32 offen lds
 v_mfma_f32_16x16x32_bf16 v[56:59], a[124:127], a[84:87], v[56:59]
 s_add_u32 m0, s39, 32768
 v_mfma_f32_16x16x32_bf16 v[60:63], a[124:127], a[92:95], v[60:63]
 buffer_load_dwordx4 v1, s[8:11], s31 offen lds
 v_mfma_f32_16x16x32_bf16 v[60:63], a[120:123], a[88:91], v[60:63]
 v_mfma_f32_16x16x32_bf16 v[76:79], a[96:99], a[88:91], v[76:79]
 ds_read_b64_tr_b16 a[112:113], v15 offset:4096
 v_mfma_f32_16x16x32_bf16 v[76:79], a[100:103], a[92:95], v[76:79]
 ds_read_b64_tr_b16 a[114:115], v15 offset:4352
 v_mfma_f32_16x16x32_bf16 v[72:75], a[100:103], a[84:87], v[72:75]
 ds_read_b64_tr_b16 a[116:117], v15 offset:6144
 v_mfma_f32_16x16x32_bf16 v[72:75], a[96:99], a[80:83], v[72:75]
 ds_read_b64_tr_b16 a[118:119], v15 offset:6400
 s_add_u32 m0, s47, 118784
 v_mfma_f32_16x16x32_bf16 v[68:71], a[96:99], a[72:75], v[68:71]
 buffer_load_dwordx4 v6, s[16:19], s33 offen lds
 v_mfma_f32_16x16x32_bf16 v[68:71], a[100:103], a[76:79], v[68:71]
 v_mfma_f32_16x16x32_bf16 v[64:67], a[100:103], a[68:71], v[64:67]
 v_mfma_f32_16x16x32_bf16 v[64:67], a[96:99], a[64:67], v[64:67]
 s_waitcnt lgkmcnt(4)
 v_mfma_f32_16x16x32_bf16 v[80:83], a[104:107], a[64:67], v[80:83]
 ds_read_b64_tr_b16 a[120:121], v14 offset:8192
 v_mfma_f32_16x16x32_bf16 v[80:83], a[108:111], a[68:71], v[80:83]
 ds_read_b64_tr_b16 a[122:123], v14 offset:8448
 v_mfma_f32_16x16x32_bf16 v[84:87], a[108:111], a[76:79], v[84:87]
 ds_read_b64_tr_b16 a[124:125], v14 offset:10240
 v_mfma_f32_16x16x32_bf16 v[84:87], a[104:107], a[72:75], v[84:87]
 ds_read_b64_tr_b16 a[126:127], v14 offset:10496
 s_add_u32 m0, s39, 33792
 v_mfma_f32_16x16x32_bf16 v[88:91], a[104:107], a[80:83], v[88:91]
 buffer_load_dwordx4 v2, s[8:11], s31 offen lds
 v_mfma_f32_16x16x32_bf16 v[88:91], a[108:111], a[84:87], v[88:91]
 s_add_u32 m0, s47, 119808
 v_mfma_f32_16x16x32_bf16 v[92:95], a[108:111], a[92:95], v[92:95]
 buffer_load_dwordx4 v7, s[16:19], s33 offen lds
 s_add_u32 s37, s31, 32768
 v_mfma_f32_16x16x32_bf16 v[92:95], a[104:107], a[88:91], v[92:95]
 s_mov_b32 s50, 256
 buffer_load_dword v43, v18, s[48:51], 0 offen sc1
 s_waitcnt lgkmcnt(4)
 v_mfma_f32_16x16x32_bf16 v[108:111], a[112:115], a[88:91], v[108:111]
 ds_read_b64_tr_b16 a[96:97], v15 offset:8192
 v_mfma_f32_16x16x32_bf16 v[108:111], a[116:119], a[92:95], v[108:111]
 ds_read_b64_tr_b16 a[98:99], v15 offset:8448
 v_mfma_f32_16x16x32_bf16 v[104:107], a[116:119], a[84:87], v[104:107]
 ds_read_b64_tr_b16 a[100:101], v15 offset:10240
 v_mfma_f32_16x16x32_bf16 v[104:107], a[112:115], a[80:83], v[104:107]
 ds_read_b64_tr_b16 a[102:103], v15 offset:10496
 v_mfma_f32_16x16x32_bf16 v[100:103], a[112:115], a[72:75], v[100:103]
 v_mfma_f32_16x16x32_bf16 v[100:103], a[116:119], a[76:79], v[100:103]
 s_add_u32 m0, s39, 34816
 v_mfma_f32_16x16x32_bf16 v[96:99], a[116:119], a[68:71], v[96:99]
 buffer_load_dwordx4 v1, s[8:11], s37 offen lds
 v_mfma_f32_16x16x32_bf16 v[96:99], a[112:115], a[64:67], v[96:99]
 s_waitcnt lgkmcnt(4)
 v_mfma_f32_16x16x32_bf16 v[112:115], a[64:67], a[120:123], v[112:115]
 ds_read_b64_tr_b16 a[104:105], v16 offset:32768
 v_mfma_f32_16x16x32_bf16 v[112:115], a[68:71], a[124:127], v[112:115]
 ds_read_b64_tr_b16 a[106:107], v16 offset:34560
 v_mfma_f32_16x16x32_bf16 v[116:119], a[76:79], a[124:127], v[116:119]
 ds_read_b64_tr_b16 a[108:109], v16 offset:39936
 v_mfma_f32_16x16x32_bf16 v[116:119], a[72:75], a[120:123], v[116:119]
 ds_read_b64_tr_b16 a[110:111], v16 offset:41728
 s_add_u32 m0, s46, 94208
 v_mfma_f32_16x16x32_bf16 v[120:123], a[80:83], a[120:123], v[120:123]
 buffer_load_dwordx4 v4, s[12:15], s32 offen lds
 v_mfma_f32_16x16x32_bf16 v[120:123], a[84:87], a[124:127], v[120:123]
 v_mfma_f32_16x16x32_bf16 v[124:127], a[92:95], a[124:127], v[124:127]
 v_mfma_f32_16x16x32_bf16 v[124:127], a[88:91], a[120:123], v[124:127]
 s_waitcnt lgkmcnt(4)
 v_mfma_f32_16x16x32_bf16 v[140:143], a[88:91], a[96:99], v[140:143]
 ds_read_b64_tr_b16 a[112:113], v16 offset:32800
 v_mfma_f32_16x16x32_bf16 v[140:143], a[92:95], a[100:103], v[140:143]
 ds_read_b64_tr_b16 a[114:115], v16 offset:34592
 v_mfma_f32_16x16x32_bf16 v[136:139], a[84:87], a[100:103], v[136:139]
 ds_read_b64_tr_b16 a[116:117], v16 offset:39968
 v_mfma_f32_16x16x32_bf16 v[136:139], a[80:83], a[96:99], v[136:139]
 ds_read_b64_tr_b16 a[118:119], v16 offset:41760
 s_add_u32 m0, s39, 35840
 v_mfma_f32_16x16x32_bf16 v[132:135], a[72:75], a[96:99], v[132:135]
 buffer_load_dwordx4 v2, s[8:11], s37 offen lds
 v_mfma_f32_16x16x32_bf16 v[132:135], a[76:79], a[100:103], v[132:135]
 s_add_u32 m0, s47, 120832
 v_mfma_f32_16x16x32_bf16 v[128:131], a[68:71], a[100:103], v[128:131]
 buffer_load_dwordx4 v8, s[24:27], s33 offen lds
 s_add_u32 s37, s31, 65536
 v_mfma_f32_16x16x32_bf16 v[128:131], a[64:67], a[96:99], v[128:131]
 s_waitcnt lgkmcnt(4)
 v_mfma_f32_16x16x32_bf16 v[144:147], a[104:107], a[64:67], v[144:147]
 ds_read_b64_tr_b16 a[120:121], v16 offset:32832
 v_mfma_f32_16x16x32_bf16 v[144:147], a[108:111], a[68:71], v[144:147]
 ds_read_b64_tr_b16 a[122:123], v16 offset:34624
 v_mfma_f32_16x16x32_bf16 v[148:151], a[108:111], a[76:79], v[148:151]
 ds_read_b64_tr_b16 a[124:125], v16 offset:40000
 v_mfma_f32_16x16x32_bf16 v[148:151], a[104:107], a[72:75], v[148:151]
 ds_read_b64_tr_b16 a[126:127], v16 offset:41792
 v_mfma_f32_16x16x32_bf16 v[152:155], a[104:107], a[80:83], v[152:155]
 v_mfma_f32_16x16x32_bf16 v[152:155], a[108:111], a[84:87], v[152:155]
 s_add_u32 m0, s39, 36864
 v_mfma_f32_16x16x32_bf16 v[156:159], a[108:111], a[92:95], v[156:159]
 buffer_load_dwordx4 v1, s[8:11], s37 offen lds
 v_mfma_f32_16x16x32_bf16 v[156:159], a[104:107], a[88:91], v[156:159]
 s_waitcnt lgkmcnt(4)
 v_mfma_f32_16x16x32_bf16 v[172:175], a[112:115], a[88:91], v[172:175]
 ds_read_b64_tr_b16 a[96:97], v16 offset:32864
 v_mfma_f32_16x16x32_bf16 v[172:175], a[116:119], a[92:95], v[172:175]
 ds_read_b64_tr_b16 a[98:99], v16 offset:34656
 v_mfma_f32_16x16x32_bf16 v[168:171], a[116:119], a[84:87], v[168:171]
 ds_read_b64_tr_b16 a[100:101], v16 offset:40032
 v_mfma_f32_16x16x32_bf16 v[168:171], a[112:115], a[80:83], v[168:171]
 ds_read_b64_tr_b16 a[102:103], v16 offset:41824
 s_add_u32 m0, s47, 121856
 v_mfma_f32_16x16x32_bf16 v[164:167], a[112:115], a[72:75], v[164:167]
 buffer_load_dwordx4 v9, s[24:27], s33 offen lds
 v_mfma_f32_16x16x32_bf16 v[164:167], a[116:119], a[76:79], v[164:167]
 v_mfma_f32_16x16x32_bf16 v[160:163], a[116:119], a[68:71], v[160:163]
 v_mfma_f32_16x16x32_bf16 v[160:163], a[112:115], a[64:67], v[160:163]
 s_waitcnt lgkmcnt(4)
 v_mfma_f32_16x16x32_bf16 v[176:179], a[120:123], a[64:67], v[176:179]
 ds_read_b64_tr_b16 a[104:105], v16 offset:32896
 v_mfma_f32_16x16x32_bf16 v[176:179], a[124:127], a[68:71], v[176:179]
 ds_read_b64_tr_b16 a[106:107], v16 offset:34688
 v_mfma_f32_16x16x32_bf16 v[180:183], a[124:127], a[76:79], v[180:183]
 ds_read_b64_tr_b16 a[108:109], v16 offset:40064
 v_mfma_f32_16x16x32_bf16 v[180:183], a[120:123], a[72:75], v[180:183]
 ds_read_b64_tr_b16 a[110:111], v16 offset:41856
 s_add_u32 m0, s39, 37888
 v_mfma_f32_16x16x32_bf16 v[184:187], a[120:123], a[80:83], v[184:187]
 buffer_load_dwordx4 v2, s[8:11], s37 offen lds
 v_mfma_f32_16x16x32_bf16 v[184:187], a[124:127], a[84:87], v[184:187]
 s_add_u32 m0, s46, 98304
 v_mfma_f32_16x16x32_bf16 v[188:191], a[124:127], a[92:95], v[188:191]
 buffer_load_dwordx4 v5, s[12:15], s32 offen lds
 s_add_u32 s37, s31, 98304
 v_mfma_f32_16x16x32_bf16 v[188:191], a[120:123], a[88:91], v[188:191]
 s_waitcnt lgkmcnt(4)
 v_mfma_f32_16x16x32_bf16 v[204:207], a[96:99], a[88:91], v[204:207]
 ds_read_b64_tr_b16 a[112:113], v16 offset:32928
 v_mfma_f32_16x16x32_bf16 v[204:207], a[100:103], a[92:95], v[204:207]
 ds_read_b64_tr_b16 a[114:115], v16 offset:34720
 v_mfma_f32_16x16x32_bf16 v[200:203], a[100:103], a[84:87], v[200:203]
 ds_read_b64_tr_b16 a[116:117], v16 offset:40096
 v_mfma_f32_16x16x32_bf16 v[200:203], a[96:99], a[80:83], v[200:203]
 ds_read_b64_tr_b16 a[118:119], v16 offset:41888
 v_mfma_f32_16x16x32_bf16 v[196:199], a[96:99], a[72:75], v[196:199]
 v_mfma_f32_16x16x32_bf16 v[196:199], a[100:103], a[76:79], v[196:199]
 s_add_u32 m0, s39, 38912
 v_mfma_f32_16x16x32_bf16 v[192:195], a[100:103], a[68:71], v[192:195]
 buffer_load_dwordx4 v1, s[8:11], s37 offen lds
 v_mfma_f32_16x16x32_bf16 v[192:195], a[96:99], a[64:67], v[192:195]
 s_waitcnt lgkmcnt(4)
 v_mfma_f32_16x16x32_bf16 v[208:211], a[104:107], a[64:67], v[208:211]
 ds_read_b64_tr_b16 a[120:121], v16 offset:32960
 v_mfma_f32_16x16x32_bf16 v[208:211], a[108:111], a[68:71], v[208:211]
 ds_read_b64_tr_b16 a[122:123], v16 offset:34752
 v_mfma_f32_16x16x32_bf16 v[212:215], a[108:111], a[76:79], v[212:215]
 ds_read_b64_tr_b16 a[124:125], v16 offset:40128
 v_mfma_f32_16x16x32_bf16 v[212:215], a[104:107], a[72:75], v[212:215]
 ds_read_b64_tr_b16 a[126:127], v16 offset:41920
 s_add_u32 m0, s39, 39936
 v_mfma_f32_16x16x32_bf16 v[216:219], a[104:107], a[80:83], v[216:219]
 buffer_load_dwordx4 v2, s[8:11], s37 offen lds
 s_and_b32 s38, s34, 13
 v_mfma_f32_16x16x32_bf16 v[216:219], a[108:111], a[84:87], v[216:219]
 s_xor_b32 s38, s38, 14
 s_lshl_b32 s31, s38, 7
 s_mul_i32 s32, s38, 393216
 v_mfma_f32_16x16x32_bf16 v[220:223], a[108:111], a[92:95], v[220:223]
 s_mul_i32 s33, s38, 458752
 v_mfma_f32_16x16x32_bf16 v[220:223], a[104:107], a[88:91], v[220:223]
 s_waitcnt vmcnt(16) lgkmcnt(0)
 s_barrier
 v_mfma_f32_16x16x32_bf16 v[236:239], a[112:115], a[88:91], v[236:239]
 ds_read_b64_tr_b16 a[96:97], v14 offset:12288
 v_mfma_f32_16x16x32_bf16 v[236:239], a[116:119], a[92:95], v[236:239]
 ds_read_b64_tr_b16 a[98:99], v14 offset:12544
 v_mfma_f32_16x16x32_bf16 v[232:235], a[116:119], a[84:87], v[232:235]
 ds_read_b64_tr_b16 a[100:101], v14 offset:14336
 v_mfma_f32_16x16x32_bf16 v[232:235], a[112:115], a[80:83], v[232:235]
 ds_read_b64_tr_b16 a[102:103], v14 offset:14592
 v_mfma_f32_16x16x32_bf16 v[228:231], a[112:115], a[72:75], v[228:231]
 ds_read_b128 a[0:3], v10 offset:0
 v_mfma_f32_16x16x32_bf16 v[228:231], a[116:119], a[76:79], v[228:231]
 ds_read_b128 a[4:7], v11 offset:0
 v_mfma_f32_16x16x32_bf16 v[224:227], a[116:119], a[68:71], v[224:227]
 ds_read_b128 a[12:15], v11 offset:2048
 v_mfma_f32_16x16x32_bf16 v[224:227], a[112:115], a[64:67], v[224:227]
 ds_read_b128 a[8:11], v10 offset:2048
 v_mfma_f32_16x16x32_bf16 v[240:243], a[120:123], a[64:67], v[240:243]
 ds_read_b64_tr_b16 a[104:105], v15 offset:12288
 v_mfma_f32_16x16x32_bf16 v[240:243], a[124:127], a[68:71], v[240:243]
 ds_read_b64_tr_b16 a[106:107], v15 offset:12544
 v_mfma_f32_16x16x32_bf16 v[244:247], a[124:127], a[76:79], v[244:247]
 ds_read_b64_tr_b16 a[108:109], v15 offset:14336
 v_mfma_f32_16x16x32_bf16 v[244:247], a[120:123], a[72:75], v[244:247]
 ds_read_b64_tr_b16 a[110:111], v15 offset:14592
 v_mfma_f32_16x16x32_bf16 v[248:251], a[120:123], a[80:83], v[248:251]
 ds_read_b128 a[16:19], v10 offset:4096
 v_mfma_f32_16x16x32_bf16 v[248:251], a[124:127], a[84:87], v[248:251]
 ds_read_b128 a[20:23], v11 offset:4096
 v_mfma_f32_16x16x32_bf16 v[252:255], a[124:127], a[92:95], v[252:255]
 ds_read_b128 a[28:31], v11 offset:6144
 v_mfma_f32_16x16x32_bf16 v[252:255], a[120:123], a[88:91], v[252:255]
 ds_read_b128 a[24:27], v10 offset:6144
 s_waitcnt lgkmcnt(8)
 v_mfma_f32_16x16x32_bf16 v[48:51], a[96:99], a[0:3], v[48:51]
 ds_read_b64_tr_b16 a[112:113], v14 offset:16384
 v_mfma_f32_16x16x32_bf16 v[48:51], a[100:103], a[4:7], v[48:51]
 ds_read_b64_tr_b16 a[114:115], v14 offset:16640
 v_mfma_f32_16x16x32_bf16 v[52:55], a[100:103], a[12:15], v[52:55]
 ds_read_b64_tr_b16 a[116:117], v14 offset:18432
 s_cmp_eq_u32 s70, 12
 s_cbranch_scc1 L_cap12
L_capb12:
 v_mfma_f32_16x16x32_bf16 v[52:55], a[96:99], a[8:11], v[52:55]
 ds_read_b64_tr_b16 a[118:119], v14 offset:18688
 s_add_u32 m0, s46, 65536
 s_waitcnt lgkmcnt(4)
 v_mfma_f32_16x16x32_bf16 v[56:59], a[96:99], a[16:19], v[56:59]
 buffer_load_dwordx4 v3, s[12:15], s32 offen lds
 v_mfma_f32_16x16x32_bf16 v[56:59], a[100:103], a[20:23], v[56:59]
 s_add_u32 m0, s39, 0
 v_mfma_f32_16x16x32_bf16 v[60:63], a[100:103], a[28:31], v[60:63]
 buffer_load_dwordx4 v1, s[8:11], s31 offen lds
 v_mfma_f32_16x16x32_bf16 v[60:63], a[96:99], a[24:27], v[60:63]
 v_mfma_f32_16x16x32_bf16 v[76:79], a[104:107], a[24:27], v[76:79]
 ds_read_b64_tr_b16 a[120:121], v15 offset:16384
 v_mfma_f32_16x16x32_bf16 v[76:79], a[108:111], a[28:31], v[76:79]
 ds_read_b64_tr_b16 a[122:123], v15 offset:16640
 v_mfma_f32_16x16x32_bf16 v[72:75], a[108:111], a[20:23], v[72:75]
 ds_read_b64_tr_b16 a[124:125], v15 offset:18432
 v_mfma_f32_16x16x32_bf16 v[72:75], a[104:107], a[16:19], v[72:75]
 ds_read_b64_tr_b16 a[126:127], v15 offset:18688
 s_add_u32 m0, s47, 135168
 v_mfma_f32_16x16x32_bf16 v[68:71], a[104:107], a[8:11], v[68:71]
 buffer_load_dwordx4 v6, s[16:19], s33 offen lds
 v_mfma_f32_16x16x32_bf16 v[68:71], a[108:111], a[12:15], v[68:71]
 v_mfma_f32_16x16x32_bf16 v[64:67], a[108:111], a[4:7], v[64:67]
 s_waitcnt vmcnt(13)
 v_cmp_gt_u32 vcc, 32, v43
 v_mfma_f32_16x16x32_bf16 v[64:67], a[104:107], a[0:3], v[64:67]
 s_cbranch_vccnz L_ps_wait
L_ps_ok:
 s_waitcnt lgkmcnt(4)
 v_mfma_f32_16x16x32_bf16 v[80:83], a[112:115], a[0:3], v[80:83]
 ds_read_b64_tr_b16 a[96:97], v14 offset:20480
 v_mfma_f32_16x16x32_bf16 v[80:83], a[116:119], a[4:7], v[80:83]
 ds_read_b64_tr_b16 a[98:99], v14 offset:20736
 v_mfma_f32_16x16x32_bf16 v[84:87], a[116:119], a[12:15], v[84:87]
 ds_read_b64_tr_b16 a[100:101], v14 offset:22528
 v_mfma_f32_16x16x32_bf16 v[84:87], a[112:115], a[8:11], v[84:87]
 ds_read_b64_tr_b16 a[102:103], v14 offset:22784
 s_add_u32 m0, s39, 1024
 v_mfma_f32_16x16x32_bf16 v[88:91], a[112:115], a[16:19], v[88:91]
 buffer_load_dwordx4 v2, s[8:11], s31 offen lds
 v_mfma_f32_16x16x32_bf16 v[88:91], a[116:119], a[20:23], v[88:91]
 s_add_u32 m0, s47, 136192
 v_mfma_f32_16x16x32_bf16 v[92:95], a[116:119], a[28:31], v[92:95]
 buffer_load_dwordx4 v7, s[16:19], s33 offen lds
 s_add_u32 s37, s31, 32768
 v_mfma_f32_16x16x32_bf16 v[92:95], a[112:115], a[24:27], v[92:95]
 buffer_load_dwordx4 v[26:29], v35, s[20:23], s57 offen offset:0 sc1
 s_waitcnt lgkmcnt(4)
 v_mfma_f32_16x16x32_bf16 v[108:111], a[120:123], a[24:27], v[108:111]
 ds_read_b64_tr_b16 a[104:105], v15 offset:20480
 v_mfma_f32_16x16x32_bf16 v[108:111], a[124:127], a[28:31], v[108:111]
 ds_read_b64_tr_b16 a[106:107], v15 offset:20736
 v_mfma_f32_16x16x32_bf16 v[104:107], a[124:127], a[20:23], v[104:107]
 ds_read_b64_tr_b16 a[108:109], v15 offset:22528
 v_mfma_f32_16x16x32_bf16 v[104:107], a[120:123], a[16:19], v[104:107]
 ds_read_b64_tr_b16 a[110:111], v15 offset:22784
 v_mfma_f32_16x16x32_bf16 v[100:103], a[120:123], a[8:11], v[100:103]
 buffer_load_dwordx4 v[30:33], v35, s[20:23], s57 offen offset:512 sc1
 v_mfma_f32_16x16x32_bf16 v[100:103], a[124:127], a[12:15], v[100:103]
 s_add_u32 m0, s39, 2048
 v_mfma_f32_16x16x32_bf16 v[96:99], a[124:127], a[4:7], v[96:99]
 buffer_load_dwordx4 v1, s[8:11], s37 offen lds
 v_mfma_f32_16x16x32_bf16 v[96:99], a[120:123], a[0:3], v[96:99]
 s_waitcnt lgkmcnt(4)
 v_mfma_f32_16x16x32_bf16 v[112:115], a[0:3], a[96:99], v[112:115]
 ds_read_b64_tr_b16 a[112:113], v16 offset:0
 v_mfma_f32_16x16x32_bf16 v[112:115], a[4:7], a[100:103], v[112:115]
 ds_read_b64_tr_b16 a[114:115], v16 offset:1792
 v_mfma_f32_16x16x32_bf16 v[116:119], a[12:15], a[100:103], v[116:119]
 ds_read_b64_tr_b16 a[116:117], v16 offset:7168
 v_mfma_f32_16x16x32_bf16 v[116:119], a[8:11], a[96:99], v[116:119]
 ds_read_b64_tr_b16 a[118:119], v16 offset:8960
 s_add_u32 m0, s46, 69632
 v_mfma_f32_16x16x32_bf16 v[120:123], a[16:19], a[96:99], v[120:123]
 buffer_load_dwordx4 v4, s[12:15], s32 offen lds
 v_mfma_f32_16x16x32_bf16 v[120:123], a[20:23], a[100:103], v[120:123]
 v_mfma_f32_16x16x32_bf16 v[124:127], a[28:31], a[100:103], v[124:127]
 v_mfma_f32_16x16x32_bf16 v[124:127], a[24:27], a[96:99], v[124:127]
 s_mov_b32 m0, s96
 s_bfm_b64 exec, 40, 0
 buffer_load_dwordx4 v22, s[20:23], 0 offen sc1 lds
 s_mov_b64 exec, -1
 s_waitcnt lgkmcnt(4)
 v_mfma_f32_16x16x32_bf16 v[140:143], a[24:27], a[104:107], v[140:143]
 ds_read_b64_tr_b16 a[120:121], v16 offset:32
 v_mfma_f32_16x16x32_bf16 v[140:143], a[28:31], a[108:111], v[140:143]
 ds_read_b64_tr_b16 a[122:123], v16 offset:1824
 v_mfma_f32_16x16x32_bf16 v[136:139], a[20:23], a[108:111], v[136:139]
 ds_read_b64_tr_b16 a[124:125], v16 offset:7200
 v_mfma_f32_16x16x32_bf16 v[136:139], a[16:19], a[104:107], v[136:139]
 ds_read_b64_tr_b16 a[126:127], v16 offset:8992
 s_add_u32 m0, s39, 3072
 v_mfma_f32_16x16x32_bf16 v[132:135], a[8:11], a[104:107], v[132:135]
 buffer_load_dwordx4 v2, s[8:11], s37 offen lds
 v_mfma_f32_16x16x32_bf16 v[132:135], a[12:15], a[108:111], v[132:135]
 s_add_u32 m0, s47, 137216
 v_mfma_f32_16x16x32_bf16 v[128:131], a[4:7], a[108:111], v[128:131]
 buffer_load_dwordx4 v8, s[24:27], s33 offen lds
 s_add_u32 s37, s31, 65536
 v_mfma_f32_16x16x32_bf16 v[128:131], a[0:3], a[104:107], v[128:131]
 s_waitcnt lgkmcnt(4)
 v_mfma_f32_16x16x32_bf16 v[144:147], a[112:115], a[0:3], v[144:147]
 ds_read_b64_tr_b16 a[96:97], v16 offset:64
 v_mfma_f32_16x16x32_bf16 v[144:147], a[116:119], a[4:7], v[144:147]
 ds_read_b64_tr_b16 a[98:99], v16 offset:1856
 v_mfma_f32_16x16x32_bf16 v[148:151], a[116:119], a[12:15], v[148:151]
 ds_read_b64_tr_b16 a[100:101], v16 offset:7232
 v_mfma_f32_16x16x32_bf16 v[148:151], a[112:115], a[8:11], v[148:151]
 ds_read_b64_tr_b16 a[102:103], v16 offset:9024
 v_mfma_f32_16x16x32_bf16 v[152:155], a[112:115], a[16:19], v[152:155]
 v_mfma_f32_16x16x32_bf16 v[152:155], a[116:119], a[20:23], v[152:155]
 s_add_u32 m0, s39, 4096
 v_mfma_f32_16x16x32_bf16 v[156:159], a[116:119], a[28:31], v[156:159]
 buffer_load_dwordx4 v1, s[8:11], s37 offen lds
 v_mfma_f32_16x16x32_bf16 v[156:159], a[112:115], a[24:27], v[156:159]
 s_waitcnt lgkmcnt(4)
 v_mfma_f32_16x16x32_bf16 v[172:175], a[120:123], a[24:27], v[172:175]
 ds_read_b64_tr_b16 a[104:105], v16 offset:96
 v_mfma_f32_16x16x32_bf16 v[172:175], a[124:127], a[28:31], v[172:175]
 ds_read_b64_tr_b16 a[106:107], v16 offset:1888
 v_mfma_f32_16x16x32_bf16 v[168:171], a[124:127], a[20:23], v[168:171]
 ds_read_b64_tr_b16 a[108:109], v16 offset:7264
 v_mfma_f32_16x16x32_bf16 v[168:171], a[120:123], a[16:19], v[168:171]
 ds_read_b64_tr_b16 a[110:111], v16 offset:9056
 s_add_u32 m0, s47, 138240
 v_mfma_f32_16x16x32_bf16 v[164:167], a[120:123], a[8:11], v[164:167]
 buffer_load_dwordx4 v9, s[24:27], s33 offen lds
 v_mfma_f32_16x16x32_bf16 v[164:167], a[124:127], a[12:15], v[164:167]
 v_mfma_f32_16x16x32_bf16 v[160:163], a[124:127], a[4:7], v[160:163]
 v_mfma_f32_16x16x32_bf16 v[160:163], a[120:123], a[0:3], v[160:163]
 s_waitcnt lgkmcnt(4)
 v_mfma_f32_16x16x32_bf16 v[176:179], a[96:99], a[0:3], v[176:179]
 ds_read_b64_tr_b16 a[112:113], v16 offset:128
 v_mfma_f32_16x16x32_bf16 v[176:179], a[100:103], a[4:7], v[176:179]
 ds_read_b64_tr_b16 a[114:115], v16 offset:1920
 v_mfma_f32_16x16x32_bf16 v[180:183], a[100:103], a[12:15], v[180:183]
 ds_read_b64_tr_b16 a[116:117], v16 offset:7296
 v_mfma_f32_16x16x32_bf16 v[180:183], a[96:99], a[8:11], v[180:183]
 ds_read_b64_tr_b16 a[118:119], v16 offset:9088
 s_add_u32 m0, s39, 5120
 v_mfma_f32_16x16x32_bf16 v[184:187], a[96:99], a[16:19], v[184:187]
 buffer_load_dwordx4 v2, s[8:11], s37 offen lds
 v_mfma_f32_16x16x32_bf16 v[184:187], a[100:103], a[20:23], v[184:187]
 s_add_u32 m0, s46, 73728
 v_mfma_f32_16x16x32_bf16 v[188:191], a[100:103], a[28:31], v[188:191]
 buffer_load_dwordx4 v5, s[12:15], s32 offen lds
 s_add_u32 s37, s31, 98304
 v_mfma_f32_16x16x32_bf16 v[188:191], a[96:99], a[24:27], v[188:191]
 s_waitcnt lgkmcnt(4)
 v_mfma_f32_16x16x32_bf16 v[204:207], a[104:107], a[24:27], v[204:207]
 ds_read_b64_tr_b16 a[120:121], v16 offset:160
 v_mfma_f32_16x16x32_bf16 v[204:207], a[108:111], a[28:31], v[204:207]
 ds_read_b64_tr_b16 a[122:123], v16 offset:1952
 v_mfma_f32_16x16x32_bf16 v[200:203], a[108:111], a[20:23], v[200:203]
 ds_read_b64_tr_b16 a[124:125], v16 offset:7328
 v_mfma_f32_16x16x32_bf16 v[200:203], a[104:107], a[16:19], v[200:203]
 ds_read_b64_tr_b16 a[126:127], v16 offset:9120
 v_mfma_f32_16x16x32_bf16 v[196:199], a[104:107], a[8:11], v[196:199]
 v_mfma_f32_16x16x32_bf16 v[196:199], a[108:111], a[12:15], v[196:199]
 s_add_u32 m0, s39, 6144
 v_mfma_f32_16x16x32_bf16 v[192:195], a[108:111], a[4:7], v[192:195]
 buffer_load_dwordx4 v1, s[8:11], s37 offen lds
 v_mfma_f32_16x16x32_bf16 v[192:195], a[104:107], a[0:3], v[192:195]
L_pg6:
 s_cbranch_execz L_pg10
 s_waitcnt lgkmcnt(4)
 v_mfma_f32_16x16x32_bf16 v[208:211], a[112:115], a[0:3], v[208:211]
 ds_read_b64_tr_b16 a[96:97], v16 offset:192
 s_waitcnt vmcnt(10)
 v_add_f32 v26, v26, v30
 v_mfma_f32_16x16x32_bf16 v[208:211], a[116:119], a[4:7], v[208:211]
 ds_read_b64_tr_b16 a[98:99], v16 offset:1984
 v_add_f32 v27, v27, v31
 v_mfma_f32_16x16x32_bf16 v[212:215], a[116:119], a[12:15], v[212:215]
 ds_read_b64_tr_b16 a[100:101], v16 offset:7360
 v_add_f32 v28, v28, v32
 v_mfma_f32_16x16x32_bf16 v[212:215], a[112:115], a[8:11], v[212:215]
 ds_read_b64_tr_b16 a[102:103], v16 offset:9152
 s_add_u32 m0, s39, 7168
 v_mfma_f32_16x16x32_bf16 v[216:219], a[112:115], a[16:19], v[216:219]
 buffer_load_dwordx4 v2, s[8:11], s37 offen lds
 s_and_b32 s38, s35, 13
 v_mfma_f32_16x16x32_bf16 v[216:219], a[116:119], a[20:23], v[216:219]
 s_xor_b32 s38, s38, 14
 s_lshl_b32 s31, s38, 7
 s_mul_i32 s32, s38, 393216
 v_mfma_f32_16x16x32_bf16 v[220:223], a[116:119], a[28:31], v[220:223]
 s_mul_i32 s33, s38, 458752
 v_add_f32 v29, v29, v33
 v_mfma_f32_16x16x32_bf16 v[220:223], a[112:115], a[24:27], v[220:223]
 s_waitcnt lgkmcnt(0)
 s_barrier
 v_mfma_f32_16x16x32_bf16 v[236:239], a[120:123], a[24:27], v[236:239]
 ds_read_b64_tr_b16 a[104:105], v14 offset:24576
 v_add_f32_dpp v26, v26, v26 row_ror:8 row_mask:0xf bank_mask:0xf
 v_mfma_f32_16x16x32_bf16 v[236:239], a[124:127], a[28:31], v[236:239]
 ds_read_b64_tr_b16 a[106:107], v14 offset:24832
 v_add_f32_dpp v27, v27, v27 row_ror:8 row_mask:0xf bank_mask:0xf
 v_mfma_f32_16x16x32_bf16 v[232:235], a[124:127], a[20:23], v[232:235]
 ds_read_b64_tr_b16 a[108:109], v14 offset:26624
 v_add_f32_dpp v28, v28, v28 row_ror:8 row_mask:0xf bank_mask:0xf
 v_mfma_f32_16x16x32_bf16 v[232:235], a[120:123], a[16:19], v[232:235]
 ds_read_b64_tr_b16 a[110:111], v14 offset:26880
 v_add_f32_dpp v29, v29, v29 row_ror:8 row_mask:0xf bank_mask:0xf
 v_mfma_f32_16x16x32_bf16 v[228:231], a[120:123], a[8:11], v[228:231]
 ds_read_b128 a[32:35], v10 offset:32768
 v_add_f32_dpp v26, v26, v26 row_ror:4 row_mask:0xf bank_mask:0xf
 v_mfma_f32_16x16x32_bf16 v[228:231], a[124:127], a[12:15], v[228:231]
 ds_read_b128 a[36:39], v11 offset:32768
 v_add_f32_dpp v27, v27, v27 row_ror:4 row_mask:0xf bank_mask:0xf
 v_mfma_f32_16x16x32_bf16 v[224:227], a[124:127], a[4:7], v[224:227]
 ds_read_b128 a[44:47], v11 offset:34816
 v_add_f32_dpp v28, v28, v28 row_ror:4 row_mask:0xf bank_mask:0xf
 v_mfma_f32_16x16x32_bf16 v[224:227], a[120:123], a[0:3], v[224:227]
 ds_read_b128 a[40:43], v10 offset:34816
 v_mfma_f32_16x16x32_bf16 v[240:243], a[96:99], a[0:3], v[240:243]
 ds_read_b64_tr_b16 a[112:113], v15 offset:24576
 v_add_f32_dpp v29, v29, v29 row_ror:4 row_mask:0xf bank_mask:0xf
 v_mfma_f32_16x16x32_bf16 v[240:243], a[100:103], a[4:7], v[240:243]
 ds_read_b64_tr_b16 a[114:115], v15 offset:24832
 v_mfma_f32_16x16x32_bf16 v[244:247], a[100:103], a[12:15], v[244:247]
 ds_read_b64_tr_b16 a[116:117], v15 offset:26624
 v_mfma_f32_16x16x32_bf16 v[244:247], a[96:99], a[8:11], v[244:247]
 ds_read_b64_tr_b16 a[118:119], v15 offset:26880
 v_mfma_f32_16x16x32_bf16 v[248:251], a[96:99], a[16:19], v[248:251]
 ds_read_b128 a[48:51], v10 offset:36864
 v_mfma_f32_16x16x32_bf16 v[248:251], a[100:103], a[20:23], v[248:251]
 ds_read_b128 a[52:55], v11 offset:36864
 v_mfma_f32_16x16x32_bf16 v[252:255], a[100:103], a[28:31], v[252:255]
 ds_read_b128 a[60:63], v11 offset:38912
 v_mfma_f32_16x16x32_bf16 v[252:255], a[96:99], a[24:27], v[252:255]
 ds_read_b128 a[56:59], v10 offset:38912
 ds_write_b128 v34, v[26:29]
 s_waitcnt vmcnt(8)
 s_waitcnt lgkmcnt(9)
 v_mfma_f32_16x16x32_bf16 v[48:51], a[104:107], a[32:35], v[48:51]
 ds_read_b64_tr_b16 a[120:121], v14 offset:28672
 s_and_b32 s3, s2, 7
 v_mfma_f32_16x16x32_bf16 v[48:51], a[108:111], a[36:39], v[48:51]
 ds_read_b64_tr_b16 a[122:123], v14 offset:28928
 s_lshl_b32 s3, s3, 5
 v_mfma_f32_16x16x32_bf16 v[52:55], a[108:111], a[44:47], v[52:55]
 ds_read_b64_tr_b16 a[124:125], v14 offset:30720
 s_lshr_b32 s99, s2, 3
 s_cmp_eq_u32 s70, 13
 s_cbranch_scc1 L_cap13
L_capb13:
 v_mfma_f32_16x16x32_bf16 v[52:55], a[104:107], a[40:43], v[52:55]
 ds_read_b64_tr_b16 a[126:127], v14 offset:30976
 s_add_u32 m0, s46, 77824
 s_waitcnt lgkmcnt(5)
 v_mfma_f32_16x16x32_bf16 v[56:59], a[104:107], a[48:51], v[56:59]
 buffer_load_dwordx4 v3, s[12:15], s32 offen lds
 s_add_u32 s3, s3, s99
 v_mfma_f32_16x16x32_bf16 v[56:59], a[108:111], a[52:55], v[56:59]
 s_add_u32 m0, s46, 81920
 s_cmp_eq_u32 s54, 0
 s_cselect_b32 s49, 0xff800000, 0
 v_mfma_f32_16x16x32_bf16 v[60:63], a[108:111], a[60:63], v[60:63]
 buffer_load_dwordx4 v4, s[12:15], s32 offen lds
 s_lshl_b32 s3, s3, 2
 v_mfma_f32_16x16x32_bf16 v[60:63], a[104:107], a[56:59], v[60:63]
 s_add_u32 s3, s3, s28
 s_movk_i32 s98, 512
 v_mfma_f32_16x16x32_bf16 v[76:79], a[112:115], a[56:59], v[76:79]
 ds_read_b64_tr_b16 a[96:97], v15 offset:28672
 s_sub_u32 s57, s87, 131072
 v_mfma_f32_16x16x32_bf16 v[76:79], a[116:119], a[60:63], v[76:79]
 ds_read_b64_tr_b16 a[98:99], v15 offset:28928
 s_lshl_b32 s57, s57, 2
 v_mfma_f32_16x16x32_bf16 v[72:75], a[116:119], a[52:55], v[72:75]
 ds_read_b64_tr_b16 a[100:101], v15 offset:30720
 s_add_u32 s57, s57, 27262976
 v_mfma_f32_16x16x32_bf16 v[72:75], a[112:115], a[48:51], v[72:75]
 ds_read_b64_tr_b16 a[102:103], v15 offset:30976
 s_add_u32 m0, s46, 86016
 v_mfma_f32_16x16x32_bf16 v[68:71], a[112:115], a[40:43], v[68:71]
 buffer_load_dwordx4 v5, s[12:15], s32 offen lds
 v_and_b32 v36, 15, v0
 v_mfma_f32_16x16x32_bf16 v[68:71], a[116:119], a[44:47], v[68:71]
 s_add_u32 m0, s39, 32768
 s_mov_b32 s12, s68
 s_and_b32 s13, s69, 0xffff
 v_mfma_f32_16x16x32_bf16 v[64:67], a[116:119], a[36:39], v[64:67]
 buffer_load_dwordx4 v1, s[8:11], s31 offen lds
 s_mov_b32 s14, 0x200000
 v_mfma_f32_16x16x32_bf16 v[64:67], a[112:115], a[32:35], v[64:67]
 s_cmp_eq_u32 s28, 3
 s_cselect_b32 s98, 64000, s98
 s_waitcnt lgkmcnt(4)
 v_mfma_f32_16x16x32_bf16 v[80:83], a[120:123], a[32:35], v[80:83]
 ds_read_b64_tr_b16 a[104:105], v14 offset:32768
 s_lshl_b32 s50, s98, 2
 v_mfma_f32_16x16x32_bf16 v[80:83], a[124:127], a[36:39], v[80:83]
 ds_read_b64_tr_b16 a[106:107], v14 offset:33024
 s_add_u32 s50, s50, s57
 v_mfma_f32_16x16x32_bf16 v[84:87], a[124:127], a[44:47], v[84:87]
 ds_read_b64_tr_b16 a[108:109], v14 offset:34816
 s_add_u32 s98, s98, s87
 v_mfma_f32_16x16x32_bf16 v[84:87], a[120:123], a[40:43], v[84:87]
 ds_read_b64_tr_b16 a[110:111], v14 offset:35072
 s_add_u32 m0, s39, 33792
 v_mfma_f32_16x16x32_bf16 v[88:91], a[120:123], a[48:51], v[88:91]
 buffer_load_dwordx4 v2, s[8:11], s31 offen lds
 s_add_u32 s37, s31, 32768
 v_mfma_f32_16x16x32_bf16 v[88:91], a[124:127], a[52:55], v[88:91]
 s_add_u32 m0, s39, 34816
 s_min_u32 s48, s54, 1
 v_lshl_add_u32 v22, v36, 2, s96
 v_mfma_f32_16x16x32_bf16 v[92:95], a[124:127], a[60:63], v[92:95]
 buffer_load_dwordx4 v1, s[8:11], s37 offen lds
 v_and_b32 v37, 1, v0
 v_mfma_f32_16x16x32_bf16 v[92:95], a[120:123], a[56:59], v[92:95]
 ds_read2_b32 v[32:33], v22 offset0:64 offset1:144
 s_waitcnt lgkmcnt(5)
 v_mfma_f32_16x16x32_bf16 v[108:111], a[96:99], a[56:59], v[108:111]
 ds_read_b64_tr_b16 a[112:113], v15 offset:32768
 v_lshl_add_u32 v38, v19, 2, v37
 v_mfma_f32_16x16x32_bf16 v[108:111], a[100:103], a[60:63], v[108:111]
 ds_read_b64_tr_b16 a[114:115], v15 offset:33024
 v_add_u32 v39, 2, v38
 v_mfma_f32_16x16x32_bf16 v[104:107], a[100:103], a[52:55], v[104:107]
 ds_read_b64_tr_b16 a[116:117], v15 offset:34816
 v_cmp_eq_u32 s[6:7], 1, v37
 v_mfma_f32_16x16x32_bf16 v[104:107], a[96:99], a[48:51], v[104:107]
 ds_read_b64_tr_b16 a[118:119], v15 offset:35072
 s_add_u32 m0, s39, 35840
 v_mfma_f32_16x16x32_bf16 v[100:103], a[96:99], a[40:43], v[100:103]
 buffer_load_dwordx4 v2, s[8:11], s37 offen lds
 s_add_u32 s37, s31, 65536
 v_mfma_f32_16x16x32_bf16 v[100:103], a[100:103], a[44:47], v[100:103]
 s_add_u32 m0, s39, 36864
 ds_read2_b32 v[26:27], v22 offset0:16 offset1:96
 v_mfma_f32_16x16x32_bf16 v[96:99], a[100:103], a[36:39], v[96:99]
 buffer_load_dwordx4 v1, s[8:11], s37 offen lds
 v_cmp_le_u32 s[52:53], v38, v36
 v_mfma_f32_16x16x32_bf16 v[96:99], a[96:99], a[32:35], v[96:99]
 s_waitcnt vmcnt(8)
 s_barrier
 s_waitcnt lgkmcnt(6)
 v_mfma_f32_16x16x32_bf16 v[112:115], a[32:35], a[104:107], v[112:115]
 ds_read_b64_tr_b16 a[120:121], v14 offset:0
 v_cmp_le_u32 s[4:5], v39, v36
 v_mfma_f32_16x16x32_bf16 v[112:115], a[36:39], a[108:111], v[112:115]
 ds_read_b64_tr_b16 a[122:123], v14 offset:256
 v_add_u32 v40, 16, v38
 v_mfma_f32_16x16x32_bf16 v[116:119], a[44:47], a[108:111], v[116:119]
 ds_read_b64_tr_b16 a[124:125], v14 offset:2048
 v_add_u32 v41, 16, v39
 v_mfma_f32_16x16x32_bf16 v[116:119], a[40:43], a[104:107], v[116:119]
 ds_read_b64_tr_b16 a[126:127], v14 offset:2304
 s_add_u32 m0, s39, 37888
 v_mfma_f32_16x16x32_bf16 v[120:123], a[48:51], a[104:107], v[120:123]
 ds_read_b128 a[64:67], v10 offset:0
 buffer_load_dwordx4 v2, s[8:11], s37 offen lds
 v_mfma_f32_16x16x32_bf16 v[120:123], a[52:55], a[108:111], v[120:123]
 ds_read_b128 a[68:71], v11 offset:0
 s_add_u32 s37, s31, 98304
 s_add_u32 m0, s39, 38912
 v_mfma_f32_16x16x32_bf16 v[124:127], a[60:63], a[108:111], v[124:127]
 ds_read_b128 a[76:79], v11 offset:2048
 buffer_load_dwordx4 v1, s[8:11], s37 offen lds
 v_mfma_f32_16x16x32_bf16 v[124:127], a[56:59], a[104:107], v[124:127]
 ds_read_b128 a[72:75], v10 offset:2048
 s_waitcnt lgkmcnt(9)
 v_mfma_f32_16x16x32_bf16 v[140:143], a[56:59], a[112:115], v[140:143]
 ds_read_b64_tr_b16 a[96:97], v15 offset:0
 v_cndmask_b32 v38, v38, v40, s[52:53]
 v_mfma_f32_16x16x32_bf16 v[140:143], a[60:63], a[116:119], v[140:143]
 ds_read_b64_tr_b16 a[98:99], v15 offset:256
 v_cndmask_b32 v39, v39, v41, s[4:5]
 v_mfma_f32_16x16x32_bf16 v[136:139], a[52:55], a[116:119], v[136:139]
 ds_read_b64_tr_b16 a[100:101], v15 offset:2048
 v_lshl_add_u32 v23, v38, 2, s96
 v_mfma_f32_16x16x32_bf16 v[136:139], a[48:51], a[112:115], v[136:139]
 ds_read_b64_tr_b16 a[102:103], v15 offset:2304
 s_add_u32 m0, s39, 39936
 v_mfma_f32_16x16x32_bf16 v[132:135], a[40:43], a[112:115], v[132:135]
 ds_read_b128 a[80:83], v10 offset:4096
 buffer_load_dwordx4 v2, s[8:11], s37 offen lds
 v_mfma_f32_16x16x32_bf16 v[132:135], a[44:47], a[116:119], v[132:135]
 ds_read_b128 a[84:87], v11 offset:4096
 s_add_u32 m0, s47, 102400
 v_mfma_f32_16x16x32_bf16 v[128:131], a[36:39], a[116:119], v[128:131]
 ds_read_b128 a[92:95], v11 offset:6144
 buffer_load_dwordx4 v6, s[16:19], s33 offen lds
 v_mfma_f32_16x16x32_bf16 v[128:131], a[32:35], a[112:115], v[128:131]
 ds_read_b128 a[88:91], v10 offset:6144
 s_waitcnt lgkmcnt(8)
 v_mfma_f32_16x16x32_bf16 v[48:51], a[120:123], a[64:67], v[48:51]
 ds_read_b64_tr_b16 a[104:105], v14 offset:4096
 v_lshl_add_u32 v24, v39, 2, s96
 v_mfma_f32_16x16x32_bf16 v[48:51], a[124:127], a[68:71], v[48:51]
 ds_read_b64_tr_b16 a[106:107], v14 offset:4352
 v_and_b32 v38, 7, v0
 v_mfma_f32_16x16x32_bf16 v[52:55], a[124:127], a[76:79], v[52:55]
 ds_read_b64_tr_b16 a[108:109], v14 offset:6144
 v_xor_b32 v39, 1, v38
 s_cmp_eq_u32 s70, 14
 s_cbranch_scc1 L_cap14
L_capb14:
 v_mfma_f32_16x16x32_bf16 v[52:55], a[120:123], a[72:75], v[52:55]
 ds_read_b64_tr_b16 a[110:111], v14 offset:6400
 s_add_u32 m0, s47, 103424
 s_waitcnt lgkmcnt(4)
 v_mfma_f32_16x16x32_bf16 v[56:59], a[120:123], a[80:83], v[56:59]
 buffer_load_dwordx4 v7, s[16:19], s33 offen lds
 v_cmp_eq_u32 vcc, s63, v38
 v_mfma_f32_16x16x32_bf16 v[56:59], a[124:127], a[84:87], v[56:59]
 s_add_u32 m0, s47, 104448
 ds_read2_b32 v[28:29], v22 offset0:32 offset1:112
 v_mfma_f32_16x16x32_bf16 v[60:63], a[124:127], a[92:95], v[60:63]
 buffer_load_dwordx4 v8, s[24:27], s33 offen lds
 s_mov_b32 s16, s76
 v_mfma_f32_16x16x32_bf16 v[60:63], a[120:123], a[88:91], v[60:63]
 ds_read2_b32 v[30:31], v22 offset0:48 offset1:128
 v_mfma_f32_16x16x32_bf16 v[76:79], a[96:99], a[88:91], v[76:79]
 ds_read_b64_tr_b16 a[112:113], v15 offset:4096
 s_and_b32 s17, s77, 0xffff
 v_mfma_f32_16x16x32_bf16 v[76:79], a[100:103], a[92:95], v[76:79]
 ds_read_b64_tr_b16 a[114:115], v15 offset:4352
 s_mov_b32 s18, 0x700000
 v_mfma_f32_16x16x32_bf16 v[72:75], a[100:103], a[84:87], v[72:75]
 ds_read_b64_tr_b16 a[116:117], v15 offset:6144
 v_cndmask_b32 v38, v38, v39, vcc
 v_mfma_f32_16x16x32_bf16 v[72:75], a[96:99], a[80:83], v[72:75]
 ds_read_b64_tr_b16 a[118:119], v15 offset:6400
 s_add_u32 m0, s47, 105472
 v_mfma_f32_16x16x32_bf16 v[68:71], a[96:99], a[72:75], v[68:71]
 buffer_load_dwordx4 v9, s[24:27], s33 offen lds
 v_lshlrev_b32 v18, 2, v38
 v_mfma_f32_16x16x32_bf16 v[68:71], a[100:103], a[76:79], v[68:71]
 s_lshl_b32 s32, s3, 11
 s_mul_i32 s33, s3, 7168
 s_mov_b32 s24, s20
 v_mfma_f32_16x16x32_bf16 v[64:67], a[100:103], a[68:71], v[64:67]
 s_mov_b32 s25, s21
 s_cmp_eq_u32 s54, 0
 s_cselect_b32 s26, 0, s22
 v_mfma_f32_16x16x32_bf16 v[64:67], a[96:99], a[64:67], v[64:67]
 s_waitcnt lgkmcnt(6)
 v_min_u32 v44, 15, v0
 v_lshlrev_b32 v44, 7, v44
 v_mfma_f32_16x16x32_bf16 v[80:83], a[104:107], a[64:67], v[80:83]
 ds_read_b64_tr_b16 a[120:121], v14 offset:8192
 v_min_u32 v45, 55, v0
 v_mfma_f32_16x16x32_bf16 v[80:83], a[108:111], a[68:71], v[80:83]
 ds_read_b64_tr_b16 a[122:123], v14 offset:8448
 v_lshlrev_b32 v45, 7, v45
 v_mfma_f32_16x16x32_bf16 v[84:87], a[108:111], a[76:79], v[84:87]
 ds_read_b64_tr_b16 a[124:125], v14 offset:10240
 v_mov_b32 v46, 0xffff
 v_mfma_f32_16x16x32_bf16 v[84:87], a[104:107], a[72:75], v[84:87]
 ds_read_b64_tr_b16 a[126:127], v14 offset:10496
 v_mov_b32 v47, 0xffff0000
 v_mfma_f32_16x16x32_bf16 v[88:91], a[104:107], a[80:83], v[88:91]
 buffer_load_dword a255, v45, s[16:19], s33 offen
 v_cndmask_b32 v47, v46, v47, s[6:7]
 v_mfma_f32_16x16x32_bf16 v[88:91], a[108:111], a[84:87], v[88:91]
 buffer_load_dword a253, v44, s[12:15], s32 offen
 v_cndmask_b32 v12, 0, v47, s[52:53]
 v_mfma_f32_16x16x32_bf16 v[92:95], a[108:111], a[92:95], v[92:95]
 s_cmp_lt_u32 s28, 2
 s_cselect_b32 s12, s12, s16
 s_cselect_b32 s13, s13, s17
 v_mfma_f32_16x16x32_bf16 v[92:95], a[104:107], a[88:91], v[92:95]
 s_cmp_lt_u32 s28, 2
 s_cselect_b32 s14, s14, s18
 s_waitcnt lgkmcnt(4)
 v_mfma_f32_16x16x32_bf16 v[108:111], a[112:115], a[88:91], v[108:111]
 ds_read_b64_tr_b16 a[96:97], v15 offset:8192
 v_cndmask_b32 v13, v47, 0, s[52:53]
 v_mfma_f32_16x16x32_bf16 v[108:111], a[116:119], a[92:95], v[108:111]
 ds_read_b64_tr_b16 a[98:99], v15 offset:8448
 v_cndmask_b32 v17, 0, v47, s[4:5]
 v_mfma_f32_16x16x32_bf16 v[104:107], a[116:119], a[84:87], v[104:107]
 ds_read_b64_tr_b16 a[100:101], v15 offset:10240
 v_cndmask_b32 v6, v47, 0, s[4:5]
 v_mfma_f32_16x16x32_bf16 v[104:107], a[112:115], a[80:83], v[104:107]
 ds_read_b64_tr_b16 a[102:103], v15 offset:10496
 v_lshlrev_b32 v3, 4, v19
 v_mfma_f32_16x16x32_bf16 v[100:103], a[112:115], a[72:75], v[100:103]
 v_add_u32 v4, s96, v3
 v_add_u32 v3, 151552, v3
 v_mfma_f32_16x16x32_bf16 v[100:103], a[116:119], a[76:79], v[100:103]
 v_lshlrev_b32 v5, 2, v36
 v_add_u32 v5, 151552, v5
 v_mfma_f32_16x16x32_bf16 v[96:99], a[116:119], a[68:71], v[96:99]
 ds_read_b128 v[36:39], v3 offset:128
 v_lshlrev_b32 v8, 4, v0
 v_mfma_f32_16x16x32_bf16 v[96:99], a[112:115], a[64:67], v[96:99]
 s_waitcnt vmcnt(6)
 s_barrier
 s_waitcnt lgkmcnt(5)
 v_mfma_f32_16x16x32_bf16 v[112:115], a[64:67], a[120:123], v[112:115]
 ds_read_b64_tr_b16 a[104:105], v14 offset:16384
 v_lshlrev_b32 v9, 3, v0
 v_mfma_f32_16x16x32_bf16 v[112:115], a[68:71], a[124:127], v[112:115]
 ds_read_b64_tr_b16 a[106:107], v14 offset:16640
 v_mov_b32 v1, 1
 v_mfma_f32_16x16x32_bf16 v[116:119], a[76:79], a[124:127], v[116:119]
 ds_read_b64_tr_b16 a[108:109], v14 offset:18432
 v_cmp_eq_u32 vcc, 0, v0
 v_mfma_f32_16x16x32_bf16 v[116:119], a[72:75], a[120:123], v[116:119]
 ds_read_b64_tr_b16 a[110:111], v14 offset:18688
 v_bfrev_b32 v2, 1
 v_mfma_f32_16x16x32_bf16 v[120:123], a[80:83], a[120:123], v[120:123]
 ds_read_b128 a[0:3], v10 offset:32768
 v_cndmask_b32 v2, v2, v0, vcc
 v_mfma_f32_16x16x32_bf16 v[120:123], a[84:87], a[124:127], v[120:123]
 ds_read_b128 a[4:7], v11 offset:32768
 v_mfma_f32_16x16x32_bf16 v[124:127], a[92:95], a[124:127], v[124:127]
 ds_read_b128 a[12:15], v11 offset:34816
 v_mfma_f32_16x16x32_bf16 v[124:127], a[88:91], a[120:123], v[124:127]
 ds_read_b128 a[8:11], v10 offset:34816
 s_waitcnt lgkmcnt(9)
 v_mfma_f32_16x16x32_bf16 v[140:143], a[88:91], a[96:99], v[140:143]
 ds_read_b64_tr_b16 a[112:113], v15 offset:16384
 v_mfma_f32_16x16x32_bf16 v[140:143], a[92:95], a[100:103], v[140:143]
 ds_read_b64_tr_b16 a[114:115], v15 offset:16640
 v_mfma_f32_16x16x32_bf16 v[136:139], a[84:87], a[100:103], v[136:139]
 ds_read_b64_tr_b16 a[116:117], v15 offset:18432
 v_mfma_f32_16x16x32_bf16 v[136:139], a[80:83], a[96:99], v[136:139]
 ds_read_b64_tr_b16 a[118:119], v15 offset:18688
 v_mfma_f32_16x16x32_bf16 v[132:135], a[72:75], a[96:99], v[132:135]
 ds_read_b128 a[16:19], v10 offset:36864
 v_mfma_f32_16x16x32_bf16 v[132:135], a[76:79], a[100:103], v[132:135]
 ds_read_b128 a[20:23], v11 offset:36864
 v_mfma_f32_16x16x32_bf16 v[128:131], a[68:71], a[100:103], v[128:131]
 ds_read_b128 a[28:31], v11 offset:38912
 v_mfma_f32_16x16x32_bf16 v[128:131], a[64:67], a[96:99], v[128:131]
 ds_read_b128 a[24:27], v10 offset:38912
 s_waitcnt lgkmcnt(8)
 v_mfma_f32_16x16x32_bf16 v[80:83], a[104:107], a[0:3], v[80:83]
 ds_read_b64_tr_b16 a[120:121], v14 offset:20480
 v_mfma_f32_16x16x32_bf16 v[80:83], a[108:111], a[4:7], v[80:83]
 ds_read_b64_tr_b16 a[122:123], v14 offset:20736
 v_mfma_f32_16x16x32_bf16 v[84:87], a[108:111], a[12:15], v[84:87]
 ds_read_b64_tr_b16 a[124:125], v14 offset:22528
 s_cmp_eq_u32 s70, 15
 s_cbranch_scc1 L_cap15
L_capb15:
 v_mfma_f32_16x16x32_bf16 v[84:87], a[104:107], a[8:11], v[84:87]
 ds_read_b64_tr_b16 a[126:127], v14 offset:22784
 s_waitcnt lgkmcnt(4)
 v_mfma_f32_16x16x32_bf16 v[88:91], a[104:107], a[16:19], v[88:91]
 ds_read_b128 v[40:43], v3 offset:192
 v_mfma_f32_16x16x32_bf16 v[88:91], a[108:111], a[20:23], v[88:91]
 ds_read2_b32 v[34:35], v5 offset0:64 offset1:80
 v_mfma_f32_16x16x32_bf16 v[92:95], a[108:111], a[28:31], v[92:95]
 ds_read_b128 v[44:47], v4 offset:576
 v_mfma_f32_16x16x32_bf16 v[92:95], a[104:107], a[24:27], v[92:95]
 s_waitcnt vmcnt(2)
 s_barrier
 v_mfma_f32_16x16x32_bf16 v[108:111], a[112:115], a[24:27], v[108:111]
 ds_read_b64_tr_b16 a[96:97], v15 offset:20480
 s_nop 3
 v_fmac_f32 v92, v33, v36
 v_mfma_f32_16x16x32_bf16 v[108:111], a[116:119], a[28:31], v[108:111]
 ds_read_b64_tr_b16 a[98:99], v15 offset:20736
 v_fmac_f32 v93, v33, v37
 v_mfma_f32_16x16x32_bf16 v[104:107], a[116:119], a[20:23], v[104:107]
 ds_read_b64_tr_b16 a[100:101], v15 offset:22528
 v_fmac_f32 v94, v33, v38
 v_mfma_f32_16x16x32_bf16 v[104:107], a[112:115], a[16:19], v[104:107]
 ds_read_b64_tr_b16 a[102:103], v15 offset:22784
 v_fmac_f32 v95, v33, v39
 v_mfma_f32_16x16x32_bf16 v[100:103], a[112:115], a[8:11], v[100:103]
 v_cvt_pk_bf16_f32 v92, v92, v93
 v_cvt_pk_bf16_f32 v93, v94, v95
 v_mfma_f32_16x16x32_bf16 v[100:103], a[116:119], a[12:15], v[100:103]
 v_fmac_f32 v80, v27, v36
 v_fmac_f32 v81, v27, v37
 v_mfma_f32_16x16x32_bf16 v[96:99], a[116:119], a[4:7], v[96:99]
 v_fmac_f32 v82, v27, v38
 v_fmac_f32 v83, v27, v39
 v_mfma_f32_16x16x32_bf16 v[96:99], a[112:115], a[0:3], v[96:99]
 s_waitcnt lgkmcnt(7)
 v_cvt_pk_bf16_f32 v80, v80, v81
 v_cvt_pk_bf16_f32 v81, v82, v83
 v_mfma_f32_16x16x32_bf16 v[112:115], a[0:3], a[120:123], v[112:115]
 ds_read_b64_tr_b16 a[104:105], v14 offset:12288
 s_waitcnt lgkmcnt(7)
 v_fmac_f32 v108, v33, v40
 v_mfma_f32_16x16x32_bf16 v[112:115], a[4:7], a[124:127], v[112:115]
 ds_read_b64_tr_b16 a[106:107], v14 offset:12544
 v_fmac_f32 v109, v33, v41
 v_mfma_f32_16x16x32_bf16 v[116:119], a[12:15], a[124:127], v[116:119]
 ds_read_b64_tr_b16 a[108:109], v14 offset:14336
 v_fmac_f32 v110, v33, v42
 v_mfma_f32_16x16x32_bf16 v[116:119], a[8:11], a[120:123], v[116:119]
 ds_read_b64_tr_b16 a[110:111], v14 offset:14592
 v_fmac_f32 v111, v33, v43
 v_mfma_f32_16x16x32_bf16 v[120:123], a[16:19], a[120:123], v[120:123]
 v_cvt_pk_bf16_f32 v94, v108, v109
 v_cvt_pk_bf16_f32 v95, v110, v111
 v_mfma_f32_16x16x32_bf16 v[120:123], a[20:23], a[124:127], v[120:123]
 buffer_store_dwordx4 v[92:95], v8, s[20:23], s50 offen sc1
 v_fmac_f32 v96, v27, v40
 v_mfma_f32_16x16x32_bf16 v[124:127], a[28:31], a[124:127], v[124:127]
 v_fmac_f32 v97, v27, v41
 v_fmac_f32 v98, v27, v42
 v_mfma_f32_16x16x32_bf16 v[124:127], a[24:27], a[120:123], v[124:127]
 s_waitcnt lgkmcnt(4)
 v_fmac_f32 v99, v27, v43
 v_cvt_pk_bf16_f32 v82, v96, v97
 v_mfma_f32_16x16x32_bf16 v[140:143], a[24:27], a[96:99], v[140:143]
 ds_read_b64_tr_b16 a[112:113], v15 offset:12288
 v_cvt_pk_bf16_f32 v83, v98, v99
 v_mfma_f32_16x16x32_bf16 v[140:143], a[28:31], a[100:103], v[140:143]
 ds_read_b64_tr_b16 a[114:115], v15 offset:12544
 v_fmac_f32 v124, v44, v34
 v_mfma_f32_16x16x32_bf16 v[136:139], a[20:23], a[100:103], v[136:139]
 ds_read_b64_tr_b16 a[116:117], v15 offset:14336
 v_fmac_f32 v125, v45, v34
 v_mfma_f32_16x16x32_bf16 v[136:139], a[16:19], a[96:99], v[136:139]
 ds_read_b64_tr_b16 a[118:119], v15 offset:14592
 v_fmac_f32 v126, v46, v34
 v_mfma_f32_16x16x32_bf16 v[132:135], a[8:11], a[96:99], v[132:135]
 ds_read_b128 v[96:99], v4 offset:512
 v_fmac_f32 v127, v47, v34
 v_mfma_f32_16x16x32_bf16 v[132:135], a[12:15], a[100:103], v[132:135]
 v_cvt_pk_bf16_f32 v127, v126, v127
 v_cvt_pk_bf16_f32 v126, v124, v125
 v_mfma_f32_16x16x32_bf16 v[128:131], a[4:7], a[100:103], v[128:131]
 buffer_store_dwordx2 v[126:127], v9, s[20:23], s50 offen offset:1024 sc1
 v_fmac_f32 v84, v29, v36
 v_mfma_f32_16x16x32_bf16 v[128:131], a[0:3], a[96:99], v[128:131]
 s_waitcnt lgkmcnt(5)
 v_fmac_f32 v85, v29, v37
 v_fmac_f32 v86, v29, v38
 v_mfma_f32_16x16x32_bf16 v[48:51], a[104:107], a[0:3], v[48:51]
 ds_read_b64_tr_b16 a[120:121], v16 offset:16384
 v_fmac_f32 v140, v44, v35
 v_mfma_f32_16x16x32_bf16 v[48:51], a[108:111], a[4:7], v[48:51]
 ds_read_b64_tr_b16 a[122:123], v16 offset:18176
 v_fmac_f32 v141, v45, v35
 v_mfma_f32_16x16x32_bf16 v[52:55], a[108:111], a[12:15], v[52:55]
 ds_read_b64_tr_b16 a[124:125], v16 offset:23552
 v_fmac_f32 v142, v46, v35
 v_mfma_f32_16x16x32_bf16 v[52:55], a[104:107], a[8:11], v[52:55]
 ds_read_b64_tr_b16 a[126:127], v16 offset:25344
 v_fmac_f32 v143, v47, v35
 v_mfma_f32_16x16x32_bf16 v[56:59], a[104:107], a[16:19], v[56:59]
 v_cvt_pk_bf16_f32 v143, v142, v143
 v_cvt_pk_bf16_f32 v142, v140, v141
 v_mfma_f32_16x16x32_bf16 v[56:59], a[108:111], a[20:23], v[56:59]
 buffer_store_dwordx2 v[142:143], v9, s[20:23], s50 offen offset:1536 sc1
 v_fmac_f32 v87, v29, v39
 v_mfma_f32_16x16x32_bf16 v[60:63], a[108:111], a[28:31], v[60:63]
 v_fmac_f32 v100, v29, v40
 v_fmac_f32 v101, v29, v41
 v_mfma_f32_16x16x32_bf16 v[60:63], a[104:107], a[24:27], v[60:63]
 s_waitcnt lgkmcnt(5)
 v_fmac_f32 v102, v29, v42
 v_fmac_f32 v103, v29, v43
 v_mfma_f32_16x16x32_bf16 v[76:79], a[112:115], a[24:27], v[76:79]
 ds_read_b64_tr_b16 a[96:97], v16 offset:16416
 v_cvt_pk_bf16_f32 v84, v84, v85
 v_mfma_f32_16x16x32_bf16 v[76:79], a[116:119], a[28:31], v[76:79]
 ds_read_b64_tr_b16 a[98:99], v16 offset:18208
 v_cvt_pk_bf16_f32 v85, v86, v87
 v_mfma_f32_16x16x32_bf16 v[72:75], a[116:119], a[20:23], v[72:75]
 ds_read_b64_tr_b16 a[100:101], v16 offset:23584
 v_cvt_pk_bf16_f32 v86, v100, v101
 v_mfma_f32_16x16x32_bf16 v[72:75], a[112:115], a[16:19], v[72:75]
 ds_read_b64_tr_b16 a[102:103], v16 offset:25376
 v_cvt_pk_bf16_f32 v87, v102, v103
 v_mfma_f32_16x16x32_bf16 v[68:71], a[112:115], a[8:11], v[68:71]
 ds_read_b128 v[100:103], v4 offset:448
 v_fmac_f32 v88, v31, v36
 v_mfma_f32_16x16x32_bf16 v[68:71], a[116:119], a[12:15], v[68:71]
 v_fmac_f32 v89, v31, v37
 v_fmac_f32 v90, v31, v38
 v_mfma_f32_16x16x32_bf16 v[64:67], a[116:119], a[4:7], v[64:67]
 v_fmac_f32 v91, v31, v39
 v_fmac_f32 v104, v31, v40
 v_mfma_f32_16x16x32_bf16 v[64:67], a[112:115], a[0:3], v[64:67]
 s_waitcnt lgkmcnt(5)
 v_fmac_f32 v105, v31, v41
 v_fmac_f32 v106, v31, v42
 v_mfma_f32_16x16x32_bf16 v[144:147], a[120:123], a[32:35], v[144:147]
 ds_read_b64_tr_b16 a[104:105], v16 offset:32768
 v_fmac_f32 v107, v31, v43
 v_mfma_f32_16x16x32_bf16 v[144:147], a[124:127], a[36:39], v[144:147]
 ds_read_b64_tr_b16 a[106:107], v16 offset:34560
 v_cvt_pk_bf16_f32 v88, v88, v89
 v_mfma_f32_16x16x32_bf16 v[148:151], a[124:127], a[44:47], v[148:151]
 ds_read_b64_tr_b16 a[108:109], v16 offset:39936
 v_cvt_pk_bf16_f32 v89, v90, v91
 v_mfma_f32_16x16x32_bf16 v[148:151], a[120:123], a[40:43], v[148:151]
 ds_read_b64_tr_b16 a[110:111], v16 offset:41728
 v_cvt_pk_bf16_f32 v90, v104, v105
 v_mfma_f32_16x16x32_bf16 v[152:155], a[120:123], a[48:51], v[152:155]
 v_cvt_pk_bf16_f32 v91, v106, v107
 v_fmac_f32 v120, v96, v34
 v_mfma_f32_16x16x32_bf16 v[152:155], a[124:127], a[52:55], v[152:155]
 ds_read_b128 v[104:107], v4 offset:384
 v_fmac_f32 v121, v97, v34
 v_mfma_f32_16x16x32_bf16 v[156:159], a[124:127], a[60:63], v[156:159]
 ds_read_b128 v[36:39], v3
 v_fmac_f32 v122, v98, v34
 v_mfma_f32_16x16x32_bf16 v[156:159], a[120:123], a[56:59], v[156:159]
 ds_read_b128 v[40:43], v3 offset:64
 s_waitcnt lgkmcnt(8)
 v_mfma_f32_16x16x32_bf16 v[172:175], a[96:99], a[56:59], v[172:175]
 ds_read_b64_tr_b16 a[112:113], v16 offset:32800
 v_fmac_f32 v123, v99, v34
 v_mfma_f32_16x16x32_bf16 v[172:175], a[100:103], a[60:63], v[172:175]
 ds_read_b64_tr_b16 a[114:115], v16 offset:34592
 v_fmac_f32 v136, v96, v35
 v_mfma_f32_16x16x32_bf16 v[168:171], a[100:103], a[52:55], v[168:171]
 ds_read_b64_tr_b16 a[116:117], v16 offset:39968
 v_fmac_f32 v137, v97, v35
 v_mfma_f32_16x16x32_bf16 v[168:171], a[96:99], a[48:51], v[168:171]
 ds_read_b64_tr_b16 a[118:119], v16 offset:41760
 v_fmac_f32 v138, v98, v35
 v_mfma_f32_16x16x32_bf16 v[164:167], a[96:99], a[40:43], v[164:167]
 v_fmac_f32 v139, v99, v35
 v_cvt_pk_bf16_f32 v125, v122, v123
 v_mfma_f32_16x16x32_bf16 v[164:167], a[100:103], a[44:47], v[164:167]
 v_cvt_pk_bf16_f32 v124, v120, v121
 v_cvt_pk_bf16_f32 v141, v138, v139
 v_mfma_f32_16x16x32_bf16 v[160:163], a[100:103], a[36:39], v[160:163]
 v_cvt_pk_bf16_f32 v140, v136, v137
 s_waitcnt lgkmcnt(11)
 v_fmac_f32 v116, v100, v34
 v_mfma_f32_16x16x32_bf16 v[160:163], a[96:99], a[32:35], v[160:163]
 s_waitcnt lgkmcnt(7)
 v_fmac_f32 v117, v101, v34
 v_fmac_f32 v118, v102, v34
 v_mfma_f32_16x16x32_bf16 v[144:147], a[104:107], a[64:67], v[144:147]
 ds_read_b64_tr_b16 a[120:121], v16 offset:0
 v_fmac_f32 v119, v103, v34
 v_mfma_f32_16x16x32_bf16 v[144:147], a[108:111], a[68:71], v[144:147]
 ds_read_b64_tr_b16 a[122:123], v16 offset:1792
 v_fmac_f32 v132, v100, v35
 v_mfma_f32_16x16x32_bf16 v[148:151], a[108:111], a[76:79], v[148:151]
 ds_read_b64_tr_b16 a[124:125], v16 offset:7168
 v_fmac_f32 v133, v101, v35
 v_mfma_f32_16x16x32_bf16 v[148:151], a[104:107], a[72:75], v[148:151]
 ds_read_b64_tr_b16 a[126:127], v16 offset:8960
 v_fmac_f32 v134, v102, v35
 v_mfma_f32_16x16x32_bf16 v[152:155], a[104:107], a[80:83], v[152:155]
 v_fmac_f32 v135, v103, v35
 v_cvt_pk_bf16_f32 v123, v118, v119
 v_mfma_f32_16x16x32_bf16 v[152:155], a[108:111], a[84:87], v[152:155]
 v_cvt_pk_bf16_f32 v122, v116, v117
 v_cvt_pk_bf16_f32 v139, v134, v135
 v_mfma_f32_16x16x32_bf16 v[156:159], a[108:111], a[92:95], v[156:159]
 v_cvt_pk_bf16_f32 v138, v132, v133
 s_waitcnt lgkmcnt(10)
 v_fmac_f32 v112, v104, v34
 v_mfma_f32_16x16x32_bf16 v[156:159], a[104:107], a[88:91], v[156:159]
 s_barrier
 s_waitcnt lgkmcnt(4)
 v_mfma_f32_16x16x32_bf16 v[172:175], a[112:115], a[88:91], v[172:175]
L_pg7:
 s_cbranch_execz L_pg11
 ds_read_b64_tr_b16 a[96:97], v16 offset:32
 v_fmac_f32 v113, v105, v34
 v_mfma_f32_16x16x32_bf16 v[172:175], a[116:119], a[92:95], v[172:175]
 ds_read_b64_tr_b16 a[98:99], v16 offset:1824
 v_fmac_f32 v114, v106, v34
 v_mfma_f32_16x16x32_bf16 v[168:171], a[116:119], a[84:87], v[168:171]
 ds_read_b64_tr_b16 a[100:101], v16 offset:7200
 v_fmac_f32 v115, v107, v34
 v_mfma_f32_16x16x32_bf16 v[168:171], a[112:115], a[80:83], v[168:171]
 ds_read_b64_tr_b16 a[102:103], v16 offset:8992
 v_fmac_f32 v128, v104, v35
 v_mfma_f32_16x16x32_bf16 v[164:167], a[112:115], a[72:75], v[164:167]
 v_fmac_f32 v129, v105, v35
 v_fmac_f32 v130, v106, v35
 v_mfma_f32_16x16x32_bf16 v[164:167], a[116:119], a[76:79], v[164:167]
 s_mov_b32 s3, 0x3e8293ee
 v_fmac_f32 v131, v107, v35
 v_cvt_pk_bf16_f32 v121, v114, v115
 v_mfma_f32_16x16x32_bf16 v[160:163], a[116:119], a[68:71], v[160:163]
 v_cvt_pk_bf16_f32 v120, v112, v113
 v_cvt_pk_bf16_f32 v137, v130, v131
 v_mfma_f32_16x16x32_bf16 v[160:163], a[112:115], a[64:67], v[160:163]
 s_waitcnt lgkmcnt(4)
 v_cvt_pk_bf16_f32 v136, v128, v129
 v_fmac_f32 v52, v29, v36
 v_mfma_f32_16x16x32_bf16 v[144:147], a[120:123], a[0:3], v[144:147]
 ds_read_b64_tr_b16 a[104:105], v16 offset:16448
 v_fmac_f32 v53, v29, v37
 v_mfma_f32_16x16x32_bf16 v[144:147], a[124:127], a[4:7], v[144:147]
 ds_read_b64_tr_b16 a[106:107], v16 offset:18240
 v_fmac_f32 v54, v29, v38
 v_mfma_f32_16x16x32_bf16 v[148:151], a[124:127], a[12:15], v[148:151]
 ds_read_b64_tr_b16 a[108:109], v16 offset:23616
 v_fmac_f32 v55, v29, v39
 v_mfma_f32_16x16x32_bf16 v[148:151], a[120:123], a[8:11], v[148:151]
 ds_read_b64_tr_b16 a[110:111], v16 offset:25408
 v_fmac_f32 v68, v29, v40
 v_mfma_f32_16x16x32_bf16 v[152:155], a[120:123], a[16:19], v[152:155]
 v_fmac_f32 v69, v29, v41
 v_fmac_f32 v70, v29, v42
 v_mfma_f32_16x16x32_bf16 v[152:155], a[124:127], a[20:23], v[152:155]
 v_fmac_f32 v71, v29, v43
 v_cvt_pk_bf16_f32 v52, v52, v53
 v_mfma_f32_16x16x32_bf16 v[156:159], a[124:127], a[28:31], v[156:159]
 v_cvt_pk_bf16_f32 v53, v54, v55
 v_cvt_pk_bf16_f32 v54, v68, v69
 v_mfma_f32_16x16x32_bf16 v[156:159], a[120:123], a[24:27], v[156:159]
 s_waitcnt lgkmcnt(4)
 v_cvt_pk_bf16_f32 v55, v70, v71
 v_fmac_f32 v56, v31, v36
 v_mfma_f32_16x16x32_bf16 v[172:175], a[96:99], a[24:27], v[172:175]
 ds_read_b64_tr_b16 a[112:113], v16 offset:16480
 v_fmac_f32 v57, v31, v37
 v_mfma_f32_16x16x32_bf16 v[68:71], v[84:87], v[52:55], 0
 v_fmac_f32 v58, v31, v38
 v_fmac_f32 v59, v31, v39
 v_mfma_f32_16x16x32_bf16 v[100:103], v[80:83], v[52:55], 0
 v_fmac_f32 v72, v31, v40
 v_fmac_f32 v73, v31, v41
 v_mfma_f32_16x16x32_bf16 v[172:175], a[100:103], a[28:31], v[172:175]
 ds_read_b64_tr_b16 a[114:115], v16 offset:18272
 v_fmac_f32 v74, v31, v42
 v_mfma_f32_16x16x32_bf16 v[168:171], a[100:103], a[20:23], v[168:171]
 ds_read_b64_tr_b16 a[116:117], v16 offset:23648
 v_fmac_f32 v75, v31, v43
 v_mfma_f32_16x16x32_bf16 v[168:171], a[96:99], a[16:19], v[168:171]
 ds_read_b64_tr_b16 a[118:119], v16 offset:25440
 v_cvt_pk_bf16_f32 v56, v56, v57
 v_mfma_f32_16x16x32_bf16 v[164:167], a[96:99], a[8:11], v[164:167]
 v_cvt_pk_bf16_f32 v57, v58, v59
 v_cvt_pk_bf16_f32 v58, v72, v73
 v_mfma_f32_16x16x32_bf16 v[164:167], a[100:103], a[12:15], v[164:167]
 v_cvt_pk_bf16_f32 v59, v74, v75
 v_fmac_f32 v60, v33, v36
 v_mfma_f32_16x16x32_bf16 v[160:163], a[100:103], a[4:7], v[160:163]
 v_fmac_f32 v61, v33, v37
 v_fmac_f32 v62, v33, v38
 v_mfma_f32_16x16x32_bf16 v[72:75], v[88:91], v[56:59], 0
 v_fmac_f32 v63, v33, v39
 v_fmac_f32 v76, v33, v40
 v_mfma_f32_16x16x32_bf16 v[104:107], v[84:87], v[56:59], 0
 v_fmac_f32 v77, v33, v41
 v_fmac_f32 v78, v33, v42
 v_mfma_f32_16x16x32_bf16 v[160:163], a[96:99], a[0:3], v[160:163]
 s_waitcnt lgkmcnt(4)
 v_fmac_f32 v79, v33, v43
 v_cvt_pk_bf16_f32 v60, v60, v61
 v_mfma_f32_16x16x32_bf16 v[176:179], a[104:107], a[32:35], v[176:179]
 ds_read_b64_tr_b16 a[120:121], v16 offset:32832
 v_cvt_pk_bf16_f32 v61, v62, v63
 v_mfma_f32_16x16x32_bf16 v[176:179], a[108:111], a[36:39], v[176:179]
 ds_read_b64_tr_b16 a[122:123], v16 offset:34624
 v_cvt_pk_bf16_f32 v62, v76, v77
 v_mfma_f32_16x16x32_bf16 v[180:183], a[108:111], a[44:47], v[180:183]
 ds_read_b64_tr_b16 a[124:125], v16 offset:40000
 v_cvt_pk_bf16_f32 v63, v78, v79
 v_mfma_f32_16x16x32_bf16 v[180:183], a[104:107], a[40:43], v[180:183]
 ds_read_b64_tr_b16 a[126:127], v16 offset:41792
 v_fmac_f32 v48, v27, v36
 v_mfma_f32_16x16x32_bf16 v[76:79], v[92:95], v[60:63], 0
 v_fmac_f32 v49, v27, v37
 v_fmac_f32 v50, v27, v38
 v_mfma_f32_16x16x32_bf16 v[108:111], v[88:91], v[60:63], 0
 v_fmac_f32 v51, v27, v39
 v_fmac_f32 v64, v27, v40
 v_mfma_f32_16x16x32_bf16 v[184:187], a[104:107], a[48:51], v[184:187]
 s_add_u32 m0, s39, 0
 v_fmac_f32 v65, v27, v41
 v_fmac_f32 v66, v27, v42
 v_mfma_f32_16x16x32_bf16 v[184:187], a[108:111], a[52:55], v[184:187]
 buffer_load_dwordx4 v20, s[12:15], s66 offen lds
 v_fmac_f32 v67, v27, v43
 v_mfma_f32_16x16x32_bf16 v[188:191], a[108:111], a[60:63], v[188:191]
 s_add_u32 m0, s39, 1024
 ds_read2_b32 v[40:41], v23 offset0:0 offset1:16
 v_mfma_f32_16x16x32_bf16 v[188:191], a[104:107], a[56:59], v[188:191]
 buffer_load_dwordx4 v21, s[12:15], s66 offen lds
 s_waitcnt lgkmcnt(5)
 v_mfma_f32_16x16x32_bf16 v[204:207], a[112:115], a[56:59], v[204:207]
 ds_read_b64_tr_b16 a[96:97], v16 offset:32864
 s_add_u32 s66, s66, 16384
 v_mfma_f32_16x16x32_bf16 v[204:207], a[116:119], a[60:63], v[204:207]
 ds_read_b64_tr_b16 a[98:99], v16 offset:34656
 v_cvt_pk_bf16_f32 v48, v48, v49
 v_mfma_f32_16x16x32_bf16 v[200:203], a[116:119], a[52:55], v[200:203]
 ds_read_b64_tr_b16 a[100:101], v16 offset:40032
 v_cvt_pk_bf16_f32 v49, v50, v51
 v_mfma_f32_16x16x32_bf16 v[200:203], a[112:115], a[48:51], v[200:203]
 ds_read_b64_tr_b16 a[102:103], v16 offset:41824
 v_cvt_pk_bf16_f32 v50, v64, v65
 v_mfma_f32_16x16x32_bf16 v[196:199], a[112:115], a[40:43], v[196:199]
 s_add_u32 m0, s39, 2048
 ds_read2_b32 v[42:43], v24 offset0:0 offset1:16
 v_mfma_f32_16x16x32_bf16 v[196:199], a[116:119], a[44:47], v[196:199]
 buffer_load_dwordx4 v20, s[12:15], s66 offen lds
 v_cvt_pk_bf16_f32 v51, v66, v67
 v_mfma_f32_16x16x32_bf16 v[192:195], a[116:119], a[36:39], v[192:195]
 s_add_u32 m0, s39, 3072
 ds_read2_b32 v[44:45], v23 offset0:32 offset1:48
 v_mfma_f32_16x16x32_bf16 v[64:67], v[80:83], v[48:51], 0
 ds_read2_b32 v[46:47], v24 offset0:32 offset1:48
 v_mul_f32 v36, s3, v26
 v_mfma_f32_16x16x32_bf16 v[192:195], a[112:115], a[32:35], v[192:195]
 buffer_load_dwordx4 v21, s[12:15], s66 offen lds
 s_waitcnt lgkmcnt(8)
 v_mfma_f32_16x16x32_bf16 v[176:179], a[120:123], a[64:67], v[176:179]
 ds_read_b64_tr_b16 a[104:105], v16 offset:64
 v_mul_f32 v37, s3, v28
 v_mfma_f32_16x16x32_bf16 v[176:179], a[124:127], a[68:71], v[176:179]
 ds_read_b64_tr_b16 a[106:107], v16 offset:1856
 v_mul_f32 v38, s3, v30
 v_mfma_f32_16x16x32_bf16 v[180:183], a[124:127], a[76:79], v[180:183]
 ds_read_b64_tr_b16 a[108:109], v16 offset:7232
 v_mul_f32 v39, s3, v32
 v_mfma_f32_16x16x32_bf16 v[180:183], a[120:123], a[72:75], v[180:183]
 ds_read_b64_tr_b16 a[110:111], v16 offset:9024
 v_cndmask_b32 v68, v68, v69, s[6:7]
 v_mfma_f32_16x16x32_bf16 v[184:187], a[120:123], a[80:83], v[184:187]
 v_cndmask_b32 v70, v70, v71, s[6:7]
 v_cndmask_b32 v100, v100, v101, s[6:7]
 v_mfma_f32_16x16x32_bf16 v[184:187], a[124:127], a[84:87], v[184:187]
 v_cndmask_b32 v102, v102, v103, s[6:7]
 v_cndmask_b32 v68, v100, v68, s[52:53]
 v_mfma_f32_16x16x32_bf16 v[188:191], a[124:127], a[92:95], v[188:191]
 s_add_u32 m0, s39, 4096
 v_cndmask_b32 v69, v102, v70, s[4:5]
 s_waitcnt lgkmcnt(11)
 v_mul_f32 v68, v68, v41
 v_mfma_f32_16x16x32_bf16 v[188:191], a[120:123], a[88:91], v[188:191]
 buffer_load_dwordx4 v20, s[16:19], s67 offen lds
 s_waitcnt lgkmcnt(7)
 v_mfma_f32_16x16x32_bf16 v[204:207], a[96:99], a[88:91], v[204:207]
 ds_read_b64_tr_b16 a[112:113], v16 offset:96
 s_waitcnt lgkmcnt(7)
 v_mul_f32 v69, v69, v43
 v_mfma_f32_16x16x32_bf16 v[204:207], a[100:103], a[92:95], v[204:207]
 ds_read_b64_tr_b16 a[114:115], v16 offset:1888
 v_max_f32 v70, v68, v69
 v_mfma_f32_16x16x32_bf16 v[200:203], a[100:103], a[84:87], v[200:203]
 ds_read_b64_tr_b16 a[116:117], v16 offset:7264
 v_cndmask_b32 v72, v72, v73, s[6:7]
 v_mfma_f32_16x16x32_bf16 v[200:203], a[96:99], a[80:83], v[200:203]
 ds_read_b64_tr_b16 a[118:119], v16 offset:9056
 v_cndmask_b32 v74, v74, v75, s[6:7]
 v_mfma_f32_16x16x32_bf16 v[196:199], a[96:99], a[72:75], v[196:199]
 s_add_u32 m0, s39, 5120
 s_waitcnt vmcnt(5)
 buffer_store_dword v1, v2, s[20:23], s98 offen offset:384 sc1
 v_mfma_f32_16x16x32_bf16 v[196:199], a[100:103], a[76:79], v[196:199]
 buffer_load_dwordx4 v21, s[16:19], s67 offen lds
 s_add_u32 s67, s67, 16384
 v_mfma_f32_16x16x32_bf16 v[192:195], a[100:103], a[68:71], v[192:195]
 s_add_u32 m0, s39, 6144
 ds_read_b128 v[80:83], v3 offset:384
 v_mfma_f32_16x16x32_bf16 v[192:195], a[96:99], a[64:67], v[192:195]
 buffer_load_dwordx4 v20, s[16:19], s67 offen lds
 s_waitcnt lgkmcnt(5)
 v_mfma_f32_16x16x32_bf16 v[176:179], a[104:107], a[0:3], v[176:179]
 ds_read_b64_tr_b16 a[120:121], v16 offset:16512
 v_cndmask_b32 v104, v104, v105, s[6:7]
 v_mfma_f32_16x16x32_bf16 v[176:179], a[108:111], a[4:7], v[176:179]
 ds_read_b64_tr_b16 a[122:123], v16 offset:18304
 v_cndmask_b32 v106, v106, v107, s[6:7]
 v_mfma_f32_16x16x32_bf16 v[180:183], a[108:111], a[12:15], v[180:183]
 ds_read_b64_tr_b16 a[124:125], v16 offset:23680
 v_cndmask_b32 v72, v104, v72, s[52:53]
 v_mfma_f32_16x16x32_bf16 v[180:183], a[104:107], a[8:11], v[180:183]
 ds_read_b64_tr_b16 a[126:127], v16 offset:25472
 v_cndmask_b32 v73, v106, v74, s[4:5]
 v_mfma_f32_16x16x32_bf16 v[184:187], a[104:107], a[16:19], v[184:187]
 s_add_u32 m0, s39, 7168
 ds_read_b128 v[88:91], v3 offset:896
 v_mfma_f32_16x16x32_bf16 v[184:187], a[108:111], a[20:23], v[184:187]
 buffer_load_dwordx4 v21, s[16:19], s67 offen lds
 v_mul_f32 v72, v72, v44
 v_mfma_f32_16x16x32_bf16 v[188:191], a[108:111], a[28:31], v[188:191]
 ds_read_b128 v[84:87], v3 offset:448
 v_mul_f32 v73, v73, v46
 v_mfma_f32_16x16x32_bf16 v[188:191], a[104:107], a[24:27], v[188:191]
 ds_read_b128 v[92:95], v3 offset:960
 s_waitcnt lgkmcnt(8)
 v_mfma_f32_16x16x32_bf16 v[204:207], a[112:115], a[24:27], v[204:207]
 ds_read_b64_tr_b16 a[96:97], v16 offset:16544
 v_max_f32 v74, v72, v73
 v_mfma_f32_16x16x32_bf16 v[204:207], a[116:119], a[28:31], v[204:207]
 ds_read_b64_tr_b16 a[98:99], v16 offset:18336
 v_cndmask_b32 v76, v76, v77, s[6:7]
 v_mfma_f32_16x16x32_bf16 v[200:203], a[116:119], a[20:23], v[200:203]
 ds_read_b64_tr_b16 a[100:101], v16 offset:23712
 v_cndmask_b32 v78, v78, v79, s[6:7]
 v_mfma_f32_16x16x32_bf16 v[200:203], a[112:115], a[16:19], v[200:203]
 ds_read_b64_tr_b16 a[102:103], v16 offset:25504
 v_cndmask_b32 v108, v108, v109, s[6:7]
 v_mfma_f32_16x16x32_bf16 v[196:199], a[112:115], a[8:11], v[196:199]
 s_add_u32 m0, s39, 32768
 v_cndmask_b32 v110, v110, v111, s[6:7]
 v_cndmask_b32 v76, v108, v76, s[52:53]
 v_mfma_f32_16x16x32_bf16 v[196:199], a[116:119], a[12:15], v[196:199]
 buffer_load_dwordx4 v20, s[12:15], s72 offen lds
 v_cndmask_b32 v77, v110, v78, s[4:5]
 v_mfma_f32_16x16x32_bf16 v[192:195], a[116:119], a[4:7], v[192:195]
 s_add_u32 m0, s39, 33792
 v_mul_f32 v76, v76, v45
 v_mul_f32 v77, v77, v47
 v_mfma_f32_16x16x32_bf16 v[192:195], a[112:115], a[0:3], v[192:195]
 buffer_load_dwordx4 v21, s[12:15], s72 offen lds
 s_waitcnt lgkmcnt(7)
 v_mfma_f32_16x16x32_bf16 v[208:211], a[120:123], a[32:35], v[208:211]
 ds_read_b64_tr_b16 a[104:105], v16 offset:32896
 s_add_u32 s72, s72, 16384
 v_mfma_f32_16x16x32_bf16 v[208:211], a[124:127], a[36:39], v[208:211]
 ds_read_b64_tr_b16 a[106:107], v16 offset:34688
 v_max_f32 v78, v76, v77
 v_mfma_f32_16x16x32_bf16 v[212:215], a[124:127], a[44:47], v[212:215]
 ds_read_b64_tr_b16 a[108:109], v16 offset:40064
 v_mov_b32 v71, v70
 v_mfma_f32_16x16x32_bf16 v[212:215], a[120:123], a[40:43], v[212:215]
 ds_read_b64_tr_b16 a[110:111], v16 offset:41856
 v_mov_b32 v75, v74
 v_mfma_f32_16x16x32_bf16 v[216:219], a[120:123], a[48:51], v[216:219]
 s_add_u32 m0, s39, 34816
 v_mov_b32 v79, v78
 v_mfma_f32_16x16x32_bf16 v[216:219], a[124:127], a[52:55], v[216:219]
 buffer_load_dwordx4 v20, s[12:15], s72 offen lds
 v_mfma_f32_16x16x32_bf16 v[220:223], a[124:127], a[60:63], v[220:223]
 s_add_u32 m0, s39, 35840
 v_permlane16_swap_b32 v70, v71
 v_mfma_f32_16x16x32_bf16 v[220:223], a[120:123], a[56:59], v[220:223]
 buffer_load_dwordx4 v21, s[12:15], s72 offen lds
 s_waitcnt lgkmcnt(4)
 v_mfma_f32_16x16x32_bf16 v[236:239], a[96:99], a[56:59], v[236:239]
 ds_read_b64_tr_b16 a[112:113], v16 offset:32928
 v_max_f32 v70, v70, v71
 v_mfma_f32_16x16x32_bf16 v[236:239], a[100:103], a[60:63], v[236:239]
 ds_read_b64_tr_b16 a[114:115], v16 offset:34720
 v_mov_b32 v71, v70
 v_mfma_f32_16x16x32_bf16 v[232:235], a[100:103], a[52:55], v[232:235]
 ds_read_b64_tr_b16 a[116:117], v16 offset:40096
 v_mfma_f32_16x16x32_bf16 v[232:235], a[96:99], a[48:51], v[232:235]
 ds_read_b64_tr_b16 a[118:119], v16 offset:41888
 v_mfma_f32_16x16x32_bf16 v[228:231], a[96:99], a[40:43], v[228:231]
 v_permlane16_swap_b32 v74, v75
 v_mfma_f32_16x16x32_bf16 v[228:231], a[100:103], a[44:47], v[228:231]
 v_permlane16_swap_b32 v78, v79
 v_mfma_f32_16x16x32_bf16 v[224:227], a[100:103], a[36:39], v[224:227]
 s_add_u32 m0, s39, 36864
 v_max_f32 v74, v74, v75
 v_max_f32 v78, v78, v79
 v_mfma_f32_16x16x32_bf16 v[224:227], a[96:99], a[32:35], v[224:227]
 buffer_load_dwordx4 v20, s[12:15], s73 offen lds
 s_waitcnt lgkmcnt(4)
 v_mfma_f32_16x16x32_bf16 v[208:211], a[104:107], a[64:67], v[208:211]
 ds_read_b64_tr_b16 a[120:121], v16 offset:128
 v_mov_b32 v75, v74
 v_mfma_f32_16x16x32_bf16 v[208:211], a[108:111], a[68:71], v[208:211]
 ds_read_b64_tr_b16 a[122:123], v16 offset:1920
 v_mov_b32 v79, v78
 v_mfma_f32_16x16x32_bf16 v[212:215], a[108:111], a[76:79], v[212:215]
 ds_read_b64_tr_b16 a[124:125], v16 offset:7296
 v_mfma_f32_16x16x32_bf16 v[212:215], a[104:107], a[72:75], v[212:215]
 ds_read_b64_tr_b16 a[126:127], v16 offset:9088
 v_mfma_f32_16x16x32_bf16 v[216:219], a[104:107], a[80:83], v[216:219]
 s_add_u32 m0, s39, 37888
 v_permlane32_swap_b32 v70, v71
 v_mfma_f32_16x16x32_bf16 v[216:219], a[108:111], a[84:87], v[216:219]
 buffer_load_dwordx4 v21, s[12:15], s73 offen lds
 s_add_u32 s73, s73, 16384
 v_mfma_f32_16x16x32_bf16 v[220:223], a[108:111], a[92:95], v[220:223]
 s_add_u32 m0, s39, 38912
 v_permlane32_swap_b32 v74, v75
 v_mfma_f32_16x16x32_bf16 v[220:223], a[104:107], a[88:91], v[220:223]
 buffer_load_dwordx4 v20, s[12:15], s73 offen lds
 s_waitcnt lgkmcnt(4)
 v_mfma_f32_16x16x32_bf16 v[236:239], a[112:115], a[88:91], v[236:239]
 ds_read_b64_tr_b16 a[96:97], v16 offset:160
 v_max_f32 v70, v70, v71
 v_mfma_f32_16x16x32_bf16 v[236:239], a[116:119], a[92:95], v[236:239]
 ds_read_b64_tr_b16 a[98:99], v16 offset:1952
 v_max_f32 v74, v74, v75
 v_mfma_f32_16x16x32_bf16 v[232:235], a[116:119], a[84:87], v[232:235]
 ds_read_b64_tr_b16 a[100:101], v16 offset:7328
 v_mul_f32 v70, v70, v37
 v_mfma_f32_16x16x32_bf16 v[232:235], a[112:115], a[80:83], v[232:235]
 ds_read_b64_tr_b16 a[102:103], v16 offset:9120
 v_fma_f32 v68, v68, v37, -v70
 v_mfma_f32_16x16x32_bf16 v[228:231], a[112:115], a[72:75], v[228:231]
 s_add_u32 m0, s39, 39936
 buffer_load_dword v7, off, s[24:27], s87 offset:384 sc1
 v_mfma_f32_16x16x32_bf16 v[228:231], a[116:119], a[76:79], v[228:231]
 buffer_load_dwordx4 v21, s[12:15], s73 offen lds
 v_fma_f32 v69, v69, v37, -v70
 v_mfma_f32_16x16x32_bf16 v[224:227], a[116:119], a[68:71], v[224:227]
 v_permlane32_swap_b32 v78, v79
 v_mfma_f32_16x16x32_bf16 v[224:227], a[112:115], a[64:67], v[224:227]
 s_waitcnt lgkmcnt(4)
 v_max_f32 v78, v78, v79
 v_mul_f32 v74, v74, v38
 v_mfma_f32_16x16x32_bf16 v[208:211], a[120:123], a[0:3], v[208:211]
 ds_read_b64_tr_b16 a[104:105], v16 offset:16576
 v_fma_f32 v72, v72, v38, -v74
 v_mfma_f32_16x16x32_bf16 v[208:211], a[124:127], a[4:7], v[208:211]
 ds_read_b64_tr_b16 a[106:107], v16 offset:18368
 v_fma_f32 v73, v73, v38, -v74
 v_mfma_f32_16x16x32_bf16 v[212:215], a[124:127], a[12:15], v[212:215]
 ds_read_b64_tr_b16 a[108:109], v16 offset:23744
 v_mul_f32 v78, v78, v39
 v_mfma_f32_16x16x32_bf16 v[212:215], a[120:123], a[8:11], v[212:215]
 ds_read_b64_tr_b16 a[110:111], v16 offset:25536
 v_fma_f32 v76, v76, v39, -v78
 v_mfma_f32_16x16x32_bf16 v[216:219], a[120:123], a[16:19], v[216:219]
 s_add_u32 m0, s47, 69632
 v_fma_f32 v77, v77, v39, -v78
 v_mfma_f32_16x16x32_bf16 v[216:219], a[124:127], a[20:23], v[216:219]
 buffer_load_dwordx4 v20, s[12:15], s74 offen lds
 v_mfma_f32_16x16x32_bf16 v[220:223], a[124:127], a[28:31], v[220:223]
 s_add_u32 m0, s47, 70656
 v_exp_f32 v68, v68
 v_mfma_f32_16x16x32_bf16 v[220:223], a[120:123], a[24:27], v[220:223]
 buffer_load_dwordx4 v21, s[12:15], s74 offen lds
 s_waitcnt lgkmcnt(4)
 v_mfma_f32_16x16x32_bf16 v[236:239], a[96:99], a[24:27], v[236:239]
 ds_read_b64_tr_b16 a[112:113], v16 offset:32960
 s_add_u32 s74, s74, 16384
 v_mfma_f32_16x16x32_bf16 v[236:239], a[100:103], a[28:31], v[236:239]
 ds_read_b64_tr_b16 a[114:115], v16 offset:34752
 v_mfma_f32_16x16x32_bf16 v[232:235], a[100:103], a[20:23], v[232:235]
 ds_read_b64_tr_b16 a[116:117], v16 offset:40128
 v_mfma_f32_16x16x32_bf16 v[232:235], a[96:99], a[16:19], v[232:235]
 ds_read_b64_tr_b16 a[118:119], v16 offset:41920
 v_mfma_f32_16x16x32_bf16 v[228:231], a[96:99], a[8:11], v[228:231]
 s_add_u32 m0, s47, 71680
 v_exp_f32 v69, v69
 v_mfma_f32_16x16x32_bf16 v[228:231], a[100:103], a[12:15], v[228:231]
 buffer_load_dwordx4 v20, s[12:15], s74 offen lds
 v_add_f32 v70, v68, v69
 v_mfma_f32_16x16x32_bf16 v[224:227], a[100:103], a[4:7], v[224:227]
 s_add_u32 m0, s47, 72704
 v_exp_f32 v72, v72
 v_mfma_f32_16x16x32_bf16 v[224:227], a[96:99], a[0:3], v[224:227]
 buffer_load_dwordx4 v21, s[12:15], s74 offen lds
 s_waitcnt lgkmcnt(4)
 v_mfma_f32_16x16x32_bf16 v[240:243], a[104:107], a[32:35], v[240:243]
 ds_read_b64_tr_b16 a[120:121], v16 offset:192
 v_mul_f32 v68, v68, v41
 v_mfma_f32_16x16x32_bf16 v[240:243], a[108:111], a[36:39], v[240:243]
 ds_read_b64_tr_b16 a[122:123], v16 offset:1984
 v_mul_f32 v69, v69, v43
 v_mfma_f32_16x16x32_bf16 v[244:247], a[108:111], a[44:47], v[244:247]
 ds_read_b64_tr_b16 a[124:125], v16 offset:7360
 v_mov_b32 v71, v70
 v_mfma_f32_16x16x32_bf16 v[244:247], a[104:107], a[40:43], v[244:247]
 ds_read_b64_tr_b16 a[126:127], v16 offset:9152
 s_add_u32 s3, s56, 147456
 v_mfma_f32_16x16x32_bf16 v[248:251], a[104:107], a[48:51], v[248:251]
 v_exp_f32 v73, v73
 v_mfma_f32_16x16x32_bf16 v[248:251], a[108:111], a[52:55], v[248:251]
 v_exp_f32 v76, v76
 v_mfma_f32_16x16x32_bf16 v[252:255], a[108:111], a[60:63], v[252:255]
 s_add_u32 m0, s47, 86016
 v_exp_f32 v77, v77
 v_mfma_f32_16x16x32_bf16 v[252:255], a[104:107], a[56:59], v[252:255]
 buffer_load_dwordx4 v20, s[12:15], s75 offen lds
 s_waitcnt vmcnt(10) lgkmcnt(0)
 s_barrier
 v_mfma_f32_16x16x32_bf16 v[240:243], a[112:115], a[64:67], v[240:243]
 v_add_f32 v74, v72, v73
 v_add_f32 v78, v76, v77
 v_mfma_f32_16x16x32_bf16 v[240:243], a[116:119], a[68:71], v[240:243]
 v_mul_f32 v72, v72, v44
 v_mul_f32 v73, v73, v46
 v_mfma_f32_16x16x32_bf16 v[244:247], a[116:119], a[76:79], v[244:247]
 v_mul_f32 v76, v76, v45
 s_waitcnt vmcnt(6)
 v_cmp_gt_u32 vcc, s48, v7
 v_mfma_f32_16x16x32_bf16 v[244:247], a[112:115], a[72:75], v[244:247]
 v_mul_f32 v77, v77, v47
 s_cbranch_vccnz L_phx_wait
L_phx_ok:
 v_mfma_f32_16x16x32_bf16 v[248:251], a[112:115], a[80:83], v[248:251]
 s_add_u32 m0, s47, 87040
 buffer_load_dwordx4 v[128:131], v8, s[24:27], s57 offen sc1
 v_mfma_f32_16x16x32_bf16 v[248:251], a[116:119], a[84:87], v[248:251]
 buffer_load_dwordx4 v21, s[12:15], s75 offen lds
 s_add_u32 s75, s75, 16384
 v_mfma_f32_16x16x32_bf16 v[252:255], a[116:119], a[92:95], v[252:255]
 s_add_u32 m0, s47, 88064
 buffer_load_dwordx2 v[118:119], v9, s[24:27], s57 offen offset:1024 sc1
 buffer_load_dwordx2 v[134:135], v9, s[24:27], s57 offen offset:1536 sc1
 v_mfma_f32_16x16x32_bf16 v[252:255], a[112:115], a[88:91], v[252:255]
 buffer_load_dwordx4 v20, s[12:15], s75 offen lds
 v_mfma_f32_16x16x32_bf16 v[240:243], a[120:123], a[0:3], v[240:243]
 v_mov_b32 v75, v74
 v_mov_b32 v79, v78
 v_mfma_f32_16x16x32_bf16 v[240:243], a[124:127], a[4:7], v[240:243]
 v_permlane16_swap_b32 v70, v71
 v_mfma_f32_16x16x32_bf16 v[244:247], a[124:127], a[12:15], v[244:247]
 v_permlane16_swap_b32 v74, v75
 v_mfma_f32_16x16x32_bf16 v[244:247], a[120:123], a[8:11], v[244:247]
 v_permlane16_swap_b32 v78, v79
 v_mfma_f32_16x16x32_bf16 v[248:251], a[120:123], a[16:19], v[248:251]
 s_add_u32 m0, s47, 89088
 v_add_f32 v70, v70, v71
 v_add_f32 v74, v74, v75
 v_mfma_f32_16x16x32_bf16 v[248:251], a[124:127], a[20:23], v[248:251]
 buffer_load_dwordx4 v21, s[12:15], s75 offen lds
 v_add_f32 v78, v78, v79
 v_mfma_f32_16x16x32_bf16 v[252:255], a[124:127], a[28:31], v[252:255]
 v_mov_b32 v71, v70
 v_mov_b32 v75, v74
 v_mfma_f32_16x16x32_bf16 v[252:255], a[120:123], a[24:27], v[252:255]
 v_mov_b32 v79, v78
 v_permlane32_swap_b32 v70, v71
 v_permlane32_swap_b32 v74, v75
 v_permlane32_swap_b32 v78, v79
 v_add_f32 v70, v70, v71
 v_add_f32 v74, v74, v75
 v_add_f32 v78, v78, v79
 v_rcp_f32 v70, v70
 v_rcp_f32 v74, v74
 v_rcp_f32 v78, v78
 v_mul_f32 v68, v68, v70
 v_mul_f32 v69, v69, v70
 v_cvt_pk_bf16_f32 v68, v68, v68
 v_cvt_pk_bf16_f32 v69, v69, v69
 v_and_b32 v100, v68, v13
 v_and_b32 v101, v69, v6
 v_and_b32 v102, v68, v12
 v_and_b32 v103, v69, v17
 v_mul_f32 v72, v72, v74
 v_mul_f32 v73, v73, v74
 v_mfma_f32_16x16x32_bf16 v[52:55], v[120:123], v[100:103], 0
 v_mfma_f32_16x16x32_bf16 v[68:71], v[136:139], v[100:103], 0
 v_cvt_pk_bf16_f32 v72, v72, v72
 v_cvt_pk_bf16_f32 v73, v73, v73
 v_and_b32 v104, v72, v13
 v_and_b32 v105, v73, v6
 v_and_b32 v106, v72, v12
 v_and_b32 v107, v73, v17
 v_mul_f32 v76, v76, v78
 v_mul_f32 v77, v77, v78
 v_mfma_f32_16x16x32_bf16 v[56:59], v[122:125], v[104:107], 0
 v_mfma_f32_16x16x32_bf16 v[72:75], v[138:141], v[104:107], 0
 v_cvt_pk_bf16_f32 v76, v76, v76
 v_cvt_pk_bf16_f32 v77, v77, v77
 v_and_b32 v108, v76, v13
 v_and_b32 v109, v77, v6
 v_and_b32 v110, v76, v12
 v_and_b32 v111, v77, v17
 v_cvt_pk_bf16_f32 v52, v52, v53
 v_cvt_pk_bf16_f32 v53, v54, v55
 v_mfma_f32_16x16x32_bf16 v[60:63], v[124:127], v[108:111], 0
 v_mfma_f32_16x16x32_bf16 v[76:79], v[140:143], v[108:111], 0
 v_cvt_pk_bf16_f32 v54, v68, v69
 v_cvt_pk_bf16_f32 v55, v70, v71
 buffer_store_dwordx4 v[52:55], v8, s[20:23], s3 offen sc1
 v_cvt_pk_bf16_f32 v56, v56, v57
 v_cvt_pk_bf16_f32 v57, v58, v59
 v_cvt_pk_bf16_f32 v58, v72, v73
 v_cvt_pk_bf16_f32 v59, v74, v75
 s_add_u32 s3, s56, 294912
 buffer_store_dwordx4 v[56:59], v8, s[20:23], s3 offen sc1
 v_cvt_pk_bf16_f32 v60, v60, v61
 v_cvt_pk_bf16_f32 v61, v62, v63
 v_cvt_pk_bf16_f32 v62, v76, v77
 v_cvt_pk_bf16_f32 v63, v78, v79
 s_add_u32 s3, s56, 442368
 buffer_store_dwordx4 v[60:63], v8, s[20:23], s3 offen sc1
L_epi:
 s_lshl_b32 s55, s63, 12
 v_add_u32 v44, s91, v8
 v_add_u32 v45, 147456, v44
 v_add_u32 v46, 294912, v44
 v_add_u32 v47, 442368, v44
 v_pk_fma_f32 v[148:149], v[28:29], v[80:81], v[148:149] op_sel:[1,0,0] op_sel_hi:[1,1,1]
 v_pk_fma_f32 v[150:151], v[28:29], v[82:83], v[150:151] op_sel:[1,0,0] op_sel_hi:[1,1,1]
 v_pk_fma_f32 v[164:165], v[28:29], v[84:85], v[164:165] op_sel:[1,0,0] op_sel_hi:[1,1,1]
 v_pk_fma_f32 v[166:167], v[28:29], v[86:87], v[166:167] op_sel:[1,0,0] op_sel_hi:[1,1,1]
 v_pk_fma_f32 v[148:149], v[28:29], v[148:149], v[88:89] op_sel:[0,0,0] op_sel_hi:[0,1,1]
 v_pk_fma_f32 v[150:151], v[28:29], v[150:151], v[90:91] op_sel:[0,0,0] op_sel_hi:[0,1,1]
 v_pk_fma_f32 v[164:165], v[28:29], v[164:165], v[92:93] op_sel:[0,0,0] op_sel_hi:[0,1,1]
 v_pk_fma_f32 v[166:167], v[28:29], v[166:167], v[94:95] op_sel:[0,0,0] op_sel_hi:[0,1,1]
 v_pk_mul_f32 v[100:101], v[148:149], v[148:149]
 v_pk_mul_f32 v[102:103], v[150:151], v[150:151]
 v_pk_mul_f32 v[104:105], v[164:165], v[164:165]
 v_pk_mul_f32 v[106:107], v[166:167], v[166:167]
 v_pk_fma_f32 v[100:101], v[100:101], s[78:79], s[78:79] op_sel:[0,1,0] op_sel_hi:[1,1,0]
 v_pk_fma_f32 v[102:103], v[102:103], s[78:79], s[78:79] op_sel:[0,1,0] op_sel_hi:[1,1,0]
 v_pk_fma_f32 v[104:105], v[104:105], s[78:79], s[78:79] op_sel:[0,1,0] op_sel_hi:[1,1,0]
 v_pk_fma_f32 v[106:107], v[106:107], s[78:79], s[78:79] op_sel:[0,1,0] op_sel_hi:[1,1,0]
 v_pk_mul_f32 v[100:101], v[100:101], v[148:149]
 v_pk_mul_f32 v[102:103], v[102:103], v[150:151]
 v_pk_mul_f32 v[104:105], v[104:105], v[164:165]
 v_pk_mul_f32 v[106:107], v[106:107], v[166:167]
 v_exp_f32 v100, v100
 v_exp_f32 v101, v101
 v_exp_f32 v102, v102
 v_exp_f32 v103, v103
 v_exp_f32 v104, v104
 v_exp_f32 v105, v105
 v_exp_f32 v106, v106
 v_exp_f32 v107, v107
 v_pk_add_f32 v[100:101], v[100:101], 1.0 op_sel_hi:[1,0]
 v_pk_add_f32 v[102:103], v[102:103], 1.0 op_sel_hi:[1,0]
 v_pk_add_f32 v[104:105], v[104:105], 1.0 op_sel_hi:[1,0]
 v_pk_add_f32 v[106:107], v[106:107], 1.0 op_sel_hi:[1,0]
 v_rcp_f32 v100, v100
 v_rcp_f32 v101, v101
 v_rcp_f32 v102, v102
 v_rcp_f32 v103, v103
 v_rcp_f32 v104, v104
 v_rcp_f32 v105, v105
 v_rcp_f32 v106, v106
 v_rcp_f32 v107, v107
 v_pk_mul_f32 v[100:101], v[100:101], v[148:149]
 v_pk_mul_f32 v[102:103], v[102:103], v[150:151]
 v_pk_mul_f32 v[104:105], v[104:105], v[164:165]
 v_pk_mul_f32 v[106:107], v[106:107], v[166:167]
 v_cvt_pk_bf16_f32 v68, v100, v101
 v_cvt_pk_bf16_f32 v69, v102, v103
 v_cvt_pk_bf16_f32 v70, v104, v105
 v_cvt_pk_bf16_f32 v71, v106, v107
 buffer_store_dwordx4 v[68:71], v45, s[20:23], s55 offen offset:1024 sc1
 s_waitcnt vmcnt(9)
 v_mfma_f32_16x16x32_bf16 v[96:99], v[128:131], v[48:51], 0
 v_pk_fma_f32 v[152:153], v[30:31], v[80:81], v[152:153] op_sel:[1,0,0] op_sel_hi:[1,1,1]
 v_pk_fma_f32 v[154:155], v[30:31], v[82:83], v[154:155] op_sel:[1,0,0] op_sel_hi:[1,1,1]
 v_pk_fma_f32 v[168:169], v[30:31], v[84:85], v[168:169] op_sel:[1,0,0] op_sel_hi:[1,1,1]
 v_pk_fma_f32 v[170:171], v[30:31], v[86:87], v[170:171] op_sel:[1,0,0] op_sel_hi:[1,1,1]
 v_pk_fma_f32 v[152:153], v[30:31], v[152:153], v[88:89] op_sel:[0,0,0] op_sel_hi:[0,1,1]
 v_pk_fma_f32 v[154:155], v[30:31], v[154:155], v[90:91] op_sel:[0,0,0] op_sel_hi:[0,1,1]
 v_pk_fma_f32 v[168:169], v[30:31], v[168:169], v[92:93] op_sel:[0,0,0] op_sel_hi:[0,1,1]
 v_pk_fma_f32 v[170:171], v[30:31], v[170:171], v[94:95] op_sel:[0,0,0] op_sel_hi:[0,1,1]
 v_cndmask_b32 v64, v64, v65, s[6:7]
 v_pk_mul_f32 v[100:101], v[152:153], v[152:153]
 v_cndmask_b32 v66, v66, v67, s[6:7]
 v_pk_mul_f32 v[102:103], v[154:155], v[154:155]
 v_cndmask_b32 v96, v96, v97, s[6:7]
 v_pk_mul_f32 v[104:105], v[168:169], v[168:169]
 v_cndmask_b32 v98, v98, v99, s[6:7]
 v_pk_mul_f32 v[106:107], v[170:171], v[170:171]
 v_add_f32 v96, s49, v96
 v_pk_fma_f32 v[100:101], v[100:101], s[78:79], s[78:79] op_sel:[0,1,0] op_sel_hi:[1,1,0]
 v_add_f32 v98, s49, v98
 v_pk_fma_f32 v[102:103], v[102:103], s[78:79], s[78:79] op_sel:[0,1,0] op_sel_hi:[1,1,0]
 v_cndmask_b32 v64, v96, v64, s[52:53]
 v_pk_fma_f32 v[104:105], v[104:105], s[78:79], s[78:79] op_sel:[0,1,0] op_sel_hi:[1,1,0]
 v_cndmask_b32 v65, v98, v66, s[4:5]
 v_pk_fma_f32 v[106:107], v[106:107], s[78:79], s[78:79] op_sel:[0,1,0] op_sel_hi:[1,1,0]
 v_mul_f32 v64, v64, v40
 v_pk_mul_f32 v[100:101], v[100:101], v[152:153]
 v_mul_f32 v65, v65, v42
 v_pk_mul_f32 v[102:103], v[102:103], v[154:155]
 v_max_f32 v66, v64, v65
 v_pk_mul_f32 v[104:105], v[104:105], v[168:169]
 v_mov_b32 v67, v66
 v_pk_mul_f32 v[106:107], v[106:107], v[170:171]
 v_exp_f32 v100, v100
 v_permlane16_swap_b32 v66, v67
 v_exp_f32 v101, v101
 v_max_f32 v66, v66, v67
 v_exp_f32 v102, v102
 v_mov_b32 v67, v66
 v_exp_f32 v103, v103
 v_exp_f32 v104, v104
 v_permlane32_swap_b32 v66, v67
L_pg8:
 s_cbranch_execz L_pg12
 v_exp_f32 v105, v105
 v_max_f32 v66, v66, v67
 v_exp_f32 v106, v106
 v_mul_f32 v66, v66, v36
 v_exp_f32 v107, v107
 v_fma_f32 v64, v64, v36, -v66
 v_pk_add_f32 v[100:101], v[100:101], 1.0 op_sel_hi:[1,0]
 v_fma_f32 v65, v65, v36, -v66
 v_pk_add_f32 v[102:103], v[102:103], 1.0 op_sel_hi:[1,0]
 v_exp_f32 v64, v64
 v_pk_add_f32 v[104:105], v[104:105], 1.0 op_sel_hi:[1,0]
 v_exp_f32 v65, v65
 v_pk_add_f32 v[106:107], v[106:107], 1.0 op_sel_hi:[1,0]
 v_add_f32 v66, v64, v65
 v_rcp_f32 v100, v100
 v_mul_f32 v64, v64, v40
 v_rcp_f32 v101, v101
 v_mul_f32 v65, v65, v42
 v_rcp_f32 v102, v102
 v_mov_b32 v67, v66
 v_rcp_f32 v103, v103
 v_rcp_f32 v104, v104
 v_permlane16_swap_b32 v66, v67
 v_rcp_f32 v105, v105
 v_add_f32 v66, v66, v67
 v_rcp_f32 v106, v106
 v_mov_b32 v67, v66
 v_rcp_f32 v107, v107
 v_pk_mul_f32 v[100:101], v[100:101], v[152:153]
 v_permlane32_swap_b32 v66, v67
 v_pk_mul_f32 v[102:103], v[102:103], v[154:155]
 v_add_f32 v66, v66, v67
 v_pk_mul_f32 v[104:105], v[104:105], v[168:169]
 v_rcp_f32 v66, v66
 v_pk_mul_f32 v[106:107], v[106:107], v[170:171]
 v_mul_f32 v64, v64, v66
 v_cvt_pk_bf16_f32 v72, v100, v101
 v_mul_f32 v65, v65, v66
 v_cvt_pk_bf16_f32 v73, v102, v103
 v_cvt_pk_bf16_f32 v64, v64, v64
 v_cvt_pk_bf16_f32 v74, v104, v105
 v_cvt_pk_bf16_f32 v65, v65, v65
 v_cvt_pk_bf16_f32 v75, v106, v107
 buffer_store_dwordx4 v[72:75], v46, s[20:23], s55 offen offset:1024 sc1
 v_and_b32 v96, v64, v13
 v_pk_fma_f32 v[156:157], v[32:33], v[80:81], v[156:157] op_sel:[1,0,0] op_sel_hi:[1,1,1]
 v_and_b32 v97, v65, v6
 v_pk_fma_f32 v[158:159], v[32:33], v[82:83], v[158:159] op_sel:[1,0,0] op_sel_hi:[1,1,1]
 v_and_b32 v98, v64, v12
 v_pk_fma_f32 v[172:173], v[32:33], v[84:85], v[172:173] op_sel:[1,0,0] op_sel_hi:[1,1,1]
 v_and_b32 v99, v65, v17
 v_pk_fma_f32 v[174:175], v[32:33], v[86:87], v[174:175] op_sel:[1,0,0] op_sel_hi:[1,1,1]
 v_pk_fma_f32 v[156:157], v[32:33], v[156:157], v[88:89] op_sel:[0,0,0] op_sel_hi:[0,1,1]
 s_waitcnt vmcnt(8)
 v_mfma_f32_16x16x32_bf16 v[48:51], v[118:121], v[96:99], 0
 s_waitcnt vmcnt(7)
 v_mfma_f32_16x16x32_bf16 v[64:67], v[134:137], v[96:99], 0
 v_pk_fma_f32 v[158:159], v[32:33], v[158:159], v[90:91] op_sel:[0,0,0] op_sel_hi:[0,1,1]
 v_pk_fma_f32 v[172:173], v[32:33], v[172:173], v[92:93] op_sel:[0,0,0] op_sel_hi:[0,1,1]
 v_pk_fma_f32 v[174:175], v[32:33], v[174:175], v[94:95] op_sel:[0,0,0] op_sel_hi:[0,1,1]
 v_pk_mul_f32 v[100:101], v[156:157], v[156:157]
 v_pk_mul_f32 v[102:103], v[158:159], v[158:159]
 v_pk_mul_f32 v[104:105], v[172:173], v[172:173]
 v_pk_mul_f32 v[106:107], v[174:175], v[174:175]
 v_pk_fma_f32 v[100:101], v[100:101], s[78:79], s[78:79] op_sel:[0,1,0] op_sel_hi:[1,1,0]
 v_cvt_pk_bf16_f32 v48, v48, v49
 v_pk_fma_f32 v[102:103], v[102:103], s[78:79], s[78:79] op_sel:[0,1,0] op_sel_hi:[1,1,0]
 v_cvt_pk_bf16_f32 v49, v50, v51
 v_pk_fma_f32 v[104:105], v[104:105], s[78:79], s[78:79] op_sel:[0,1,0] op_sel_hi:[1,1,0]
 v_cvt_pk_bf16_f32 v50, v64, v65
 v_pk_fma_f32 v[106:107], v[106:107], s[78:79], s[78:79] op_sel:[0,1,0] op_sel_hi:[1,1,0]
 v_cvt_pk_bf16_f32 v51, v66, v67
 v_pk_mul_f32 v[100:101], v[100:101], v[156:157]
 s_add_u32 s3, s56, 0
 v_pk_mul_f32 v[102:103], v[102:103], v[158:159]
 buffer_store_dwordx4 v[48:51], v8, s[20:23], s3 offen sc1
 v_pk_mul_f32 v[104:105], v[104:105], v[172:173]
 v_pk_mul_f32 v[106:107], v[106:107], v[174:175]
 v_exp_f32 v100, v100
 v_exp_f32 v101, v101
 v_exp_f32 v102, v102
 v_exp_f32 v103, v103
 v_exp_f32 v104, v104
 v_exp_f32 v105, v105
 v_exp_f32 v106, v106
 v_exp_f32 v107, v107
 v_pk_add_f32 v[100:101], v[100:101], 1.0 op_sel_hi:[1,0]
 v_pk_add_f32 v[102:103], v[102:103], 1.0 op_sel_hi:[1,0]
 v_pk_add_f32 v[104:105], v[104:105], 1.0 op_sel_hi:[1,0]
 v_pk_add_f32 v[106:107], v[106:107], 1.0 op_sel_hi:[1,0]
 v_rcp_f32 v100, v100
 v_rcp_f32 v101, v101
 v_rcp_f32 v102, v102
 v_rcp_f32 v103, v103
 v_rcp_f32 v104, v104
 v_rcp_f32 v105, v105
 v_rcp_f32 v106, v106
 v_rcp_f32 v107, v107
 v_pk_mul_f32 v[100:101], v[100:101], v[156:157]
 v_pk_mul_f32 v[102:103], v[102:103], v[158:159]
 v_pk_mul_f32 v[104:105], v[104:105], v[172:173]
 v_pk_mul_f32 v[106:107], v[106:107], v[174:175]
 v_cvt_pk_bf16_f32 v76, v100, v101
 v_cvt_pk_bf16_f32 v77, v102, v103
 v_cvt_pk_bf16_f32 v78, v104, v105
 v_cvt_pk_bf16_f32 v79, v106, v107
 buffer_store_dwordx4 v[76:79], v47, s[20:23], s55 offen offset:1024 sc1
 v_pk_fma_f32 v[144:145], v[26:27], v[80:81], v[144:145] op_sel:[1,0,0] op_sel_hi:[1,1,1]
 v_pk_fma_f32 v[146:147], v[26:27], v[82:83], v[146:147] op_sel:[1,0,0] op_sel_hi:[1,1,1]
 v_pk_fma_f32 v[160:161], v[26:27], v[84:85], v[160:161] op_sel:[1,0,0] op_sel_hi:[1,1,1]
 v_pk_fma_f32 v[162:163], v[26:27], v[86:87], v[162:163] op_sel:[1,0,0] op_sel_hi:[1,1,1]
 v_pk_fma_f32 v[144:145], v[26:27], v[144:145], v[88:89] op_sel:[0,0,0] op_sel_hi:[0,1,1]
 v_pk_fma_f32 v[146:147], v[26:27], v[146:147], v[90:91] op_sel:[0,0,0] op_sel_hi:[0,1,1]
 v_pk_fma_f32 v[160:161], v[26:27], v[160:161], v[92:93] op_sel:[0,0,0] op_sel_hi:[0,1,1]
 v_pk_fma_f32 v[162:163], v[26:27], v[162:163], v[94:95] op_sel:[0,0,0] op_sel_hi:[0,1,1]
 ds_read_b128 v[80:83], v3 offset:640
 ds_read_b128 v[88:91], v3 offset:1152
 ds_read_b128 v[84:87], v3 offset:704
 ds_read_b128 v[92:95], v3 offset:1216
 v_pk_mul_f32 v[100:101], v[144:145], v[144:145]
 v_pk_mul_f32 v[102:103], v[146:147], v[146:147]
 v_pk_mul_f32 v[104:105], v[160:161], v[160:161]
 v_pk_mul_f32 v[106:107], v[162:163], v[162:163]
 v_pk_fma_f32 v[100:101], v[100:101], s[78:79], s[78:79] op_sel:[0,1,0] op_sel_hi:[1,1,0]
 v_pk_fma_f32 v[102:103], v[102:103], s[78:79], s[78:79] op_sel:[0,1,0] op_sel_hi:[1,1,0]
 v_pk_fma_f32 v[104:105], v[104:105], s[78:79], s[78:79] op_sel:[0,1,0] op_sel_hi:[1,1,0]
 v_pk_fma_f32 v[106:107], v[106:107], s[78:79], s[78:79] op_sel:[0,1,0] op_sel_hi:[1,1,0]
 v_pk_mul_f32 v[100:101], v[100:101], v[144:145]
 v_pk_mul_f32 v[102:103], v[102:103], v[146:147]
 v_pk_mul_f32 v[104:105], v[104:105], v[160:161]
 v_pk_mul_f32 v[106:107], v[106:107], v[162:163]
 v_exp_f32 v100, v100
 v_exp_f32 v101, v101
 v_exp_f32 v102, v102
 v_exp_f32 v103, v103
 v_exp_f32 v104, v104
 v_exp_f32 v105, v105
 v_exp_f32 v106, v106
 v_exp_f32 v107, v107
 v_pk_add_f32 v[100:101], v[100:101], 1.0 op_sel_hi:[1,0]
 v_pk_add_f32 v[102:103], v[102:103], 1.0 op_sel_hi:[1,0]
 v_pk_add_f32 v[104:105], v[104:105], 1.0 op_sel_hi:[1,0]
 v_pk_add_f32 v[106:107], v[106:107], 1.0 op_sel_hi:[1,0]
 v_rcp_f32 v100, v100
 v_rcp_f32 v101, v101
 v_rcp_f32 v102, v102
 v_rcp_f32 v103, v103
 v_rcp_f32 v104, v104
 v_rcp_f32 v105, v105
 v_rcp_f32 v106, v106
 v_rcp_f32 v107, v107
 v_pk_mul_f32 v[100:101], v[100:101], v[144:145]
 v_pk_mul_f32 v[102:103], v[102:103], v[146:147]
 v_pk_mul_f32 v[104:105], v[104:105], v[160:161]
 v_pk_mul_f32 v[106:107], v[106:107], v[162:163]
 v_cvt_pk_bf16_f32 v64, v100, v101
 v_cvt_pk_bf16_f32 v65, v102, v103
 v_cvt_pk_bf16_f32 v66, v104, v105
 v_cvt_pk_bf16_f32 v67, v106, v107
 buffer_store_dwordx4 v[64:67], v44, s[20:23], s55 offen offset:1024 sc1
 s_waitcnt lgkmcnt(3)
 v_pk_fma_f32 v[208:209], v[26:27], v[80:81], v[208:209] op_sel:[1,0,0] op_sel_hi:[1,1,1]
 v_pk_fma_f32 v[210:211], v[26:27], v[82:83], v[210:211] op_sel:[1,0,0] op_sel_hi:[1,1,1]
 s_waitcnt lgkmcnt(1)
 v_pk_fma_f32 v[224:225], v[26:27], v[84:85], v[224:225] op_sel:[1,0,0] op_sel_hi:[1,1,1]
 v_pk_fma_f32 v[226:227], v[26:27], v[86:87], v[226:227] op_sel:[1,0,0] op_sel_hi:[1,1,1]
 v_pk_fma_f32 v[208:209], v[26:27], v[208:209], v[88:89] op_sel:[0,0,0] op_sel_hi:[0,1,1]
 v_pk_fma_f32 v[210:211], v[26:27], v[210:211], v[90:91] op_sel:[0,0,0] op_sel_hi:[0,1,1]
 s_waitcnt lgkmcnt(0)
 v_pk_fma_f32 v[224:225], v[26:27], v[224:225], v[92:93] op_sel:[0,0,0] op_sel_hi:[0,1,1]
 v_pk_fma_f32 v[226:227], v[26:27], v[226:227], v[94:95] op_sel:[0,0,0] op_sel_hi:[0,1,1]
 v_pk_mul_f32 v[100:101], v[208:209], v[208:209]
 v_pk_mul_f32 v[102:103], v[210:211], v[210:211]
 v_pk_mul_f32 v[104:105], v[224:225], v[224:225]
 v_pk_mul_f32 v[106:107], v[226:227], v[226:227]
 v_pk_fma_f32 v[100:101], v[100:101], s[78:79], s[78:79] op_sel:[0,1,0] op_sel_hi:[1,1,0]
 v_pk_fma_f32 v[102:103], v[102:103], s[78:79], s[78:79] op_sel:[0,1,0] op_sel_hi:[1,1,0]
 v_pk_fma_f32 v[104:105], v[104:105], s[78:79], s[78:79] op_sel:[0,1,0] op_sel_hi:[1,1,0]
 v_pk_fma_f32 v[106:107], v[106:107], s[78:79], s[78:79] op_sel:[0,1,0] op_sel_hi:[1,1,0]
 v_pk_mul_f32 v[100:101], v[100:101], v[208:209]
 v_pk_mul_f32 v[102:103], v[102:103], v[210:211]
 v_pk_mul_f32 v[104:105], v[104:105], v[224:225]
 v_pk_mul_f32 v[106:107], v[106:107], v[226:227]
 v_exp_f32 v100, v100
 v_exp_f32 v101, v101
 v_exp_f32 v102, v102
 v_exp_f32 v103, v103
 v_exp_f32 v104, v104
 v_exp_f32 v105, v105
 v_exp_f32 v106, v106
 v_exp_f32 v107, v107
 v_pk_add_f32 v[100:101], v[100:101], 1.0 op_sel_hi:[1,0]
 v_pk_add_f32 v[102:103], v[102:103], 1.0 op_sel_hi:[1,0]
 v_pk_add_f32 v[104:105], v[104:105], 1.0 op_sel_hi:[1,0]
 v_pk_add_f32 v[106:107], v[106:107], 1.0 op_sel_hi:[1,0]
 v_rcp_f32 v100, v100
 v_rcp_f32 v101, v101
 v_rcp_f32 v102, v102
 v_rcp_f32 v103, v103
 v_rcp_f32 v104, v104
 v_rcp_f32 v105, v105
 v_rcp_f32 v106, v106
 v_rcp_f32 v107, v107
 v_pk_mul_f32 v[100:101], v[100:101], v[208:209]
 v_pk_mul_f32 v[102:103], v[102:103], v[210:211]
 v_pk_mul_f32 v[104:105], v[104:105], v[224:225]
 v_pk_mul_f32 v[106:107], v[106:107], v[226:227]
 v_cvt_pk_bf16_f32 v208, v100, v101
 v_cvt_pk_bf16_f32 v209, v102, v103
 v_cvt_pk_bf16_f32 v210, v104, v105
 v_cvt_pk_bf16_f32 v211, v106, v107
 v_xor_b32 v14, s45, v25
 v_xor_b32 v15, 32, v14
 v_xor_b32 v4, s60, v25
 v_xor_b32 v5, 32, v4
 v_xor_b32 v6, s61, v25
 v_xor_b32 v7, 32, v6
 v_xor_b32 v9, s97, v25
 v_xor_b32 v10, 32, v9
 buffer_store_dwordx4 v[208:211], v44, s[20:23], s55 offen offset:3072 sc1
 v_pk_fma_f32 v[212:213], v[28:29], v[80:81], v[212:213] op_sel:[1,0,0] op_sel_hi:[1,1,1]
 v_pk_fma_f32 v[214:215], v[28:29], v[82:83], v[214:215] op_sel:[1,0,0] op_sel_hi:[1,1,1]
 v_pk_fma_f32 v[228:229], v[28:29], v[84:85], v[228:229] op_sel:[1,0,0] op_sel_hi:[1,1,1]
 v_pk_fma_f32 v[230:231], v[28:29], v[86:87], v[230:231] op_sel:[1,0,0] op_sel_hi:[1,1,1]
 v_pk_fma_f32 v[212:213], v[28:29], v[212:213], v[88:89] op_sel:[0,0,0] op_sel_hi:[0,1,1]
 v_pk_fma_f32 v[214:215], v[28:29], v[214:215], v[90:91] op_sel:[0,0,0] op_sel_hi:[0,1,1]
 v_pk_fma_f32 v[228:229], v[28:29], v[228:229], v[92:93] op_sel:[0,0,0] op_sel_hi:[0,1,1]
 v_pk_fma_f32 v[230:231], v[28:29], v[230:231], v[94:95] op_sel:[0,0,0] op_sel_hi:[0,1,1]
 v_pk_mul_f32 v[100:101], v[212:213], v[212:213]
 v_pk_mul_f32 v[102:103], v[214:215], v[214:215]
 v_pk_mul_f32 v[104:105], v[228:229], v[228:229]
 v_pk_mul_f32 v[106:107], v[230:231], v[230:231]
 v_pk_fma_f32 v[100:101], v[100:101], s[78:79], s[78:79] op_sel:[0,1,0] op_sel_hi:[1,1,0]
 v_pk_fma_f32 v[102:103], v[102:103], s[78:79], s[78:79] op_sel:[0,1,0] op_sel_hi:[1,1,0]
 v_pk_fma_f32 v[104:105], v[104:105], s[78:79], s[78:79] op_sel:[0,1,0] op_sel_hi:[1,1,0]
 v_pk_fma_f32 v[106:107], v[106:107], s[78:79], s[78:79] op_sel:[0,1,0] op_sel_hi:[1,1,0]
 v_pk_mul_f32 v[100:101], v[100:101], v[212:213]
 v_pk_mul_f32 v[102:103], v[102:103], v[214:215]
 v_pk_mul_f32 v[104:105], v[104:105], v[228:229]
 v_pk_mul_f32 v[106:107], v[106:107], v[230:231]
 v_exp_f32 v100, v100
 v_exp_f32 v101, v101
 v_exp_f32 v102, v102
 v_exp_f32 v103, v103
 v_exp_f32 v104, v104
 v_exp_f32 v105, v105
 v_exp_f32 v106, v106
 v_exp_f32 v107, v107
 v_pk_add_f32 v[100:101], v[100:101], 1.0 op_sel_hi:[1,0]
 v_pk_add_f32 v[102:103], v[102:103], 1.0 op_sel_hi:[1,0]
 v_pk_add_f32 v[104:105], v[104:105], 1.0 op_sel_hi:[1,0]
 v_pk_add_f32 v[106:107], v[106:107], 1.0 op_sel_hi:[1,0]
 v_rcp_f32 v100, v100
 v_rcp_f32 v101, v101
 v_rcp_f32 v102, v102
 v_rcp_f32 v103, v103
 v_rcp_f32 v104, v104
 v_rcp_f32 v105, v105
 v_rcp_f32 v106, v106
 v_rcp_f32 v107, v107
 v_pk_mul_f32 v[100:101], v[100:101], v[212:213]
 v_pk_mul_f32 v[102:103], v[102:103], v[214:215]
 v_pk_mul_f32 v[104:105], v[104:105], v[228:229]
 v_pk_mul_f32 v[106:107], v[106:107], v[230:231]
 v_cvt_pk_bf16_f32 v212, v100, v101
 v_cvt_pk_bf16_f32 v213, v102, v103
 v_cvt_pk_bf16_f32 v214, v104, v105
 v_cvt_pk_bf16_f32 v215, v106, v107
 buffer_store_dwordx4 v[212:215], v45, s[20:23], s55 offen offset:3072 sc1
 v_pk_fma_f32 v[216:217], v[30:31], v[80:81], v[216:217] op_sel:[1,0,0] op_sel_hi:[1,1,1]
 v_pk_fma_f32 v[218:219], v[30:31], v[82:83], v[218:219] op_sel:[1,0,0] op_sel_hi:[1,1,1]
 v_pk_fma_f32 v[232:233], v[30:31], v[84:85], v[232:233] op_sel:[1,0,0] op_sel_hi:[1,1,1]
 v_pk_fma_f32 v[234:235], v[30:31], v[86:87], v[234:235] op_sel:[1,0,0] op_sel_hi:[1,1,1]
 v_pk_fma_f32 v[216:217], v[30:31], v[216:217], v[88:89] op_sel:[0,0,0] op_sel_hi:[0,1,1]
 v_pk_fma_f32 v[218:219], v[30:31], v[218:219], v[90:91] op_sel:[0,0,0] op_sel_hi:[0,1,1]
 v_pk_fma_f32 v[232:233], v[30:31], v[232:233], v[92:93] op_sel:[0,0,0] op_sel_hi:[0,1,1]
 v_pk_fma_f32 v[234:235], v[30:31], v[234:235], v[94:95] op_sel:[0,0,0] op_sel_hi:[0,1,1]
 v_pk_mul_f32 v[100:101], v[216:217], v[216:217]
 v_pk_mul_f32 v[102:103], v[218:219], v[218:219]
 v_pk_mul_f32 v[104:105], v[232:233], v[232:233]
 v_pk_mul_f32 v[106:107], v[234:235], v[234:235]
 v_pk_fma_f32 v[100:101], v[100:101], s[78:79], s[78:79] op_sel:[0,1,0] op_sel_hi:[1,1,0]
 v_pk_fma_f32 v[102:103], v[102:103], s[78:79], s[78:79] op_sel:[0,1,0] op_sel_hi:[1,1,0]
 v_pk_fma_f32 v[104:105], v[104:105], s[78:79], s[78:79] op_sel:[0,1,0] op_sel_hi:[1,1,0]
 v_pk_fma_f32 v[106:107], v[106:107], s[78:79], s[78:79] op_sel:[0,1,0] op_sel_hi:[1,1,0]
 v_pk_mul_f32 v[100:101], v[100:101], v[216:217]
 v_pk_mul_f32 v[102:103], v[102:103], v[218:219]
 v_pk_mul_f32 v[104:105], v[104:105], v[232:233]
 v_pk_mul_f32 v[106:107], v[106:107], v[234:235]
 v_exp_f32 v100, v100
 v_exp_f32 v101, v101
 v_exp_f32 v102, v102
 v_exp_f32 v103, v103
 v_exp_f32 v104, v104
 v_exp_f32 v105, v105
 v_exp_f32 v106, v106
 v_exp_f32 v107, v107
 v_pk_add_f32 v[100:101], v[100:101], 1.0 op_sel_hi:[1,0]
 v_pk_add_f32 v[102:103], v[102:103], 1.0 op_sel_hi:[1,0]
 v_pk_add_f32 v[104:105], v[104:105], 1.0 op_sel_hi:[1,0]
 v_pk_add_f32 v[106:107], v[106:107], 1.0 op_sel_hi:[1,0]
 v_rcp_f32 v100, v100
 v_rcp_f32 v101, v101
 v_rcp_f32 v102, v102
 v_rcp_f32 v103, v103
 v_rcp_f32 v104, v104
 v_rcp_f32 v105, v105
 v_rcp_f32 v106, v106
 v_rcp_f32 v107, v107
 v_pk_mul_f32 v[100:101], v[100:101], v[216:217]
 v_pk_mul_f32 v[102:103], v[102:103], v[218:219]
 v_pk_mul_f32 v[104:105], v[104:105], v[232:233]
 v_pk_mul_f32 v[106:107], v[106:107], v[234:235]
 v_cvt_pk_bf16_f32 v216, v100, v101
 v_cvt_pk_bf16_f32 v217, v102, v103
 v_cvt_pk_bf16_f32 v218, v104, v105
 v_cvt_pk_bf16_f32 v219, v106, v107
 buffer_store_dwordx4 v[216:219], v46, s[20:23], s55 offen offset:3072 sc1
 s_waitcnt vmcnt(3)
 buffer_store_dword v1, v2, s[20:23], s89 offen offset:0 sc1
 v_pk_fma_f32 v[220:221], v[32:33], v[80:81], v[220:221] op_sel:[1,0,0] op_sel_hi:[1,1,1]
 v_pk_fma_f32 v[222:223], v[32:33], v[82:83], v[222:223] op_sel:[1,0,0] op_sel_hi:[1,1,1]
 v_pk_fma_f32 v[236:237], v[32:33], v[84:85], v[236:237] op_sel:[1,0,0] op_sel_hi:[1,1,1]
 v_pk_fma_f32 v[238:239], v[32:33], v[86:87], v[238:239] op_sel:[1,0,0] op_sel_hi:[1,1,1]
 v_pk_fma_f32 v[220:221], v[32:33], v[220:221], v[88:89] op_sel:[0,0,0] op_sel_hi:[0,1,1]
 v_pk_fma_f32 v[222:223], v[32:33], v[222:223], v[90:91] op_sel:[0,0,0] op_sel_hi:[0,1,1]
 v_pk_fma_f32 v[236:237], v[32:33], v[236:237], v[92:93] op_sel:[0,0,0] op_sel_hi:[0,1,1]
 v_pk_fma_f32 v[238:239], v[32:33], v[238:239], v[94:95] op_sel:[0,0,0] op_sel_hi:[0,1,1]
 ds_read_b128 v[80:83], v3 offset:512
 ds_read_b128 v[88:91], v3 offset:1024
 ds_read_b128 v[84:87], v3 offset:576
 ds_read_b128 v[92:95], v3 offset:1088
 v_pk_mul_f32 v[100:101], v[220:221], v[220:221]
 v_pk_mul_f32 v[102:103], v[222:223], v[222:223]
 v_pk_mul_f32 v[104:105], v[236:237], v[236:237]
 v_pk_mul_f32 v[106:107], v[238:239], v[238:239]
 v_pk_fma_f32 v[100:101], v[100:101], s[78:79], s[78:79] op_sel:[0,1,0] op_sel_hi:[1,1,0]
 v_pk_fma_f32 v[102:103], v[102:103], s[78:79], s[78:79] op_sel:[0,1,0] op_sel_hi:[1,1,0]
 v_pk_fma_f32 v[104:105], v[104:105], s[78:79], s[78:79] op_sel:[0,1,0] op_sel_hi:[1,1,0]
 v_pk_fma_f32 v[106:107], v[106:107], s[78:79], s[78:79] op_sel:[0,1,0] op_sel_hi:[1,1,0]
 v_pk_mul_f32 v[100:101], v[100:101], v[220:221]
 v_pk_mul_f32 v[102:103], v[102:103], v[222:223]
 v_pk_mul_f32 v[104:105], v[104:105], v[236:237]
 v_pk_mul_f32 v[106:107], v[106:107], v[238:239]
 v_exp_f32 v100, v100
 v_exp_f32 v101, v101
 v_exp_f32 v102, v102
 v_exp_f32 v103, v103
 v_exp_f32 v104, v104
 v_exp_f32 v105, v105
 v_exp_f32 v106, v106
 v_exp_f32 v107, v107
 v_pk_add_f32 v[100:101], v[100:101], 1.0 op_sel_hi:[1,0]
 v_pk_add_f32 v[102:103], v[102:103], 1.0 op_sel_hi:[1,0]
 v_pk_add_f32 v[104:105], v[104:105], 1.0 op_sel_hi:[1,0]
 v_pk_add_f32 v[106:107], v[106:107], 1.0 op_sel_hi:[1,0]
 v_rcp_f32 v100, v100
 v_rcp_f32 v101, v101
 v_rcp_f32 v102, v102
 v_rcp_f32 v103, v103
 v_rcp_f32 v104, v104
 v_rcp_f32 v105, v105
 v_rcp_f32 v106, v106
 v_rcp_f32 v107, v107
 v_pk_mul_f32 v[100:101], v[100:101], v[220:221]
 v_pk_mul_f32 v[102:103], v[102:103], v[222:223]
 v_pk_mul_f32 v[104:105], v[104:105], v[236:237]
 v_pk_mul_f32 v[106:107], v[106:107], v[238:239]
 v_cvt_pk_bf16_f32 v220, v100, v101
 v_cvt_pk_bf16_f32 v221, v102, v103
 v_cvt_pk_bf16_f32 v222, v104, v105
 v_cvt_pk_bf16_f32 v223, v106, v107
 buffer_store_dwordx4 v[220:223], v47, s[20:23], s55 offen offset:3072 sc1
 s_waitcnt lgkmcnt(3)
 v_pk_fma_f32 v[176:177], v[26:27], v[80:81], v[176:177] op_sel:[1,0,0] op_sel_hi:[1,1,1]
 v_pk_fma_f32 v[178:179], v[26:27], v[82:83], v[178:179] op_sel:[1,0,0] op_sel_hi:[1,1,1]
 s_waitcnt lgkmcnt(1)
 v_pk_fma_f32 v[192:193], v[26:27], v[84:85], v[192:193] op_sel:[1,0,0] op_sel_hi:[1,1,1]
 v_pk_fma_f32 v[194:195], v[26:27], v[86:87], v[194:195] op_sel:[1,0,0] op_sel_hi:[1,1,1]
 v_pk_fma_f32 v[176:177], v[26:27], v[176:177], v[88:89] op_sel:[0,0,0] op_sel_hi:[0,1,1]
 v_pk_fma_f32 v[178:179], v[26:27], v[178:179], v[90:91] op_sel:[0,0,0] op_sel_hi:[0,1,1]
 s_waitcnt lgkmcnt(0)
 v_pk_fma_f32 v[192:193], v[26:27], v[192:193], v[92:93] op_sel:[0,0,0] op_sel_hi:[0,1,1]
 v_pk_fma_f32 v[194:195], v[26:27], v[194:195], v[94:95] op_sel:[0,0,0] op_sel_hi:[0,1,1]
 v_pk_mul_f32 v[100:101], v[176:177], v[176:177]
 v_pk_mul_f32 v[102:103], v[178:179], v[178:179]
 v_pk_mul_f32 v[104:105], v[192:193], v[192:193]
 v_pk_mul_f32 v[106:107], v[194:195], v[194:195]
 v_pk_fma_f32 v[100:101], v[100:101], s[78:79], s[78:79] op_sel:[0,1,0] op_sel_hi:[1,1,0]
 v_pk_fma_f32 v[102:103], v[102:103], s[78:79], s[78:79] op_sel:[0,1,0] op_sel_hi:[1,1,0]
 v_pk_fma_f32 v[104:105], v[104:105], s[78:79], s[78:79] op_sel:[0,1,0] op_sel_hi:[1,1,0]
 v_pk_fma_f32 v[106:107], v[106:107], s[78:79], s[78:79] op_sel:[0,1,0] op_sel_hi:[1,1,0]
 v_pk_mul_f32 v[100:101], v[100:101], v[176:177]
 v_pk_mul_f32 v[102:103], v[102:103], v[178:179]
 v_pk_mul_f32 v[104:105], v[104:105], v[192:193]
 v_pk_mul_f32 v[106:107], v[106:107], v[194:195]
 v_exp_f32 v100, v100
 v_exp_f32 v101, v101
 v_exp_f32 v102, v102
 v_exp_f32 v103, v103
 v_exp_f32 v104, v104
 v_exp_f32 v105, v105
 v_exp_f32 v106, v106
 v_exp_f32 v107, v107
 v_pk_add_f32 v[100:101], v[100:101], 1.0 op_sel_hi:[1,0]
 v_pk_add_f32 v[102:103], v[102:103], 1.0 op_sel_hi:[1,0]
 v_pk_add_f32 v[104:105], v[104:105], 1.0 op_sel_hi:[1,0]
 v_pk_add_f32 v[106:107], v[106:107], 1.0 op_sel_hi:[1,0]
 v_rcp_f32 v100, v100
 v_rcp_f32 v101, v101
 v_rcp_f32 v102, v102
 v_rcp_f32 v103, v103
 v_rcp_f32 v104, v104
 v_rcp_f32 v105, v105
 v_rcp_f32 v106, v106
 v_rcp_f32 v107, v107
 v_pk_mul_f32 v[100:101], v[100:101], v[176:177]
 v_pk_mul_f32 v[102:103], v[102:103], v[178:179]
 v_pk_mul_f32 v[104:105], v[104:105], v[192:193]
 v_pk_mul_f32 v[106:107], v[106:107], v[194:195]
 v_cvt_pk_bf16_f32 v224, v100, v101
 v_cvt_pk_bf16_f32 v225, v102, v103
 v_cvt_pk_bf16_f32 v226, v104, v105
 v_cvt_pk_bf16_f32 v227, v106, v107
 buffer_store_dwordx4 v[224:227], v44, s[20:23], s55 offen offset:2048 sc1
 v_pk_fma_f32 v[180:181], v[28:29], v[80:81], v[180:181] op_sel:[1,0,0] op_sel_hi:[1,1,1]
 v_pk_fma_f32 v[182:183], v[28:29], v[82:83], v[182:183] op_sel:[1,0,0] op_sel_hi:[1,1,1]
 v_pk_fma_f32 v[196:197], v[28:29], v[84:85], v[196:197] op_sel:[1,0,0] op_sel_hi:[1,1,1]
 v_pk_fma_f32 v[198:199], v[28:29], v[86:87], v[198:199] op_sel:[1,0,0] op_sel_hi:[1,1,1]
 v_pk_fma_f32 v[180:181], v[28:29], v[180:181], v[88:89] op_sel:[0,0,0] op_sel_hi:[0,1,1]
 v_pk_fma_f32 v[182:183], v[28:29], v[182:183], v[90:91] op_sel:[0,0,0] op_sel_hi:[0,1,1]
 v_pk_fma_f32 v[196:197], v[28:29], v[196:197], v[92:93] op_sel:[0,0,0] op_sel_hi:[0,1,1]
 v_pk_fma_f32 v[198:199], v[28:29], v[198:199], v[94:95] op_sel:[0,0,0] op_sel_hi:[0,1,1]
 v_pk_mul_f32 v[100:101], v[180:181], v[180:181]
 v_pk_mul_f32 v[102:103], v[182:183], v[182:183]
 v_pk_mul_f32 v[104:105], v[196:197], v[196:197]
 v_pk_mul_f32 v[106:107], v[198:199], v[198:199]
 v_pk_fma_f32 v[100:101], v[100:101], s[78:79], s[78:79] op_sel:[0,1,0] op_sel_hi:[1,1,0]
 v_pk_fma_f32 v[102:103], v[102:103], s[78:79], s[78:79] op_sel:[0,1,0] op_sel_hi:[1,1,0]
 v_pk_fma_f32 v[104:105], v[104:105], s[78:79], s[78:79] op_sel:[0,1,0] op_sel_hi:[1,1,0]
 v_pk_fma_f32 v[106:107], v[106:107], s[78:79], s[78:79] op_sel:[0,1,0] op_sel_hi:[1,1,0]
 v_pk_mul_f32 v[100:101], v[100:101], v[180:181]
 v_pk_mul_f32 v[102:103], v[102:103], v[182:183]
 v_pk_mul_f32 v[104:105], v[104:105], v[196:197]
 v_pk_mul_f32 v[106:107], v[106:107], v[198:199]
 v_exp_f32 v100, v100
 v_exp_f32 v101, v101
 v_exp_f32 v102, v102
 v_exp_f32 v103, v103
 v_exp_f32 v104, v104
 v_exp_f32 v105, v105
 v_exp_f32 v106, v106
 v_exp_f32 v107, v107
 v_pk_add_f32 v[100:101], v[100:101], 1.0 op_sel_hi:[1,0]
 v_pk_add_f32 v[102:103], v[102:103], 1.0 op_sel_hi:[1,0]
 v_pk_add_f32 v[104:105], v[104:105], 1.0 op_sel_hi:[1,0]
 v_pk_add_f32 v[106:107], v[106:107], 1.0 op_sel_hi:[1,0]
 v_rcp_f32 v100, v100
 v_rcp_f32 v101, v101
 v_rcp_f32 v102, v102
 v_rcp_f32 v103, v103
 v_rcp_f32 v104, v104
 v_rcp_f32 v105, v105
 v_rcp_f32 v106, v106
 v_rcp_f32 v107, v107
 v_pk_mul_f32 v[100:101], v[100:101], v[180:181]
 v_pk_mul_f32 v[102:103], v[102:103], v[182:183]
 v_pk_mul_f32 v[104:105], v[104:105], v[196:197]
 v_pk_mul_f32 v[106:107], v[106:107], v[198:199]
 v_cvt_pk_bf16_f32 v228, v100, v101
 v_cvt_pk_bf16_f32 v229, v102, v103
 v_cvt_pk_bf16_f32 v230, v104, v105
 v_cvt_pk_bf16_f32 v231, v106, v107
 buffer_store_dwordx4 v[228:231], v45, s[20:23], s55 offen offset:2048 sc1
 v_pk_fma_f32 v[184:185], v[30:31], v[80:81], v[184:185] op_sel:[1,0,0] op_sel_hi:[1,1,1]
 v_pk_fma_f32 v[186:187], v[30:31], v[82:83], v[186:187] op_sel:[1,0,0] op_sel_hi:[1,1,1]
 v_pk_fma_f32 v[200:201], v[30:31], v[84:85], v[200:201] op_sel:[1,0,0] op_sel_hi:[1,1,1]
 v_pk_fma_f32 v[202:203], v[30:31], v[86:87], v[202:203] op_sel:[1,0,0] op_sel_hi:[1,1,1]
 v_pk_fma_f32 v[184:185], v[30:31], v[184:185], v[88:89] op_sel:[0,0,0] op_sel_hi:[0,1,1]
 v_pk_fma_f32 v[186:187], v[30:31], v[186:187], v[90:91] op_sel:[0,0,0] op_sel_hi:[0,1,1]
 v_pk_fma_f32 v[200:201], v[30:31], v[200:201], v[92:93] op_sel:[0,0,0] op_sel_hi:[0,1,1]
 v_pk_fma_f32 v[202:203], v[30:31], v[202:203], v[94:95] op_sel:[0,0,0] op_sel_hi:[0,1,1]
 v_pk_mul_f32 v[100:101], v[184:185], v[184:185]
 v_pk_mul_f32 v[102:103], v[186:187], v[186:187]
 v_pk_mul_f32 v[104:105], v[200:201], v[200:201]
 v_pk_mul_f32 v[106:107], v[202:203], v[202:203]
 v_pk_fma_f32 v[100:101], v[100:101], s[78:79], s[78:79] op_sel:[0,1,0] op_sel_hi:[1,1,0]
 v_pk_fma_f32 v[102:103], v[102:103], s[78:79], s[78:79] op_sel:[0,1,0] op_sel_hi:[1,1,0]
 v_pk_fma_f32 v[104:105], v[104:105], s[78:79], s[78:79] op_sel:[0,1,0] op_sel_hi:[1,1,0]
 v_pk_fma_f32 v[106:107], v[106:107], s[78:79], s[78:79] op_sel:[0,1,0] op_sel_hi:[1,1,0]
 v_pk_mul_f32 v[100:101], v[100:101], v[184:185]
 v_pk_mul_f32 v[102:103], v[102:103], v[186:187]
 v_pk_mul_f32 v[104:105], v[104:105], v[200:201]
 v_pk_mul_f32 v[106:107], v[106:107], v[202:203]
 v_exp_f32 v100, v100
 v_exp_f32 v101, v101
 v_exp_f32 v102, v102
 v_exp_f32 v103, v103
 v_exp_f32 v104, v104
 v_exp_f32 v105, v105
 v_exp_f32 v106, v106
 v_exp_f32 v107, v107
 v_pk_add_f32 v[100:101], v[100:101], 1.0 op_sel_hi:[1,0]
 v_pk_add_f32 v[102:103], v[102:103], 1.0 op_sel_hi:[1,0]
 v_pk_add_f32 v[104:105], v[104:105], 1.0 op_sel_hi:[1,0]
 v_pk_add_f32 v[106:107], v[106:107], 1.0 op_sel_hi:[1,0]
 v_rcp_f32 v100, v100
 v_rcp_f32 v101, v101
 v_rcp_f32 v102, v102
 v_rcp_f32 v103, v103
 v_rcp_f32 v104, v104
 v_rcp_f32 v105, v105
 v_rcp_f32 v106, v106
 v_rcp_f32 v107, v107
 v_pk_mul_f32 v[100:101], v[100:101], v[184:185]
 v_pk_mul_f32 v[102:103], v[102:103], v[186:187]
 v_pk_mul_f32 v[104:105], v[104:105], v[200:201]
 v_pk_mul_f32 v[106:107], v[106:107], v[202:203]
 v_cvt_pk_bf16_f32 v232, v100, v101
 v_cvt_pk_bf16_f32 v233, v102, v103
 v_cvt_pk_bf16_f32 v234, v104, v105
 v_cvt_pk_bf16_f32 v235, v106, v107
 buffer_store_dwordx4 v[232:235], v46, s[20:23], s55 offen offset:2048 sc1
 v_pk_fma_f32 v[188:189], v[32:33], v[80:81], v[188:189] op_sel:[1,0,0] op_sel_hi:[1,1,1]
 v_pk_fma_f32 v[190:191], v[32:33], v[82:83], v[190:191] op_sel:[1,0,0] op_sel_hi:[1,1,1]
 v_pk_fma_f32 v[204:205], v[32:33], v[84:85], v[204:205] op_sel:[1,0,0] op_sel_hi:[1,1,1]
 v_pk_fma_f32 v[206:207], v[32:33], v[86:87], v[206:207] op_sel:[1,0,0] op_sel_hi:[1,1,1]
 v_pk_fma_f32 v[188:189], v[32:33], v[188:189], v[88:89] op_sel:[0,0,0] op_sel_hi:[0,1,1]
 v_pk_fma_f32 v[190:191], v[32:33], v[190:191], v[90:91] op_sel:[0,0,0] op_sel_hi:[0,1,1]
 v_pk_fma_f32 v[204:205], v[32:33], v[204:205], v[92:93] op_sel:[0,0,0] op_sel_hi:[0,1,1]
 v_pk_fma_f32 v[206:207], v[32:33], v[206:207], v[94:95] op_sel:[0,0,0] op_sel_hi:[0,1,1]
 ds_read_b128 v[80:83], v3 offset:768
 ds_read_b128 v[88:91], v3 offset:1280
 v_pk_mul_f32 v[100:101], v[188:189], v[188:189]
 v_pk_mul_f32 v[102:103], v[190:191], v[190:191]
 v_pk_mul_f32 v[104:105], v[204:205], v[204:205]
 v_pk_mul_f32 v[106:107], v[206:207], v[206:207]
 v_pk_fma_f32 v[100:101], v[100:101], s[78:79], s[78:79] op_sel:[0,1,0] op_sel_hi:[1,1,0]
 v_pk_fma_f32 v[102:103], v[102:103], s[78:79], s[78:79] op_sel:[0,1,0] op_sel_hi:[1,1,0]
 v_pk_fma_f32 v[104:105], v[104:105], s[78:79], s[78:79] op_sel:[0,1,0] op_sel_hi:[1,1,0]
 v_pk_fma_f32 v[106:107], v[106:107], s[78:79], s[78:79] op_sel:[0,1,0] op_sel_hi:[1,1,0]
 v_pk_mul_f32 v[100:101], v[100:101], v[188:189]
 v_pk_mul_f32 v[102:103], v[102:103], v[190:191]
 v_pk_mul_f32 v[104:105], v[104:105], v[204:205]
 v_pk_mul_f32 v[106:107], v[106:107], v[206:207]
 v_exp_f32 v100, v100
 v_exp_f32 v101, v101
 v_exp_f32 v102, v102
 v_exp_f32 v103, v103
 v_exp_f32 v104, v104
 v_exp_f32 v105, v105
 v_exp_f32 v106, v106
 v_exp_f32 v107, v107
 v_pk_add_f32 v[100:101], v[100:101], 1.0 op_sel_hi:[1,0]
 v_pk_add_f32 v[102:103], v[102:103], 1.0 op_sel_hi:[1,0]
 v_pk_add_f32 v[104:105], v[104:105], 1.0 op_sel_hi:[1,0]
 v_pk_add_f32 v[106:107], v[106:107], 1.0 op_sel_hi:[1,0]
 v_rcp_f32 v100, v100
 v_rcp_f32 v101, v101
 v_rcp_f32 v102, v102
 v_rcp_f32 v103, v103
 v_rcp_f32 v104, v104
 v_rcp_f32 v105, v105
 v_rcp_f32 v106, v106
 v_rcp_f32 v107, v107
 v_pk_mul_f32 v[100:101], v[100:101], v[188:189]
 v_pk_mul_f32 v[102:103], v[102:103], v[190:191]
 v_pk_mul_f32 v[104:105], v[104:105], v[204:205]
 v_pk_mul_f32 v[106:107], v[106:107], v[206:207]
 v_cvt_pk_bf16_f32 v236, v100, v101
 v_cvt_pk_bf16_f32 v237, v102, v103
 v_cvt_pk_bf16_f32 v238, v104, v105
 v_cvt_pk_bf16_f32 v239, v106, v107
 buffer_store_dwordx4 v[236:239], v47, s[20:23], s55 offen offset:2048 sc1
 s_waitcnt lgkmcnt(1)
 v_pk_fma_f32 v[240:241], v[26:27], v[80:81], v[240:241] op_sel:[1,0,0] op_sel_hi:[1,1,1]
 v_pk_fma_f32 v[242:243], v[26:27], v[82:83], v[242:243] op_sel:[1,0,0] op_sel_hi:[1,1,1]
 s_waitcnt lgkmcnt(0)
 v_pk_fma_f32 v[240:241], v[26:27], v[240:241], v[88:89] op_sel:[0,0,0] op_sel_hi:[0,1,1]
 v_pk_fma_f32 v[242:243], v[26:27], v[242:243], v[90:91] op_sel:[0,0,0] op_sel_hi:[0,1,1]
 v_pk_mul_f32 v[100:101], v[240:241], v[240:241]
 v_pk_mul_f32 v[102:103], v[242:243], v[242:243]
 v_pk_fma_f32 v[100:101], v[100:101], s[78:79], s[78:79] op_sel:[0,1,0] op_sel_hi:[1,1,0]
 v_pk_fma_f32 v[102:103], v[102:103], s[78:79], s[78:79] op_sel:[0,1,0] op_sel_hi:[1,1,0]
 v_pk_mul_f32 v[100:101], v[100:101], v[240:241]
 v_pk_mul_f32 v[102:103], v[102:103], v[242:243]
 v_exp_f32 v100, v100
 v_exp_f32 v101, v101
 v_exp_f32 v102, v102
 v_exp_f32 v103, v103
 v_pk_add_f32 v[100:101], v[100:101], 1.0 op_sel_hi:[1,0]
 v_pk_add_f32 v[102:103], v[102:103], 1.0 op_sel_hi:[1,0]
 v_rcp_f32 v100, v100
 v_rcp_f32 v101, v101
 v_rcp_f32 v102, v102
 v_rcp_f32 v103, v103
 v_pk_mul_f32 v[100:101], v[100:101], v[240:241]
 v_pk_mul_f32 v[102:103], v[102:103], v[242:243]
 v_cvt_pk_bf16_f32 v240, v100, v101
 v_cvt_pk_bf16_f32 v241, v102, v103
 v_pk_fma_f32 v[244:245], v[28:29], v[80:81], v[244:245] op_sel:[1,0,0] op_sel_hi:[1,1,1]
 v_pk_fma_f32 v[246:247], v[28:29], v[82:83], v[246:247] op_sel:[1,0,0] op_sel_hi:[1,1,1]
 v_pk_fma_f32 v[244:245], v[28:29], v[244:245], v[88:89] op_sel:[0,0,0] op_sel_hi:[0,1,1]
 v_pk_fma_f32 v[246:247], v[28:29], v[246:247], v[90:91] op_sel:[0,0,0] op_sel_hi:[0,1,1]
 v_pk_mul_f32 v[100:101], v[244:245], v[244:245]
 v_pk_mul_f32 v[102:103], v[246:247], v[246:247]
 v_pk_fma_f32 v[100:101], v[100:101], s[78:79], s[78:79] op_sel:[0,1,0] op_sel_hi:[1,1,0]
 v_pk_fma_f32 v[102:103], v[102:103], s[78:79], s[78:79] op_sel:[0,1,0] op_sel_hi:[1,1,0]
 v_pk_mul_f32 v[100:101], v[100:101], v[244:245]
 v_pk_mul_f32 v[102:103], v[102:103], v[246:247]
 v_exp_f32 v100, v100
 v_exp_f32 v101, v101
 v_exp_f32 v102, v102
 v_exp_f32 v103, v103
 v_pk_add_f32 v[100:101], v[100:101], 1.0 op_sel_hi:[1,0]
 v_pk_add_f32 v[102:103], v[102:103], 1.0 op_sel_hi:[1,0]
 v_rcp_f32 v100, v100
 v_rcp_f32 v101, v101
 v_rcp_f32 v102, v102
 v_rcp_f32 v103, v103
 v_pk_mul_f32 v[100:101], v[100:101], v[244:245]
 v_pk_mul_f32 v[102:103], v[102:103], v[246:247]
 v_cvt_pk_bf16_f32 v242, v100, v101
 v_cvt_pk_bf16_f32 v243, v102, v103
 ds_read_b64_tr_b16 a[96:97], v14 offset:0
L_pg9:
 s_cbranch_execz L_pg13
 ds_read_b64_tr_b16 a[98:99], v14 offset:8192
 ds_read_b64_tr_b16 a[100:101], v14 offset:16384
 ds_read_b64_tr_b16 a[102:103], v14 offset:24576
 ds_read_b64_tr_b16 a[104:105], v15 offset:0
 ds_read_b64_tr_b16 a[106:107], v15 offset:8192
 ds_read_b64_tr_b16 a[108:109], v15 offset:16384
 ds_read_b64_tr_b16 a[110:111], v15 offset:24576
 v_pk_fma_f32 v[248:249], v[30:31], v[80:81], v[248:249] op_sel:[1,0,0] op_sel_hi:[1,1,1]
 v_pk_fma_f32 v[250:251], v[30:31], v[82:83], v[250:251] op_sel:[1,0,0] op_sel_hi:[1,1,1]
 v_pk_fma_f32 v[248:249], v[30:31], v[248:249], v[88:89] op_sel:[0,0,0] op_sel_hi:[0,1,1]
 v_pk_fma_f32 v[250:251], v[30:31], v[250:251], v[90:91] op_sel:[0,0,0] op_sel_hi:[0,1,1]
 v_pk_mul_f32 v[100:101], v[248:249], v[248:249]
 v_pk_mul_f32 v[102:103], v[250:251], v[250:251]
 v_pk_fma_f32 v[100:101], v[100:101], s[78:79], s[78:79] op_sel:[0,1,0] op_sel_hi:[1,1,0]
 v_pk_fma_f32 v[102:103], v[102:103], s[78:79], s[78:79] op_sel:[0,1,0] op_sel_hi:[1,1,0]
 v_pk_mul_f32 v[100:101], v[100:101], v[248:249]
 v_pk_mul_f32 v[102:103], v[102:103], v[250:251]
 v_exp_f32 v100, v100
 v_exp_f32 v101, v101
 v_exp_f32 v102, v102
 v_exp_f32 v103, v103
 v_pk_add_f32 v[100:101], v[100:101], 1.0 op_sel_hi:[1,0]
 v_pk_add_f32 v[102:103], v[102:103], 1.0 op_sel_hi:[1,0]
 v_rcp_f32 v100, v100
 v_rcp_f32 v101, v101
 v_rcp_f32 v102, v102
 v_rcp_f32 v103, v103
 v_pk_mul_f32 v[100:101], v[100:101], v[248:249]
 v_pk_mul_f32 v[102:103], v[102:103], v[250:251]
 v_cvt_pk_bf16_f32 v248, v100, v101
 v_cvt_pk_bf16_f32 v249, v102, v103
 buffer_load_dword v17, v18, s[20:23], s86 offen offset:0 sc1
 v_pk_fma_f32 v[252:253], v[32:33], v[80:81], v[252:253] op_sel:[1,0,0] op_sel_hi:[1,1,1]
 v_pk_fma_f32 v[254:255], v[32:33], v[82:83], v[254:255] op_sel:[1,0,0] op_sel_hi:[1,1,1]
 v_pk_fma_f32 v[252:253], v[32:33], v[252:253], v[88:89] op_sel:[0,0,0] op_sel_hi:[0,1,1]
 v_pk_fma_f32 v[254:255], v[32:33], v[254:255], v[90:91] op_sel:[0,0,0] op_sel_hi:[0,1,1]
 v_pk_mul_f32 v[100:101], v[252:253], v[252:253]
 v_pk_mul_f32 v[102:103], v[254:255], v[254:255]
 v_pk_fma_f32 v[100:101], v[100:101], s[78:79], s[78:79] op_sel:[0,1,0] op_sel_hi:[1,1,0]
 v_pk_fma_f32 v[102:103], v[102:103], s[78:79], s[78:79] op_sel:[0,1,0] op_sel_hi:[1,1,0]
 v_pk_mul_f32 v[100:101], v[100:101], v[252:253]
 v_pk_mul_f32 v[102:103], v[102:103], v[254:255]
 v_exp_f32 v100, v100
 v_exp_f32 v101, v101
 v_exp_f32 v102, v102
 v_exp_f32 v103, v103
 v_pk_add_f32 v[100:101], v[100:101], 1.0 op_sel_hi:[1,0]
 v_pk_add_f32 v[102:103], v[102:103], 1.0 op_sel_hi:[1,0]
 v_rcp_f32 v100, v100
 v_rcp_f32 v101, v101
 v_rcp_f32 v102, v102
 v_rcp_f32 v103, v103
 v_pk_mul_f32 v[100:101], v[100:101], v[252:253]
 v_pk_mul_f32 v[102:103], v[102:103], v[254:255]
 v_cvt_pk_bf16_f32 v250, v100, v101
 v_cvt_pk_bf16_f32 v251, v102, v103
 s_waitcnt lgkmcnt(4)
 v_mfma_f32_16x16x32_bf16 v[80:83], a[96:99], v[48:51], 0
 ds_read_b64_tr_b16 a[112:113], v4 offset:0
 v_mfma_f32_16x16x32_bf16 v[80:83], a[100:103], v[64:67], v[80:83]
 ds_read_b64_tr_b16 a[114:115], v4 offset:8192
 v_mfma_f32_16x16x32_bf16 v[84:87], a[100:103], v[68:71], 0
 ds_read_b64_tr_b16 a[116:117], v4 offset:16384
 v_mfma_f32_16x16x32_bf16 v[84:87], a[96:99], v[52:55], v[84:87]
 ds_read_b64_tr_b16 a[118:119], v4 offset:24576
 v_mfma_f32_16x16x32_bf16 v[88:91], a[96:99], v[56:59], 0
 v_mfma_f32_16x16x32_bf16 v[88:91], a[100:103], v[72:75], v[88:91]
 s_add_u32 s3, s58, 0
 v_mfma_f32_16x16x32_bf16 v[92:95], a[100:103], v[76:79], 0
 buffer_store_dwordx4 v[240:243], v8, s[20:23], s3 offen sc1
 v_mfma_f32_16x16x32_bf16 v[92:95], a[96:99], v[60:63], v[92:95]
 s_waitcnt lgkmcnt(4)
 v_mfma_f32_16x16x32_bf16 v[108:111], a[104:107], v[60:63], 0
 ds_read_b64_tr_b16 a[120:121], v5 offset:0
 v_mfma_f32_16x16x32_bf16 v[108:111], a[108:111], v[76:79], v[108:111]
 ds_read_b64_tr_b16 a[122:123], v5 offset:8192
 v_mfma_f32_16x16x32_bf16 v[104:107], a[108:111], v[72:75], 0
 ds_read_b64_tr_b16 a[124:125], v5 offset:16384
 v_mfma_f32_16x16x32_bf16 v[104:107], a[104:107], v[56:59], v[104:107]
 ds_read_b64_tr_b16 a[126:127], v5 offset:24576
 s_add_u32 s3, s58, 294912
 v_mfma_f32_16x16x32_bf16 v[100:103], a[104:107], v[52:55], 0
 buffer_store_dwordx4 v[248:251], v8, s[20:23], s3 offen sc1
 s_cmp_le_u32 s63, 4
 s_addc_u32 s33, 4, 0
 v_mfma_f32_16x16x32_bf16 v[100:103], a[108:111], v[68:71], v[100:103]
 s_add_u32 s33, s33, s65
 s_and_b32 s33, s33, 7
 s_mul_i32 s33, s33, s64
 s_add_u32 s32, s33, s43
 s_add_u32 m0, s47, 102400
 v_mfma_f32_16x16x32_bf16 v[96:99], a[108:111], v[64:67], 0
 buffer_load_dwordx4 v20, s[12:15], s32 offen lds
 v_mfma_f32_16x16x32_bf16 v[96:99], a[104:107], v[48:51], v[96:99]
 s_waitcnt lgkmcnt(4)
 v_mfma_f32_16x16x32_bf16 v[112:115], a[112:115], v[48:51], 0
 ds_read_b64_tr_b16 a[96:97], v6 offset:0
 v_mfma_f32_16x16x32_bf16 v[112:115], a[116:119], v[64:67], v[112:115]
 ds_read_b64_tr_b16 a[98:99], v6 offset:8192
 v_mfma_f32_16x16x32_bf16 v[116:119], a[116:119], v[68:71], 0
 ds_read_b64_tr_b16 a[100:101], v6 offset:16384
 v_mfma_f32_16x16x32_bf16 v[116:119], a[112:115], v[52:55], v[116:119]
 ds_read_b64_tr_b16 a[102:103], v6 offset:24576
 s_add_u32 m0, s47, 103424
 v_mfma_f32_16x16x32_bf16 v[120:123], a[112:115], v[56:59], 0
 buffer_load_dwordx4 v21, s[12:15], s32 offen lds
 s_add_u32 s32, s32, 16384
 v_mfma_f32_16x16x32_bf16 v[120:123], a[116:119], v[72:75], v[120:123]
 s_add_u32 m0, s47, 104448
 v_mfma_f32_16x16x32_bf16 v[124:127], a[116:119], v[76:79], 0
 buffer_load_dwordx4 v20, s[12:15], s32 offen lds
 v_mfma_f32_16x16x32_bf16 v[124:127], a[112:115], v[60:63], v[124:127]
 s_waitcnt lgkmcnt(4)
 v_mfma_f32_16x16x32_bf16 v[140:143], a[120:123], v[60:63], 0
 ds_read_b64_tr_b16 a[104:105], v7 offset:0
 v_mfma_f32_16x16x32_bf16 v[140:143], a[124:127], v[76:79], v[140:143]
 ds_read_b64_tr_b16 a[106:107], v7 offset:8192
 v_mfma_f32_16x16x32_bf16 v[136:139], a[124:127], v[72:75], 0
 ds_read_b64_tr_b16 a[108:109], v7 offset:16384
 v_mfma_f32_16x16x32_bf16 v[136:139], a[120:123], v[56:59], v[136:139]
 ds_read_b64_tr_b16 a[110:111], v7 offset:24576
 s_add_u32 m0, s47, 105472
 v_mfma_f32_16x16x32_bf16 v[132:135], a[120:123], v[52:55], 0
 buffer_load_dwordx4 v21, s[12:15], s32 offen lds
 s_cmp_le_u32 s63, 0
 s_addc_u32 s37, 0, 0
 v_mfma_f32_16x16x32_bf16 v[132:135], a[124:127], v[68:71], v[132:135]
 v_mfma_f32_16x16x32_bf16 v[128:131], a[124:127], v[64:67], 0
 v_mfma_f32_16x16x32_bf16 v[128:131], a[120:123], v[48:51], v[128:131]
 s_waitcnt lgkmcnt(4)
 v_mfma_f32_16x16x32_bf16 v[144:147], a[96:99], v[48:51], 0
 ds_read_b64_tr_b16 a[112:113], v9 offset:0
 v_mfma_f32_16x16x32_bf16 v[144:147], a[100:103], v[64:67], v[144:147]
 ds_read_b64_tr_b16 a[114:115], v9 offset:8192
 v_mfma_f32_16x16x32_bf16 v[148:151], a[100:103], v[68:71], 0
 ds_read_b64_tr_b16 a[116:117], v9 offset:16384
 s_waitcnt vmcnt(6)
 v_cmp_gt_u32 vcc, 1, v17
 v_mfma_f32_16x16x32_bf16 v[148:151], a[96:99], v[52:55], v[148:151]
 ds_read_b64_tr_b16 a[118:119], v9 offset:24576
 s_lshl_b32 s31, s37, 12
 s_cbranch_vccnz L_ph1_wait
L_ph1_ok:
 v_mfma_f32_16x16x32_bf16 v[152:155], a[96:99], v[56:59], 0
 buffer_load_dwordx4 a[64:67], v44, s[20:23], s31 offen offset:0 sc1
 v_mfma_f32_16x16x32_bf16 v[152:155], a[100:103], v[72:75], v[152:155]
 v_mfma_f32_16x16x32_bf16 v[156:159], a[100:103], v[76:79], 0
 buffer_load_dwordx4 a[68:71], v44, s[20:23], s31 offen offset:1024 sc1
 v_mfma_f32_16x16x32_bf16 v[156:159], a[96:99], v[60:63], v[156:159]
 s_waitcnt lgkmcnt(4)
 v_mfma_f32_16x16x32_bf16 v[172:175], a[104:107], v[60:63], 0
 ds_read_b64_tr_b16 a[120:121], v10 offset:0
 v_mfma_f32_16x16x32_bf16 v[172:175], a[108:111], v[76:79], v[172:175]
 ds_read_b64_tr_b16 a[122:123], v10 offset:8192
 v_mfma_f32_16x16x32_bf16 v[168:171], a[108:111], v[72:75], 0
 ds_read_b64_tr_b16 a[124:125], v10 offset:16384
 v_mfma_f32_16x16x32_bf16 v[168:171], a[104:107], v[56:59], v[168:171]
 ds_read_b64_tr_b16 a[126:127], v10 offset:24576
 v_mfma_f32_16x16x32_bf16 v[164:167], a[104:107], v[52:55], 0
 buffer_load_dwordx4 a[76:79], v45, s[20:23], s31 offen offset:1024 sc1
 v_mfma_f32_16x16x32_bf16 v[164:167], a[108:111], v[68:71], v[164:167]
 v_mfma_f32_16x16x32_bf16 v[160:163], a[108:111], v[64:67], 0
 buffer_load_dwordx4 a[72:75], v45, s[20:23], s31 offen offset:0 sc1
 v_mfma_f32_16x16x32_bf16 v[160:163], a[104:107], v[48:51], v[160:163]
 s_waitcnt lgkmcnt(4)
 v_mfma_f32_16x16x32_bf16 v[176:179], a[112:115], v[48:51], 0
 ds_read_b64_tr_b16 a[96:97], v14 offset:4096
 v_mfma_f32_16x16x32_bf16 v[176:179], a[116:119], v[64:67], v[176:179]
 ds_read_b64_tr_b16 a[98:99], v14 offset:12288
 v_mfma_f32_16x16x32_bf16 v[180:183], a[116:119], v[68:71], 0
 ds_read_b64_tr_b16 a[100:101], v14 offset:20480
 v_mfma_f32_16x16x32_bf16 v[180:183], a[112:115], v[52:55], v[180:183]
 ds_read_b64_tr_b16 a[102:103], v14 offset:28672
 v_mfma_f32_16x16x32_bf16 v[184:187], a[112:115], v[56:59], 0
 buffer_load_dwordx4 a[80:83], v46, s[20:23], s31 offen offset:0 sc1
 v_mfma_f32_16x16x32_bf16 v[184:187], a[116:119], v[72:75], v[184:187]
 v_mfma_f32_16x16x32_bf16 v[188:191], a[116:119], v[76:79], 0
 buffer_load_dwordx4 a[84:87], v46, s[20:23], s31 offen offset:1024 sc1
 v_mfma_f32_16x16x32_bf16 v[188:191], a[112:115], v[60:63], v[188:191]
 s_waitcnt lgkmcnt(4)
 v_mfma_f32_16x16x32_bf16 v[204:207], a[120:123], v[60:63], 0
 ds_read_b64_tr_b16 a[104:105], v15 offset:4096
 v_mfma_f32_16x16x32_bf16 v[204:207], a[124:127], v[76:79], v[204:207]
 ds_read_b64_tr_b16 a[106:107], v15 offset:12288
 v_mfma_f32_16x16x32_bf16 v[200:203], a[124:127], v[72:75], 0
 ds_read_b64_tr_b16 a[108:109], v15 offset:20480
 v_mfma_f32_16x16x32_bf16 v[200:203], a[120:123], v[56:59], v[200:203]
 ds_read_b64_tr_b16 a[110:111], v15 offset:28672
 v_mfma_f32_16x16x32_bf16 v[196:199], a[120:123], v[52:55], 0
 buffer_load_dwordx4 a[92:95], v47, s[20:23], s31 offen offset:1024 sc1
 v_mfma_f32_16x16x32_bf16 v[196:199], a[124:127], v[68:71], v[196:199]
 v_mfma_f32_16x16x32_bf16 v[192:195], a[124:127], v[64:67], 0
 buffer_load_dwordx4 a[88:91], v47, s[20:23], s31 offen offset:0 sc1
 v_mfma_f32_16x16x32_bf16 v[192:195], a[120:123], v[48:51], v[192:195]
 s_waitcnt lgkmcnt(4)
 v_mfma_f32_16x16x32_bf16 v[80:83], a[96:99], v[224:227], v[80:83]
 ds_read_b64_tr_b16 a[112:113], v4 offset:4096
 s_cmp_le_u32 s63, 5
 s_addc_u32 s33, 5, 0
 v_mfma_f32_16x16x32_bf16 v[80:83], a[100:103], v[208:211], v[80:83]
 ds_read_b64_tr_b16 a[114:115], v4 offset:12288
 s_add_u32 s33, s33, s65
 v_mfma_f32_16x16x32_bf16 v[84:87], a[100:103], v[212:215], v[84:87]
 ds_read_b64_tr_b16 a[116:117], v4 offset:20480
 s_and_b32 s33, s33, 7
 s_mul_i32 s33, s33, s64
 v_mfma_f32_16x16x32_bf16 v[84:87], a[96:99], v[228:231], v[84:87]
 ds_read_b64_tr_b16 a[118:119], v4 offset:28672
 s_add_u32 s32, s33, s43
 s_add_u32 m0, s47, 118784
 v_mfma_f32_16x16x32_bf16 v[88:91], a[96:99], v[232:235], v[88:91]
 buffer_load_dwordx4 v20, s[12:15], s32 offen lds
 v_mfma_f32_16x16x32_bf16 v[88:91], a[100:103], v[216:219], v[88:91]
 s_add_u32 m0, s47, 119808
 v_mfma_f32_16x16x32_bf16 v[92:95], a[100:103], v[220:223], v[92:95]
 buffer_load_dwordx4 v21, s[12:15], s32 offen lds
 s_add_u32 s32, s32, 16384
 v_mfma_f32_16x16x32_bf16 v[92:95], a[96:99], v[236:239], v[92:95]
 s_waitcnt lgkmcnt(4)
 v_mfma_f32_16x16x32_bf16 v[108:111], a[104:107], v[236:239], v[108:111]
 ds_read_b64_tr_b16 a[120:121], v5 offset:4096
 v_add_u32 v48, 69632, v14
 v_mfma_f32_16x16x32_bf16 v[108:111], a[108:111], v[220:223], v[108:111]
 ds_read_b64_tr_b16 a[122:123], v5 offset:12288
 v_add_u32 v49, 69632, v15
 v_mfma_f32_16x16x32_bf16 v[104:107], a[108:111], v[216:219], v[104:107]
 ds_read_b64_tr_b16 a[124:125], v5 offset:20480
 v_add_u32 v50, 69632, v4
 v_mfma_f32_16x16x32_bf16 v[104:107], a[104:107], v[232:235], v[104:107]
 ds_read_b64_tr_b16 a[126:127], v5 offset:28672
 s_add_u32 m0, s47, 120832
 v_mfma_f32_16x16x32_bf16 v[100:103], a[104:107], v[228:231], v[100:103]
 buffer_load_dwordx4 v20, s[12:15], s32 offen lds
 v_add_u32 v51, 69632, v5
 v_mfma_f32_16x16x32_bf16 v[100:103], a[108:111], v[212:215], v[100:103]
 v_add_u32 v52, 69632, v6
 v_mfma_f32_16x16x32_bf16 v[96:99], a[108:111], v[208:211], v[96:99]
 v_add_u32 v53, 69632, v7
 v_mfma_f32_16x16x32_bf16 v[96:99], a[104:107], v[224:227], v[96:99]
 s_waitcnt lgkmcnt(4)
 v_add_u32 v54, 69632, v9
 v_mfma_f32_16x16x32_bf16 v[112:115], a[112:115], v[224:227], v[112:115]
 ds_read_b64_tr_b16 a[96:97], v6 offset:4096
 v_add_u32 v55, 69632, v10
 v_mfma_f32_16x16x32_bf16 v[112:115], a[116:119], v[208:211], v[112:115]
 ds_read_b64_tr_b16 a[98:99], v6 offset:12288
 v_min_u32 v22, 3, v0
 v_mfma_f32_16x16x32_bf16 v[116:119], a[116:119], v[212:215], v[116:119]
 ds_read_b64_tr_b16 a[100:101], v6 offset:20480
 v_lshlrev_b32 v22, 7, v22
 v_mfma_f32_16x16x32_bf16 v[116:119], a[112:115], v[228:231], v[116:119]
 ds_read_b64_tr_b16 a[102:103], v6 offset:28672
 s_add_u32 m0, s47, 121856
 v_mfma_f32_16x16x32_bf16 v[120:123], a[112:115], v[232:235], v[120:123]
 buffer_load_dwordx4 v21, s[12:15], s32 offen lds
 s_cmp_le_u32 s63, 1
 s_addc_u32 s37, 1, 0
 v_mfma_f32_16x16x32_bf16 v[120:123], a[116:119], v[216:219], v[120:123]
 s_lshl_b32 s31, s37, 12
 v_mov_b32 v23, s101
 v_mfma_f32_16x16x32_bf16 v[124:127], a[116:119], v[220:223], v[124:127]
 buffer_load_dwordx4 a[128:131], v44, s[20:23], s31 offen offset:0 sc1
 v_add_co_u32 v22, vcc, s100, v22
 v_mfma_f32_16x16x32_bf16 v[124:127], a[112:115], v[236:239], v[124:127]
 s_waitcnt lgkmcnt(4)
 v_addc_co_u32 v23, vcc, 0, v23, vcc
 v_mfma_f32_16x16x32_bf16 v[140:143], a[120:123], v[236:239], v[140:143]
 ds_read_b64_tr_b16 a[104:105], v7 offset:4096
 v_mfma_f32_16x16x32_bf16 v[140:143], a[124:127], v[220:223], v[140:143]
 ds_read_b64_tr_b16 a[106:107], v7 offset:12288
 v_mfma_f32_16x16x32_bf16 v[136:139], a[124:127], v[216:219], v[136:139]
 ds_read_b64_tr_b16 a[108:109], v7 offset:20480
 v_mfma_f32_16x16x32_bf16 v[136:139], a[120:123], v[232:235], v[136:139]
 ds_read_b64_tr_b16 a[110:111], v7 offset:28672
 v_mfma_f32_16x16x32_bf16 v[132:135], a[120:123], v[228:231], v[132:135]
 buffer_load_dwordx4 a[132:135], v44, s[20:23], s31 offen offset:1024 sc1
 v_mfma_f32_16x16x32_bf16 v[132:135], a[124:127], v[212:215], v[132:135]
 global_load_dword a252, v[22:23], off
 v_mfma_f32_16x16x32_bf16 v[128:131], a[124:127], v[208:211], v[128:131]
 v_mfma_f32_16x16x32_bf16 v[128:131], a[120:123], v[224:227], v[128:131]
 s_waitcnt lgkmcnt(4)
 v_mfma_f32_16x16x32_bf16 v[144:147], a[96:99], v[224:227], v[144:147]
 ds_read_b64_tr_b16 a[112:113], v9 offset:4096
 v_mfma_f32_16x16x32_bf16 v[144:147], a[100:103], v[208:211], v[144:147]
 ds_read_b64_tr_b16 a[114:115], v9 offset:12288
 v_mfma_f32_16x16x32_bf16 v[148:151], a[100:103], v[212:215], v[148:151]
 ds_read_b64_tr_b16 a[116:117], v9 offset:20480
 v_mfma_f32_16x16x32_bf16 v[148:151], a[96:99], v[228:231], v[148:151]
 ds_read_b64_tr_b16 a[118:119], v9 offset:28672
 v_mfma_f32_16x16x32_bf16 v[152:155], a[96:99], v[232:235], v[152:155]
 buffer_load_dwordx4 a[140:143], v45, s[20:23], s31 offen offset:1024 sc1
 v_mfma_f32_16x16x32_bf16 v[152:155], a[100:103], v[216:219], v[152:155]
 v_mfma_f32_16x16x32_bf16 v[156:159], a[100:103], v[220:223], v[156:159]
 buffer_load_dwordx4 a[136:139], v45, s[20:23], s31 offen offset:0 sc1
 v_mfma_f32_16x16x32_bf16 v[156:159], a[96:99], v[236:239], v[156:159]
 s_waitcnt lgkmcnt(4)
 v_mfma_f32_16x16x32_bf16 v[172:175], a[104:107], v[236:239], v[172:175]
 ds_read_b64_tr_b16 a[120:121], v10 offset:4096
 v_mfma_f32_16x16x32_bf16 v[172:175], a[108:111], v[220:223], v[172:175]
 ds_read_b64_tr_b16 a[122:123], v10 offset:12288
 v_mfma_f32_16x16x32_bf16 v[168:171], a[108:111], v[216:219], v[168:171]
 ds_read_b64_tr_b16 a[124:125], v10 offset:20480
 v_mfma_f32_16x16x32_bf16 v[168:171], a[104:107], v[232:235], v[168:171]
 ds_read_b64_tr_b16 a[126:127], v10 offset:28672
 v_mfma_f32_16x16x32_bf16 v[164:167], a[104:107], v[228:231], v[164:167]
 buffer_load_dwordx4 a[144:147], v46, s[20:23], s31 offen offset:0 sc1
 v_mfma_f32_16x16x32_bf16 v[164:167], a[108:111], v[212:215], v[164:167]
 v_mfma_f32_16x16x32_bf16 v[160:163], a[108:111], v[208:211], v[160:163]
 v_mfma_f32_16x16x32_bf16 v[160:163], a[104:107], v[224:227], v[160:163]
 s_waitcnt lgkmcnt(4)
 v_mfma_f32_16x16x32_bf16 v[176:179], a[112:115], v[224:227], v[176:179]
 ds_read_b64_tr_b16 a[96:97], v14 offset:32768
 v_mfma_f32_16x16x32_bf16 v[176:179], a[116:119], v[208:211], v[176:179]
 ds_read_b64_tr_b16 a[98:99], v14 offset:40960
 v_mfma_f32_16x16x32_bf16 v[180:183], a[116:119], v[212:215], v[180:183]
 ds_read_b64_tr_b16 a[100:101], v14 offset:49152
 v_mfma_f32_16x16x32_bf16 v[180:183], a[112:115], v[228:231], v[180:183]
 ds_read_b64_tr_b16 a[102:103], v14 offset:57344
 v_mfma_f32_16x16x32_bf16 v[184:187], a[112:115], v[232:235], v[184:187]
 buffer_load_dwordx4 a[148:151], v46, s[20:23], s31 offen offset:1024 sc1
 v_mfma_f32_16x16x32_bf16 v[184:187], a[116:119], v[216:219], v[184:187]
 v_mfma_f32_16x16x32_bf16 v[188:191], a[116:119], v[220:223], v[188:191]
 buffer_load_dwordx4 a[156:159], v47, s[20:23], s31 offen offset:1024 sc1
 v_mfma_f32_16x16x32_bf16 v[188:191], a[112:115], v[236:239], v[188:191]
 s_waitcnt lgkmcnt(4)
 v_mfma_f32_16x16x32_bf16 v[204:207], a[120:123], v[236:239], v[204:207]
 ds_read_b64_tr_b16 a[104:105], v15 offset:32768
 v_mfma_f32_16x16x32_bf16 v[204:207], a[124:127], v[220:223], v[204:207]
 ds_read_b64_tr_b16 a[106:107], v15 offset:40960
 v_mfma_f32_16x16x32_bf16 v[200:203], a[124:127], v[216:219], v[200:203]
 ds_read_b64_tr_b16 a[108:109], v15 offset:49152
 v_mfma_f32_16x16x32_bf16 v[200:203], a[120:123], v[232:235], v[200:203]
 ds_read_b64_tr_b16 a[110:111], v15 offset:57344
 v_mfma_f32_16x16x32_bf16 v[196:199], a[120:123], v[228:231], v[196:199]
 buffer_load_dwordx4 a[152:155], v47, s[20:23], s31 offen offset:0 sc1
 v_mfma_f32_16x16x32_bf16 v[196:199], a[124:127], v[212:215], v[196:199]
 v_mfma_f32_16x16x32_bf16 v[192:195], a[124:127], v[208:211], v[192:195]
 v_mfma_f32_16x16x32_bf16 v[192:195], a[120:123], v[224:227], v[192:195]
 s_waitcnt vmcnt(17) lgkmcnt(4)
 v_mfma_f32_16x16x32_bf16 v[80:83], a[96:99], a[64:67], v[80:83]
 ds_read_b64_tr_b16 a[112:113], v4 offset:32768
 v_mfma_f32_16x16x32_bf16 v[80:83], a[100:103], a[68:71], v[80:83]
 ds_read_b64_tr_b16 a[114:115], v4 offset:40960
 v_mfma_f32_16x16x32_bf16 v[84:87], a[100:103], a[76:79], v[84:87]
 ds_read_b64_tr_b16 a[116:117], v4 offset:49152
 v_mfma_f32_16x16x32_bf16 v[84:87], a[96:99], a[72:75], v[84:87]
 ds_read_b64_tr_b16 a[118:119], v4 offset:57344
 s_waitcnt vmcnt(13)
 v_mfma_f32_16x16x32_bf16 v[88:91], a[96:99], a[80:83], v[88:91]
 v_mfma_f32_16x16x32_bf16 v[88:91], a[100:103], a[84:87], v[88:91]
 s_waitcnt vmcnt(9)
 s_barrier
 v_mfma_f32_16x16x32_bf16 v[92:95], a[100:103], a[92:95], v[92:95]
 v_mfma_f32_16x16x32_bf16 v[92:95], a[96:99], a[88:91], v[92:95]
 s_waitcnt lgkmcnt(4)
 v_mfma_f32_16x16x32_bf16 v[108:111], a[104:107], a[88:91], v[108:111]
 ds_read_b64_tr_b16 a[120:121], v5 offset:32768
 s_cmp_le_u32 s63, 6
 s_addc_u32 s33, 6, 0
 v_mfma_f32_16x16x32_bf16 v[108:111], a[108:111], a[92:95], v[108:111]
 ds_read_b64_tr_b16 a[122:123], v5 offset:40960
 s_add_u32 s33, s33, s65
 v_mfma_f32_16x16x32_bf16 v[104:107], a[108:111], a[84:87], v[104:107]
 ds_read_b64_tr_b16 a[124:125], v5 offset:49152
 s_and_b32 s33, s33, 7
 s_mul_i32 s33, s33, s64
 v_mfma_f32_16x16x32_bf16 v[104:107], a[104:107], a[80:83], v[104:107]
 ds_read_b64_tr_b16 a[126:127], v5 offset:57344
 s_add_u32 s32, s33, s43
 s_add_u32 m0, s39, 0
 v_mfma_f32_16x16x32_bf16 v[100:103], a[104:107], a[72:75], v[100:103]
 buffer_load_dwordx4 v20, s[12:15], s32 offen lds
 v_mfma_f32_16x16x32_bf16 v[100:103], a[108:111], a[76:79], v[100:103]
 s_add_u32 m0, s39, 1024
 v_mfma_f32_16x16x32_bf16 v[96:99], a[108:111], a[68:71], v[96:99]
 buffer_load_dwordx4 v21, s[12:15], s32 offen lds
 s_add_u32 s32, s32, 16384
 v_mfma_f32_16x16x32_bf16 v[96:99], a[104:107], a[64:67], v[96:99]
 s_waitcnt lgkmcnt(4)
 v_mfma_f32_16x16x32_bf16 v[112:115], a[112:115], a[64:67], v[112:115]
 ds_read_b64_tr_b16 a[96:97], v6 offset:32768
 v_mfma_f32_16x16x32_bf16 v[112:115], a[116:119], a[68:71], v[112:115]
 ds_read_b64_tr_b16 a[98:99], v6 offset:40960
 v_mfma_f32_16x16x32_bf16 v[116:119], a[116:119], a[76:79], v[116:119]
 ds_read_b64_tr_b16 a[100:101], v6 offset:49152
 v_mfma_f32_16x16x32_bf16 v[116:119], a[112:115], a[72:75], v[116:119]
 ds_read_b64_tr_b16 a[102:103], v6 offset:57344
 s_add_u32 m0, s39, 2048
 v_mfma_f32_16x16x32_bf16 v[120:123], a[112:115], a[80:83], v[120:123]
 buffer_load_dwordx4 v20, s[12:15], s32 offen lds
 v_mfma_f32_16x16x32_bf16 v[120:123], a[116:119], a[84:87], v[120:123]
 s_add_u32 m0, s39, 3072
 v_mfma_f32_16x16x32_bf16 v[124:127], a[116:119], a[92:95], v[124:127]
 buffer_load_dwordx4 v21, s[12:15], s32 offen lds
 s_cmp_le_u32 s63, 2
 s_addc_u32 s37, 2, 0
 v_mfma_f32_16x16x32_bf16 v[124:127], a[112:115], a[88:91], v[124:127]
 s_waitcnt lgkmcnt(4)
 v_mfma_f32_16x16x32_bf16 v[140:143], a[120:123], a[88:91], v[140:143]
 ds_read_b64_tr_b16 a[104:105], v7 offset:32768
 v_mfma_f32_16x16x32_bf16 v[140:143], a[124:127], a[92:95], v[140:143]
 ds_read_b64_tr_b16 a[106:107], v7 offset:40960
 v_mfma_f32_16x16x32_bf16 v[136:139], a[124:127], a[84:87], v[136:139]
 ds_read_b64_tr_b16 a[108:109], v7 offset:49152
 v_mfma_f32_16x16x32_bf16 v[136:139], a[120:123], a[80:83], v[136:139]
 ds_read_b64_tr_b16 a[110:111], v7 offset:57344
 s_lshl_b32 s31, s37, 12
 v_mfma_f32_16x16x32_bf16 v[132:135], a[120:123], a[72:75], v[132:135]
 buffer_load_dwordx4 a[160:163], v44, s[20:23], s31 offen offset:0 sc1
 v_mfma_f32_16x16x32_bf16 v[132:135], a[124:127], a[76:79], v[132:135]
 v_mfma_f32_16x16x32_bf16 v[128:131], a[124:127], a[68:71], v[128:131]
 buffer_load_dwordx4 a[164:167], v44, s[20:23], s31 offen offset:1024 sc1
 v_mfma_f32_16x16x32_bf16 v[128:131], a[120:123], a[64:67], v[128:131]
 s_waitcnt lgkmcnt(4)
 v_mfma_f32_16x16x32_bf16 v[144:147], a[96:99], a[64:67], v[144:147]
 ds_read_b64_tr_b16 a[112:113], v9 offset:32768
 v_mfma_f32_16x16x32_bf16 v[144:147], a[100:103], a[68:71], v[144:147]
 ds_read_b64_tr_b16 a[114:115], v9 offset:40960
 v_mfma_f32_16x16x32_bf16 v[148:151], a[100:103], a[76:79], v[148:151]
 ds_read_b64_tr_b16 a[116:117], v9 offset:49152
 v_mfma_f32_16x16x32_bf16 v[148:151], a[96:99], a[72:75], v[148:151]
 ds_read_b64_tr_b16 a[118:119], v9 offset:57344
 v_mfma_f32_16x16x32_bf16 v[152:155], a[96:99], a[80:83], v[152:155]
 v_mfma_f32_16x16x32_bf16 v[152:155], a[100:103], a[84:87], v[152:155]
 v_mfma_f32_16x16x32_bf16 v[156:159], a[100:103], a[92:95], v[156:159]
 buffer_load_dwordx4 a[172:175], v45, s[20:23], s31 offen offset:1024 sc1
 v_mfma_f32_16x16x32_bf16 v[156:159], a[96:99], a[88:91], v[156:159]
 s_waitcnt lgkmcnt(4)
 v_mfma_f32_16x16x32_bf16 v[172:175], a[104:107], a[88:91], v[172:175]
 ds_read_b64_tr_b16 a[120:121], v10 offset:32768
 v_mfma_f32_16x16x32_bf16 v[172:175], a[108:111], a[92:95], v[172:175]
 ds_read_b64_tr_b16 a[122:123], v10 offset:40960
 v_mfma_f32_16x16x32_bf16 v[168:171], a[108:111], a[84:87], v[168:171]
 ds_read_b64_tr_b16 a[124:125], v10 offset:49152
 v_mfma_f32_16x16x32_bf16 v[168:171], a[104:107], a[80:83], v[168:171]
 ds_read_b64_tr_b16 a[126:127], v10 offset:57344
 v_mfma_f32_16x16x32_bf16 v[164:167], a[104:107], a[72:75], v[164:167]
 buffer_load_dwordx4 a[168:171], v45, s[20:23], s31 offen offset:0 sc1
 v_mfma_f32_16x16x32_bf16 v[164:167], a[108:111], a[76:79], v[164:167]
 v_mfma_f32_16x16x32_bf16 v[160:163], a[108:111], a[68:71], v[160:163]
 buffer_load_dwordx4 a[176:179], v46, s[20:23], s31 offen offset:0 sc1
 v_mfma_f32_16x16x32_bf16 v[160:163], a[104:107], a[64:67], v[160:163]
 s_waitcnt lgkmcnt(4)
 v_mfma_f32_16x16x32_bf16 v[176:179], a[112:115], a[64:67], v[176:179]
 ds_read_b64_tr_b16 a[96:97], v14 offset:36864
 v_mfma_f32_16x16x32_bf16 v[176:179], a[116:119], a[68:71], v[176:179]
 ds_read_b64_tr_b16 a[98:99], v14 offset:45056
 v_mfma_f32_16x16x32_bf16 v[180:183], a[116:119], a[76:79], v[180:183]
 ds_read_b64_tr_b16 a[100:101], v14 offset:53248
 v_mfma_f32_16x16x32_bf16 v[180:183], a[112:115], a[72:75], v[180:183]
 ds_read_b64_tr_b16 a[102:103], v14 offset:61440
 v_mfma_f32_16x16x32_bf16 v[184:187], a[112:115], a[80:83], v[184:187]
 buffer_load_dwordx4 a[180:183], v46, s[20:23], s31 offen offset:1024 sc1
 v_mfma_f32_16x16x32_bf16 v[184:187], a[116:119], a[84:87], v[184:187]
 v_mfma_f32_16x16x32_bf16 v[188:191], a[116:119], a[92:95], v[188:191]
 buffer_load_dwordx4 a[188:191], v47, s[20:23], s31 offen offset:1024 sc1
 v_mfma_f32_16x16x32_bf16 v[188:191], a[112:115], a[88:91], v[188:191]
 s_waitcnt lgkmcnt(4)
 v_mfma_f32_16x16x32_bf16 v[204:207], a[120:123], a[88:91], v[204:207]
 ds_read_b64_tr_b16 a[104:105], v15 offset:36864
 v_mfma_f32_16x16x32_bf16 v[204:207], a[124:127], a[92:95], v[204:207]
 ds_read_b64_tr_b16 a[106:107], v15 offset:45056
 v_mfma_f32_16x16x32_bf16 v[200:203], a[124:127], a[84:87], v[200:203]
 ds_read_b64_tr_b16 a[108:109], v15 offset:53248
 v_mfma_f32_16x16x32_bf16 v[200:203], a[120:123], a[80:83], v[200:203]
 ds_read_b64_tr_b16 a[110:111], v15 offset:61440
 v_mfma_f32_16x16x32_bf16 v[196:199], a[120:123], a[72:75], v[196:199]
 buffer_load_dwordx4 a[184:187], v47, s[20:23], s31 offen offset:0 sc1
 v_mfma_f32_16x16x32_bf16 v[196:199], a[124:127], a[76:79], v[196:199]
 v_mfma_f32_16x16x32_bf16 v[192:195], a[124:127], a[68:71], v[192:195]
 v_mfma_f32_16x16x32_bf16 v[192:195], a[120:123], a[64:67], v[192:195]
 buffer_store_dword v1, v2, s[20:23], s89 offen offset:128 sc1
 s_waitcnt vmcnt(17) lgkmcnt(4)
 v_mfma_f32_16x16x32_bf16 v[80:83], a[96:99], a[128:131], v[80:83]
 ds_read_b64_tr_b16 a[112:113], v4 offset:36864
 s_add_u32 s32, s44, 0
 v_mfma_f32_16x16x32_bf16 v[80:83], a[100:103], a[132:135], v[80:83]
 ds_read_b64_tr_b16 a[114:115], v4 offset:45056
 s_mov_b32 s24, s80
 v_mfma_f32_16x16x32_bf16 v[84:87], a[100:103], a[140:143], v[84:87]
 ds_read_b64_tr_b16 a[116:117], v4 offset:53248
 s_and_b32 s25, s81, 0xffff
 v_mfma_f32_16x16x32_bf16 v[84:87], a[96:99], a[136:139], v[84:87]
 ds_read_b64_tr_b16 a[118:119], v4 offset:61440
 s_add_u32 m0, s39, 4096
 s_waitcnt vmcnt(13)
 v_mfma_f32_16x16x32_bf16 v[88:91], a[96:99], a[144:147], v[88:91]
 buffer_load_dwordx4 v20, s[16:19], s32 offen lds
 s_mov_b32 s26, 0x400000
 v_mfma_f32_16x16x32_bf16 v[88:91], a[100:103], a[148:151], v[88:91]
 s_add_u32 m0, s39, 5120
 s_mov_b32 s12, s84
 s_and_b32 s13, s85, 0xffff
 v_mfma_f32_16x16x32_bf16 v[92:95], a[100:103], a[156:159], v[92:95]
 buffer_load_dwordx4 v21, s[16:19], s32 offen lds
 s_add_u32 s32, s32, 16384
 v_mfma_f32_16x16x32_bf16 v[92:95], a[96:99], a[152:155], v[92:95]
 s_mov_b32 s14, 0x0
 s_waitcnt lgkmcnt(4)
 v_accvgpr_read_b32 v64, a246
 v_mfma_f32_16x16x32_bf16 v[108:111], a[104:107], a[152:155], v[108:111]
 ds_read_b64_tr_b16 a[120:121], v5 offset:36864
 v_accvgpr_read_b32 v65, a247
 v_mfma_f32_16x16x32_bf16 v[108:111], a[108:111], a[156:159], v[108:111]
 ds_read_b64_tr_b16 a[122:123], v5 offset:45056
 v_accvgpr_read_b32 v66, a250
 v_mfma_f32_16x16x32_bf16 v[104:107], a[108:111], a[148:151], v[104:107]
 ds_read_b64_tr_b16 a[124:125], v5 offset:53248
 v_accvgpr_read_b32 v67, a251
 v_mfma_f32_16x16x32_bf16 v[104:107], a[104:107], a[144:147], v[104:107]
 ds_read_b64_tr_b16 a[126:127], v5 offset:61440
 s_add_u32 m0, s39, 6144
 v_mfma_f32_16x16x32_bf16 v[100:103], a[104:107], a[136:139], v[100:103]
 buffer_load_dwordx4 v20, s[16:19], s32 offen lds
 v_lshlrev_b32 v68, 16, v64
 v_mfma_f32_16x16x32_bf16 v[100:103], a[108:111], a[140:143], v[100:103]
 v_and_b32 v69, 0xffff0000, v64
 v_mfma_f32_16x16x32_bf16 v[96:99], a[108:111], a[132:135], v[96:99]
 v_lshlrev_b32 v70, 16, v65
 v_mfma_f32_16x16x32_bf16 v[96:99], a[104:107], a[128:131], v[96:99]
 s_waitcnt lgkmcnt(4)
 v_and_b32 v71, 0xffff0000, v65
 v_mfma_f32_16x16x32_bf16 v[112:115], a[112:115], a[128:131], v[112:115]
 ds_read_b64_tr_b16 a[96:97], v6 offset:36864
 v_lshlrev_b32 v72, 16, v66
 v_mfma_f32_16x16x32_bf16 v[112:115], a[116:119], a[132:135], v[112:115]
 ds_read_b64_tr_b16 a[98:99], v6 offset:45056
 v_and_b32 v73, 0xffff0000, v66
 v_mfma_f32_16x16x32_bf16 v[116:119], a[116:119], a[140:143], v[116:119]
 ds_read_b64_tr_b16 a[100:101], v6 offset:53248
 v_lshlrev_b32 v74, 16, v67
 v_mfma_f32_16x16x32_bf16 v[116:119], a[112:115], a[136:139], v[116:119]
 ds_read_b64_tr_b16 a[102:103], v6 offset:61440
 s_add_u32 m0, s39, 7168
 v_mfma_f32_16x16x32_bf16 v[120:123], a[112:115], a[144:147], v[120:123]
 buffer_load_dwordx4 v21, s[16:19], s32 offen lds
 s_cmp_le_u32 s63, 3
 s_addc_u32 s37, 3, 0
 v_mfma_f32_16x16x32_bf16 v[120:123], a[116:119], a[148:151], v[120:123]
 s_lshl_b32 s31, s37, 12
 v_and_b32 v75, 0xffff0000, v67
 v_mfma_f32_16x16x32_bf16 v[124:127], a[116:119], a[156:159], v[124:127]
 buffer_load_dwordx4 a[0:3], v44, s[20:23], s31 offen offset:0 sc1
 v_and_b32 v76, 1, v19
 v_mfma_f32_16x16x32_bf16 v[124:127], a[112:115], a[152:155], v[124:127]
 s_waitcnt lgkmcnt(4)
 v_lshrrev_b32 v38, 1, v19
 v_mfma_f32_16x16x32_bf16 v[140:143], a[120:123], a[152:155], v[140:143]
 ds_read_b64_tr_b16 a[104:105], v7 offset:36864
 v_lshlrev_b32 v77, 5, v76
 v_mfma_f32_16x16x32_bf16 v[140:143], a[124:127], a[156:159], v[140:143]
 ds_read_b64_tr_b16 a[106:107], v7 offset:45056
 v_lshl_add_u32 v77, v38, 4, v77
 v_mfma_f32_16x16x32_bf16 v[136:139], a[124:127], a[148:151], v[136:139]
 ds_read_b64_tr_b16 a[108:109], v7 offset:53248
 v_and_b32 v38, 15, v0
 v_mfma_f32_16x16x32_bf16 v[136:139], a[120:123], a[144:147], v[136:139]
 ds_read_b64_tr_b16 a[110:111], v7 offset:61440
 v_lshl_add_u32 v76, v38, 11, v77
 v_mfma_f32_16x16x32_bf16 v[132:135], a[120:123], a[136:139], v[132:135]
 buffer_load_dwordx4 a[4:7], v44, s[20:23], s31 offen offset:1024 sc1
 s_lshl_b32 s38, s63, 8
 v_mfma_f32_16x16x32_bf16 v[132:135], a[124:127], a[140:143], v[132:135]
L_pg10:
 s_cbranch_execz L_main
 s_lshl_b32 s60, s62, 6
 s_add_u32 s38, s38, s60
 s_lshl_b32 s35, s54, 11
 v_mfma_f32_16x16x32_bf16 v[128:131], a[124:127], a[132:135], v[128:131]
 s_add_u32 s35, s35, s38
 s_mul_i32 s52, s88, 196608
 s_add_u32 s52, s52, s47
 v_mfma_f32_16x16x32_bf16 v[128:131], a[120:123], a[128:131], v[128:131]
 s_add_u32 s52, s52, 33554432
 s_waitcnt lgkmcnt(4)
 v_min_u32 v78, 2, v0
 v_mfma_f32_16x16x32_bf16 v[144:147], a[96:99], a[128:131], v[144:147]
 ds_read_b64_tr_b16 a[112:113], v9 offset:36864
 v_lshlrev_b32 v78, 7, v78
 v_mfma_f32_16x16x32_bf16 v[144:147], a[100:103], a[132:135], v[144:147]
 ds_read_b64_tr_b16 a[114:115], v9 offset:45056
 s_mov_b32 s61, 7
 v_mfma_f32_16x16x32_bf16 v[148:151], a[100:103], a[140:143], v[148:151]
 ds_read_b64_tr_b16 a[116:117], v9 offset:53248
 s_add_u32 s60, s62, 1
 v_mfma_f32_16x16x32_bf16 v[148:151], a[96:99], a[136:139], v[148:151]
 ds_read_b64_tr_b16 a[118:119], v9 offset:61440
 s_and_b32 s60, s60, 3
 v_mfma_f32_16x16x32_bf16 v[152:155], a[96:99], a[144:147], v[152:155]
 buffer_load_dwordx4 a[12:15], v45, s[20:23], s31 offen offset:1024 sc1
 s_mul_i32 s4, s60, 49152
 v_mfma_f32_16x16x32_bf16 v[152:155], a[100:103], a[148:151], v[152:155]
 s_lshl_b32 s60, s60, 11
 s_add_u32 s4, s4, s52
 s_add_u32 s41, s60, s90
 v_mfma_f32_16x16x32_bf16 v[156:159], a[100:103], a[156:159], v[156:159]
 buffer_load_dwordx4 a[8:11], v45, s[20:23], s31 offen offset:0 sc1
 s_add_u32 s4, s4, 0
 v_mfma_f32_16x16x32_bf16 v[156:159], a[96:99], a[152:155], v[156:159]
 s_add_u32 s60, s62, 2
 s_and_b32 s60, s60, 3
 s_waitcnt lgkmcnt(4)
 v_mfma_f32_16x16x32_bf16 v[172:175], a[104:107], a[152:155], v[172:175]
 ds_read_b64_tr_b16 a[120:121], v10 offset:36864
 s_mul_i32 s5, s60, 49152
 v_mfma_f32_16x16x32_bf16 v[172:175], a[108:111], a[156:159], v[172:175]
 ds_read_b64_tr_b16 a[122:123], v10 offset:45056
 s_lshl_b32 s60, s60, 11
 v_mfma_f32_16x16x32_bf16 v[168:171], a[108:111], a[148:151], v[168:171]
 ds_read_b64_tr_b16 a[124:125], v10 offset:53248
 s_add_u32 s5, s5, s52
 v_mfma_f32_16x16x32_bf16 v[168:171], a[104:107], a[144:147], v[168:171]
 ds_read_b64_tr_b16 a[126:127], v10 offset:61440
 s_add_u32 s42, s60, s90
 v_mfma_f32_16x16x32_bf16 v[164:167], a[104:107], a[136:139], v[164:167]
 buffer_load_dwordx4 a[16:19], v46, s[20:23], s31 offen offset:0 sc1
 s_add_u32 s5, s5, 16384
 v_mfma_f32_16x16x32_bf16 v[164:167], a[108:111], a[140:143], v[164:167]
 s_add_u32 s60, s62, 3
 s_and_b32 s60, s60, 3
 s_mul_i32 s6, s60, 49152
 v_mfma_f32_16x16x32_bf16 v[160:163], a[108:111], a[132:135], v[160:163]
 s_lshl_b32 s60, s60, 11
 s_add_u32 s6, s6, s52
 s_add_u32 s34, s60, s90
 v_mfma_f32_16x16x32_bf16 v[160:163], a[104:107], a[128:131], v[160:163]
 s_add_u32 s6, s6, 32768
 s_mul_i32 s60, s62, 49152
 s_waitcnt lgkmcnt(4)
 v_mfma_f32_16x16x32_bf16 v[176:179], a[112:115], a[128:131], v[176:179]
 ds_read_b64_tr_b16 a[96:97], v48 offset:0
 s_add_u32 s52, s52, s60
 v_mfma_f32_16x16x32_bf16 v[176:179], a[116:119], a[132:135], v[176:179]
 ds_read_b64_tr_b16 a[98:99], v48 offset:4096
 s_add_u32 s53, s52, 16384
 v_mfma_f32_16x16x32_bf16 v[180:183], a[116:119], a[140:143], v[180:183]
 ds_read_b64_tr_b16 a[100:101], v48 offset:8192
 s_add_u32 s7, s52, 32768
 v_mfma_f32_16x16x32_bf16 v[180:183], a[112:115], a[136:139], v[180:183]
 ds_read_b64_tr_b16 a[102:103], v48 offset:12288
 v_mfma_f32_16x16x32_bf16 v[184:187], a[112:115], a[144:147], v[184:187]
 buffer_load_dwordx4 a[20:23], v46, s[20:23], s31 offen offset:1024 sc1
 v_mfma_f32_16x16x32_bf16 v[184:187], a[116:119], a[148:151], v[184:187]
 v_mfma_f32_16x16x32_bf16 v[188:191], a[116:119], a[156:159], v[188:191]
 buffer_load_dwordx4 a[28:31], v47, s[20:23], s31 offen offset:1024 sc1
 v_mfma_f32_16x16x32_bf16 v[188:191], a[112:115], a[152:155], v[188:191]
 s_waitcnt lgkmcnt(4)
 v_mfma_f32_16x16x32_bf16 v[204:207], a[120:123], a[152:155], v[204:207]
 ds_read_b64_tr_b16 a[104:105], v49 offset:0
 v_mfma_f32_16x16x32_bf16 v[204:207], a[124:127], a[156:159], v[204:207]
 ds_read_b64_tr_b16 a[106:107], v49 offset:4096
 v_mfma_f32_16x16x32_bf16 v[200:203], a[124:127], a[148:151], v[200:203]
 ds_read_b64_tr_b16 a[108:109], v49 offset:8192
 v_mfma_f32_16x16x32_bf16 v[200:203], a[120:123], a[144:147], v[200:203]
 ds_read_b64_tr_b16 a[110:111], v49 offset:12288
 v_mfma_f32_16x16x32_bf16 v[196:199], a[120:123], a[136:139], v[196:199]
 buffer_load_dwordx4 a[24:27], v47, s[20:23], s31 offen offset:0 sc1
 v_mfma_f32_16x16x32_bf16 v[196:199], a[124:127], a[140:143], v[196:199]
 v_mfma_f32_16x16x32_bf16 v[192:195], a[124:127], a[132:135], v[192:195]
 v_mfma_f32_16x16x32_bf16 v[192:195], a[120:123], a[128:131], v[192:195]
 s_waitcnt vmcnt(17) lgkmcnt(4)
 v_mfma_f32_16x16x32_bf16 v[80:83], a[96:99], a[160:163], v[80:83]
 ds_read_b64_tr_b16 a[112:113], v50 offset:0
 v_mfma_f32_16x16x32_bf16 v[80:83], a[100:103], a[164:167], v[80:83]
 ds_read_b64_tr_b16 a[114:115], v50 offset:4096
 v_mfma_f32_16x16x32_bf16 v[84:87], a[100:103], a[172:175], v[84:87]
 ds_read_b64_tr_b16 a[116:117], v50 offset:8192
 v_mfma_f32_16x16x32_bf16 v[84:87], a[96:99], a[168:171], v[84:87]
 ds_read_b64_tr_b16 a[118:119], v50 offset:12288
 s_waitcnt vmcnt(13)
 v_mfma_f32_16x16x32_bf16 v[88:91], a[96:99], a[176:179], v[88:91]
 v_mfma_f32_16x16x32_bf16 v[88:91], a[100:103], a[180:183], v[88:91]
 s_barrier
 v_mfma_f32_16x16x32_bf16 v[92:95], a[100:103], a[188:191], v[92:95]
 v_mfma_f32_16x16x32_bf16 v[92:95], a[96:99], a[184:187], v[92:95]
 s_waitcnt lgkmcnt(4)
 v_mfma_f32_16x16x32_bf16 v[108:111], a[104:107], a[184:187], v[108:111]
 ds_read_b64_tr_b16 a[120:121], v51 offset:0
 s_add_u32 s32, s44, 917504
 v_mfma_f32_16x16x32_bf16 v[108:111], a[108:111], a[188:191], v[108:111]
 ds_read_b64_tr_b16 a[122:123], v51 offset:4096
 v_mfma_f32_16x16x32_bf16 v[104:107], a[108:111], a[180:183], v[104:107]
 ds_read_b64_tr_b16 a[124:125], v51 offset:8192
 v_mfma_f32_16x16x32_bf16 v[104:107], a[104:107], a[176:179], v[104:107]
 ds_read_b64_tr_b16 a[126:127], v51 offset:12288
 s_add_u32 m0, s39, 32768
 v_mfma_f32_16x16x32_bf16 v[100:103], a[104:107], a[168:171], v[100:103]
 buffer_load_dwordx4 v20, s[16:19], s32 offen lds
 v_mfma_f32_16x16x32_bf16 v[100:103], a[108:111], a[172:175], v[100:103]
 s_add_u32 m0, s39, 33792
 v_mfma_f32_16x16x32_bf16 v[96:99], a[108:111], a[164:167], v[96:99]
 buffer_load_dwordx4 v21, s[16:19], s32 offen lds
 s_add_u32 s32, s32, 16384
 v_mfma_f32_16x16x32_bf16 v[96:99], a[104:107], a[160:163], v[96:99]
 s_waitcnt lgkmcnt(4)
 v_mfma_f32_16x16x32_bf16 v[112:115], a[112:115], a[160:163], v[112:115]
 ds_read_b64_tr_b16 a[96:97], v52 offset:0
 v_mfma_f32_16x16x32_bf16 v[112:115], a[116:119], a[164:167], v[112:115]
 ds_read_b64_tr_b16 a[98:99], v52 offset:4096
 v_mfma_f32_16x16x32_bf16 v[116:119], a[116:119], a[172:175], v[116:119]
 ds_read_b64_tr_b16 a[100:101], v52 offset:8192
 v_mfma_f32_16x16x32_bf16 v[116:119], a[112:115], a[168:171], v[116:119]
 ds_read_b64_tr_b16 a[102:103], v52 offset:12288
 s_add_u32 m0, s39, 34816
 v_mfma_f32_16x16x32_bf16 v[120:123], a[112:115], a[176:179], v[120:123]
 buffer_load_dwordx4 v20, s[16:19], s32 offen lds
 v_mfma_f32_16x16x32_bf16 v[120:123], a[116:119], a[180:183], v[120:123]
 s_add_u32 m0, s39, 35840
 v_mfma_f32_16x16x32_bf16 v[124:127], a[116:119], a[188:191], v[124:127]
 buffer_load_dwordx4 v21, s[16:19], s32 offen lds
 s_cmp_le_u32 s63, 4
 s_addc_u32 s37, 4, 0
 v_mfma_f32_16x16x32_bf16 v[124:127], a[112:115], a[184:187], v[124:127]
 s_waitcnt lgkmcnt(4)
 v_mfma_f32_16x16x32_bf16 v[140:143], a[120:123], a[184:187], v[140:143]
 ds_read_b64_tr_b16 a[104:105], v53 offset:0
 v_mfma_f32_16x16x32_bf16 v[140:143], a[124:127], a[188:191], v[140:143]
 ds_read_b64_tr_b16 a[106:107], v53 offset:4096
 v_mfma_f32_16x16x32_bf16 v[136:139], a[124:127], a[180:183], v[136:139]
 ds_read_b64_tr_b16 a[108:109], v53 offset:8192
 v_mfma_f32_16x16x32_bf16 v[136:139], a[120:123], a[176:179], v[136:139]
 ds_read_b64_tr_b16 a[110:111], v53 offset:12288
 s_lshl_b32 s31, s37, 12
 v_mfma_f32_16x16x32_bf16 v[132:135], a[120:123], a[168:171], v[132:135]
 buffer_load_dwordx4 a[32:35], v44, s[20:23], s31 offen offset:0 sc1
 v_mfma_f32_16x16x32_bf16 v[132:135], a[124:127], a[172:175], v[132:135]
 v_mfma_f32_16x16x32_bf16 v[128:131], a[124:127], a[164:167], v[128:131]
 buffer_load_dwordx4 a[36:39], v44, s[20:23], s31 offen offset:1024 sc1
 v_mfma_f32_16x16x32_bf16 v[128:131], a[120:123], a[160:163], v[128:131]
 s_waitcnt lgkmcnt(4)
 v_mfma_f32_16x16x32_bf16 v[144:147], a[96:99], a[160:163], v[144:147]
 ds_read_b64_tr_b16 a[112:113], v54 offset:0
 v_mfma_f32_16x16x32_bf16 v[144:147], a[100:103], a[164:167], v[144:147]
 ds_read_b64_tr_b16 a[114:115], v54 offset:4096
 v_mfma_f32_16x16x32_bf16 v[148:151], a[100:103], a[172:175], v[148:151]
 ds_read_b64_tr_b16 a[116:117], v54 offset:8192
 v_mfma_f32_16x16x32_bf16 v[148:151], a[96:99], a[168:171], v[148:151]
 ds_read_b64_tr_b16 a[118:119], v54 offset:12288
 v_mfma_f32_16x16x32_bf16 v[152:155], a[96:99], a[176:179], v[152:155]
 buffer_load_dwordx4 a[44:47], v45, s[20:23], s31 offen offset:1024 sc1
 v_mfma_f32_16x16x32_bf16 v[152:155], a[100:103], a[180:183], v[152:155]
 v_mfma_f32_16x16x32_bf16 v[156:159], a[100:103], a[188:191], v[156:159]
 buffer_load_dwordx4 a[40:43], v45, s[20:23], s31 offen offset:0 sc1
 v_mfma_f32_16x16x32_bf16 v[156:159], a[96:99], a[184:187], v[156:159]
 s_waitcnt lgkmcnt(4)
 v_mfma_f32_16x16x32_bf16 v[172:175], a[104:107], a[184:187], v[172:175]
 ds_read_b64_tr_b16 a[120:121], v55 offset:0
 v_mfma_f32_16x16x32_bf16 v[172:175], a[108:111], a[188:191], v[172:175]
 ds_read_b64_tr_b16 a[122:123], v55 offset:4096
 v_mfma_f32_16x16x32_bf16 v[168:171], a[108:111], a[180:183], v[168:171]
 ds_read_b64_tr_b16 a[124:125], v55 offset:8192
 v_mfma_f32_16x16x32_bf16 v[168:171], a[104:107], a[176:179], v[168:171]
 ds_read_b64_tr_b16 a[126:127], v55 offset:12288
 v_mfma_f32_16x16x32_bf16 v[164:167], a[104:107], a[168:171], v[164:167]
 buffer_load_dwordx4 a[48:51], v46, s[20:23], s31 offen offset:0 sc1
 v_mfma_f32_16x16x32_bf16 v[164:167], a[108:111], a[172:175], v[164:167]
 v_mfma_f32_16x16x32_bf16 v[160:163], a[108:111], a[164:167], v[160:163]
 buffer_load_dwordx4 a[52:55], v46, s[20:23], s31 offen offset:1024 sc1
 v_mfma_f32_16x16x32_bf16 v[160:163], a[104:107], a[160:163], v[160:163]
 s_waitcnt lgkmcnt(4)
 v_mfma_f32_16x16x32_bf16 v[176:179], a[112:115], a[160:163], v[176:179]
 ds_read_b64_tr_b16 a[96:97], v48 offset:16384
 v_mfma_f32_16x16x32_bf16 v[176:179], a[116:119], a[164:167], v[176:179]
 ds_read_b64_tr_b16 a[98:99], v48 offset:20480
 v_mfma_f32_16x16x32_bf16 v[180:183], a[116:119], a[172:175], v[180:183]
 ds_read_b64_tr_b16 a[100:101], v48 offset:24576
 v_mfma_f32_16x16x32_bf16 v[180:183], a[112:115], a[168:171], v[180:183]
 ds_read_b64_tr_b16 a[102:103], v48 offset:28672
 v_mfma_f32_16x16x32_bf16 v[184:187], a[112:115], a[176:179], v[184:187]
 buffer_load_dwordx4 a[60:63], v47, s[20:23], s31 offen offset:1024 sc1
 v_mfma_f32_16x16x32_bf16 v[184:187], a[116:119], a[180:183], v[184:187]
 v_mfma_f32_16x16x32_bf16 v[188:191], a[116:119], a[188:191], v[188:191]
 buffer_load_dwordx4 a[56:59], v47, s[20:23], s31 offen offset:0 sc1
 s_cmp_le_u32 s63, 5
 s_addc_u32 s37, 5, 0
 v_mfma_f32_16x16x32_bf16 v[188:191], a[112:115], a[184:187], v[188:191]
 s_waitcnt lgkmcnt(4)
 v_mfma_f32_16x16x32_bf16 v[204:207], a[120:123], a[184:187], v[204:207]
 ds_read_b64_tr_b16 a[104:105], v49 offset:16384
 v_mfma_f32_16x16x32_bf16 v[204:207], a[124:127], a[188:191], v[204:207]
 ds_read_b64_tr_b16 a[106:107], v49 offset:20480
 v_mfma_f32_16x16x32_bf16 v[200:203], a[124:127], a[180:183], v[200:203]
 ds_read_b64_tr_b16 a[108:109], v49 offset:24576
 v_mfma_f32_16x16x32_bf16 v[200:203], a[120:123], a[176:179], v[200:203]
 ds_read_b64_tr_b16 a[110:111], v49 offset:28672
 s_lshl_b32 s31, s37, 12
 v_mfma_f32_16x16x32_bf16 v[196:199], a[120:123], a[168:171], v[196:199]
 buffer_load_dwordx4 a[64:67], v44, s[20:23], s31 offen offset:0 sc1
 v_mfma_f32_16x16x32_bf16 v[196:199], a[124:127], a[172:175], v[196:199]
 v_mfma_f32_16x16x32_bf16 v[192:195], a[124:127], a[164:167], v[192:195]
 buffer_load_dwordx4 a[68:71], v44, s[20:23], s31 offen offset:1024 sc1
 v_mfma_f32_16x16x32_bf16 v[192:195], a[120:123], a[160:163], v[192:195]
 s_waitcnt vmcnt(18) lgkmcnt(4)
 v_mfma_f32_16x16x32_bf16 v[80:83], a[96:99], a[0:3], v[80:83]
 ds_read_b64_tr_b16 a[112:113], v50 offset:16384
 s_cmp_le_u32 s63, 0
 s_addc_u32 s33, 0, 0
 v_mfma_f32_16x16x32_bf16 v[80:83], a[100:103], a[4:7], v[80:83]
 ds_read_b64_tr_b16 a[114:115], v50 offset:20480
 s_mul_i32 s33, s33, 229376
 v_mfma_f32_16x16x32_bf16 v[84:87], a[100:103], a[12:15], v[84:87]
 ds_read_b64_tr_b16 a[116:117], v50 offset:24576
 s_add_u32 s32, s33, s59
 v_mfma_f32_16x16x32_bf16 v[84:87], a[96:99], a[8:11], v[84:87]
 ds_read_b64_tr_b16 a[118:119], v50 offset:28672
 s_add_u32 m0, s39, 36864
 s_waitcnt vmcnt(14)
 v_mfma_f32_16x16x32_bf16 v[88:91], a[96:99], a[16:19], v[88:91]
 buffer_load_dwordx4 v20, s[16:19], s32 offen lds
 v_mfma_f32_16x16x32_bf16 v[88:91], a[100:103], a[20:23], v[88:91]
 s_add_u32 m0, s39, 37888
 v_mfma_f32_16x16x32_bf16 v[92:95], a[100:103], a[28:31], v[92:95]
 buffer_load_dwordx4 v21, s[16:19], s32 offen lds
 s_add_u32 s32, s32, 16384
 v_mfma_f32_16x16x32_bf16 v[92:95], a[96:99], a[24:27], v[92:95]
 s_waitcnt lgkmcnt(4)
 v_mfma_f32_16x16x32_bf16 v[108:111], a[104:107], a[24:27], v[108:111]
 ds_read_b64_tr_b16 a[120:121], v51 offset:16384
 v_mfma_f32_16x16x32_bf16 v[108:111], a[108:111], a[28:31], v[108:111]
 ds_read_b64_tr_b16 a[122:123], v51 offset:20480
 v_mfma_f32_16x16x32_bf16 v[104:107], a[108:111], a[20:23], v[104:107]
 ds_read_b64_tr_b16 a[124:125], v51 offset:24576
 v_mfma_f32_16x16x32_bf16 v[104:107], a[104:107], a[16:19], v[104:107]
 ds_read_b64_tr_b16 a[126:127], v51 offset:28672
 s_add_u32 m0, s39, 38912
 v_mfma_f32_16x16x32_bf16 v[100:103], a[104:107], a[8:11], v[100:103]
 buffer_load_dwordx4 v20, s[16:19], s32 offen lds
 v_mfma_f32_16x16x32_bf16 v[100:103], a[108:111], a[12:15], v[100:103]
 s_add_u32 m0, s39, 39936
 v_mfma_f32_16x16x32_bf16 v[96:99], a[108:111], a[4:7], v[96:99]
 buffer_load_dwordx4 v21, s[16:19], s32 offen lds
 v_mfma_f32_16x16x32_bf16 v[96:99], a[104:107], a[0:3], v[96:99]
 s_waitcnt lgkmcnt(4)
 v_mfma_f32_16x16x32_bf16 v[112:115], a[112:115], a[0:3], v[112:115]
 ds_read_b64_tr_b16 a[96:97], v52 offset:16384
 v_mfma_f32_16x16x32_bf16 v[112:115], a[116:119], a[4:7], v[112:115]
 ds_read_b64_tr_b16 a[98:99], v52 offset:20480
 v_mfma_f32_16x16x32_bf16 v[116:119], a[116:119], a[12:15], v[116:119]
 ds_read_b64_tr_b16 a[100:101], v52 offset:24576
 v_mfma_f32_16x16x32_bf16 v[116:119], a[112:115], a[8:11], v[116:119]
 ds_read_b64_tr_b16 a[102:103], v52 offset:28672
 v_mfma_f32_16x16x32_bf16 v[120:123], a[112:115], a[16:19], v[120:123]
 buffer_load_dwordx4 a[76:79], v45, s[20:23], s31 offen offset:1024 sc1
 v_mfma_f32_16x16x32_bf16 v[120:123], a[116:119], a[20:23], v[120:123]
 v_mfma_f32_16x16x32_bf16 v[124:127], a[116:119], a[28:31], v[124:127]
 buffer_load_dwordx4 a[72:75], v45, s[20:23], s31 offen offset:0 sc1
 v_mfma_f32_16x16x32_bf16 v[124:127], a[112:115], a[24:27], v[124:127]
 s_waitcnt lgkmcnt(4)
 v_mfma_f32_16x16x32_bf16 v[140:143], a[120:123], a[24:27], v[140:143]
 ds_read_b64_tr_b16 a[104:105], v53 offset:16384
 v_mfma_f32_16x16x32_bf16 v[140:143], a[124:127], a[28:31], v[140:143]
 ds_read_b64_tr_b16 a[106:107], v53 offset:20480
 v_mfma_f32_16x16x32_bf16 v[136:139], a[124:127], a[20:23], v[136:139]
 ds_read_b64_tr_b16 a[108:109], v53 offset:24576
 v_mfma_f32_16x16x32_bf16 v[136:139], a[120:123], a[16:19], v[136:139]
 ds_read_b64_tr_b16 a[110:111], v53 offset:28672
 v_mfma_f32_16x16x32_bf16 v[132:135], a[120:123], a[8:11], v[132:135]
 buffer_load_dwordx4 a[80:83], v46, s[20:23], s31 offen offset:0 sc1
 v_mfma_f32_16x16x32_bf16 v[132:135], a[124:127], a[12:15], v[132:135]
 v_mfma_f32_16x16x32_bf16 v[128:131], a[124:127], a[4:7], v[128:131]
 v_mfma_f32_16x16x32_bf16 v[128:131], a[120:123], a[0:3], v[128:131]
 s_waitcnt lgkmcnt(4)
 v_mfma_f32_16x16x32_bf16 v[144:147], a[96:99], a[0:3], v[144:147]
 ds_read_b64_tr_b16 a[112:113], v54 offset:16384
 v_mfma_f32_16x16x32_bf16 v[144:147], a[100:103], a[4:7], v[144:147]
 ds_read_b64_tr_b16 a[114:115], v54 offset:20480
 v_mfma_f32_16x16x32_bf16 v[148:151], a[100:103], a[12:15], v[148:151]
 ds_read_b64_tr_b16 a[116:117], v54 offset:24576
 v_mfma_f32_16x16x32_bf16 v[148:151], a[96:99], a[8:11], v[148:151]
 ds_read_b64_tr_b16 a[118:119], v54 offset:28672
 v_mfma_f32_16x16x32_bf16 v[152:155], a[96:99], a[16:19], v[152:155]
 buffer_load_dwordx4 a[84:87], v46, s[20:23], s31 offen offset:1024 sc1
 v_mfma_f32_16x16x32_bf16 v[152:155], a[100:103], a[20:23], v[152:155]
 v_mfma_f32_16x16x32_bf16 v[156:159], a[100:103], a[28:31], v[156:159]
 buffer_load_dwordx4 a[92:95], v47, s[20:23], s31 offen offset:1024 sc1
 v_mfma_f32_16x16x32_bf16 v[156:159], a[96:99], a[24:27], v[156:159]
 s_waitcnt lgkmcnt(4)
 v_mfma_f32_16x16x32_bf16 v[172:175], a[104:107], a[24:27], v[172:175]
 ds_read_b64_tr_b16 a[120:121], v55 offset:16384
 v_mfma_f32_16x16x32_bf16 v[172:175], a[108:111], a[28:31], v[172:175]
 ds_read_b64_tr_b16 a[122:123], v55 offset:20480
 v_mfma_f32_16x16x32_bf16 v[168:171], a[108:111], a[20:23], v[168:171]
 ds_read_b64_tr_b16 a[124:125], v55 offset:24576
 v_mfma_f32_16x16x32_bf16 v[168:171], a[104:107], a[16:19], v[168:171]
 ds_read_b64_tr_b16 a[126:127], v55 offset:28672
 v_mfma_f32_16x16x32_bf16 v[164:167], a[104:107], a[8:11], v[164:167]
 buffer_load_dwordx4 a[88:91], v47, s[20:23], s31 offen offset:0 sc1
 s_cmp_le_u32 s63, 6
 s_addc_u32 s37, 6, 0
 v_mfma_f32_16x16x32_bf16 v[164:167], a[108:111], a[12:15], v[164:167]
 s_lshl_b32 s31, s37, 12
 v_mfma_f32_16x16x32_bf16 v[160:163], a[108:111], a[4:7], v[160:163]
 buffer_load_dwordx4 a[128:131], v44, s[20:23], s31 offen offset:0 sc1
 v_mfma_f32_16x16x32_bf16 v[160:163], a[104:107], a[0:3], v[160:163]
 s_waitcnt lgkmcnt(4)
 v_mfma_f32_16x16x32_bf16 v[176:179], a[112:115], a[0:3], v[176:179]
 ds_read_b64_tr_b16 a[96:97], v48 offset:32768
 v_mfma_f32_16x16x32_bf16 v[176:179], a[116:119], a[4:7], v[176:179]
 ds_read_b64_tr_b16 a[98:99], v48 offset:36864
 v_mfma_f32_16x16x32_bf16 v[180:183], a[116:119], a[12:15], v[180:183]
 ds_read_b64_tr_b16 a[100:101], v48 offset:40960
 v_mfma_f32_16x16x32_bf16 v[180:183], a[112:115], a[8:11], v[180:183]
 ds_read_b64_tr_b16 a[102:103], v48 offset:45056
 v_mfma_f32_16x16x32_bf16 v[184:187], a[112:115], a[16:19], v[184:187]
 buffer_load_dwordx4 a[132:135], v44, s[20:23], s31 offen offset:1024 sc1
 v_mfma_f32_16x16x32_bf16 v[184:187], a[116:119], a[20:23], v[184:187]
 v_mfma_f32_16x16x32_bf16 v[188:191], a[116:119], a[28:31], v[188:191]
 buffer_load_dwordx4 a[140:143], v45, s[20:23], s31 offen offset:1024 sc1
 v_mfma_f32_16x16x32_bf16 v[188:191], a[112:115], a[24:27], v[188:191]
 s_waitcnt lgkmcnt(4)
 v_mfma_f32_16x16x32_bf16 v[204:207], a[120:123], a[24:27], v[204:207]
 ds_read_b64_tr_b16 a[104:105], v49 offset:32768
 v_mfma_f32_16x16x32_bf16 v[204:207], a[124:127], a[28:31], v[204:207]
 ds_read_b64_tr_b16 a[106:107], v49 offset:36864
 v_mfma_f32_16x16x32_bf16 v[200:203], a[124:127], a[20:23], v[200:203]
 ds_read_b64_tr_b16 a[108:109], v49 offset:40960
 v_mfma_f32_16x16x32_bf16 v[200:203], a[120:123], a[16:19], v[200:203]
 ds_read_b64_tr_b16 a[110:111], v49 offset:45056
 v_mfma_f32_16x16x32_bf16 v[196:199], a[120:123], a[8:11], v[196:199]
 buffer_load_dwordx4 a[136:139], v45, s[20:23], s31 offen offset:0 sc1
 v_mfma_f32_16x16x32_bf16 v[196:199], a[124:127], a[12:15], v[196:199]
 v_mfma_f32_16x16x32_bf16 v[192:195], a[124:127], a[4:7], v[192:195]
 v_mfma_f32_16x16x32_bf16 v[192:195], a[120:123], a[0:3], v[192:195]
 s_waitcnt vmcnt(20) lgkmcnt(4)
 v_mfma_f32_16x16x32_bf16 v[80:83], a[96:99], a[32:35], v[80:83]
 ds_read_b64_tr_b16 a[112:113], v50 offset:32768
 v_mfma_f32_16x16x32_bf16 v[80:83], a[100:103], a[36:39], v[80:83]
 ds_read_b64_tr_b16 a[114:115], v50 offset:36864
 v_mfma_f32_16x16x32_bf16 v[84:87], a[100:103], a[44:47], v[84:87]
 ds_read_b64_tr_b16 a[116:117], v50 offset:40960
 v_mfma_f32_16x16x32_bf16 v[84:87], a[96:99], a[40:43], v[84:87]
 ds_read_b64_tr_b16 a[118:119], v50 offset:45056
 s_waitcnt vmcnt(16)
 v_mfma_f32_16x16x32_bf16 v[88:91], a[96:99], a[48:51], v[88:91]
 v_mfma_f32_16x16x32_bf16 v[88:91], a[100:103], a[52:55], v[88:91]
 buffer_load_dword v17, v18, s[20:23], s86 offen offset:128 sc1
 s_barrier
 v_mfma_f32_16x16x32_bf16 v[92:95], a[100:103], a[60:63], v[92:95]
 v_mfma_f32_16x16x32_bf16 v[92:95], a[96:99], a[56:59], v[92:95]
 s_waitcnt lgkmcnt(4)
 v_mfma_f32_16x16x32_bf16 v[108:111], a[104:107], a[56:59], v[108:111]
 ds_read_b64_tr_b16 a[120:121], v51 offset:32768
 s_cmp_le_u32 s63, 1
 s_addc_u32 s33, 1, 0
 v_mfma_f32_16x16x32_bf16 v[108:111], a[108:111], a[60:63], v[108:111]
 ds_read_b64_tr_b16 a[122:123], v51 offset:36864
 s_mul_i32 s33, s33, 229376
 v_mfma_f32_16x16x32_bf16 v[104:107], a[108:111], a[52:55], v[104:107]
 ds_read_b64_tr_b16 a[124:125], v51 offset:40960
 s_add_u32 s32, s33, s59
 v_mfma_f32_16x16x32_bf16 v[104:107], a[104:107], a[48:51], v[104:107]
 ds_read_b64_tr_b16 a[126:127], v51 offset:45056
 s_add_u32 m0, s47, 69632
 v_mfma_f32_16x16x32_bf16 v[100:103], a[104:107], a[40:43], v[100:103]
 buffer_load_dwordx4 v20, s[16:19], s32 offen lds
 v_mfma_f32_16x16x32_bf16 v[100:103], a[108:111], a[44:47], v[100:103]
 s_add_u32 m0, s47, 70656
 v_mfma_f32_16x16x32_bf16 v[96:99], a[108:111], a[36:39], v[96:99]
 buffer_load_dwordx4 v21, s[16:19], s32 offen lds
 s_add_u32 s32, s32, 16384
 v_mfma_f32_16x16x32_bf16 v[96:99], a[104:107], a[32:35], v[96:99]
 s_waitcnt lgkmcnt(4)
 v_mfma_f32_16x16x32_bf16 v[112:115], a[112:115], a[32:35], v[112:115]
 ds_read_b64_tr_b16 a[96:97], v52 offset:32768
 v_mfma_f32_16x16x32_bf16 v[112:115], a[116:119], a[36:39], v[112:115]
 ds_read_b64_tr_b16 a[98:99], v52 offset:36864
 v_mfma_f32_16x16x32_bf16 v[116:119], a[116:119], a[44:47], v[116:119]
 ds_read_b64_tr_b16 a[100:101], v52 offset:40960
 v_mfma_f32_16x16x32_bf16 v[116:119], a[112:115], a[40:43], v[116:119]
 ds_read_b64_tr_b16 a[102:103], v52 offset:45056
 s_add_u32 m0, s47, 71680
 v_mfma_f32_16x16x32_bf16 v[120:123], a[112:115], a[48:51], v[120:123]
 buffer_load_dwordx4 v20, s[16:19], s32 offen lds
 v_mfma_f32_16x16x32_bf16 v[120:123], a[116:119], a[52:55], v[120:123]
 s_add_u32 m0, s47, 72704
 v_mfma_f32_16x16x32_bf16 v[124:127], a[116:119], a[60:63], v[124:127]
 buffer_load_dwordx4 v21, s[16:19], s32 offen lds
 v_mfma_f32_16x16x32_bf16 v[124:127], a[112:115], a[56:59], v[124:127]
 s_waitcnt lgkmcnt(4)
 v_mfma_f32_16x16x32_bf16 v[140:143], a[120:123], a[56:59], v[140:143]
 ds_read_b64_tr_b16 a[104:105], v53 offset:32768
 v_mfma_f32_16x16x32_bf16 v[140:143], a[124:127], a[60:63], v[140:143]
 ds_read_b64_tr_b16 a[106:107], v53 offset:36864
 v_mfma_f32_16x16x32_bf16 v[136:139], a[124:127], a[52:55], v[136:139]
 ds_read_b64_tr_b16 a[108:109], v53 offset:40960
 v_mfma_f32_16x16x32_bf16 v[136:139], a[120:123], a[48:51], v[136:139]
 ds_read_b64_tr_b16 a[110:111], v53 offset:45056
 v_mfma_f32_16x16x32_bf16 v[132:135], a[120:123], a[40:43], v[132:135]
 buffer_load_dwordx4 a[144:147], v46, s[20:23], s31 offen offset:0 sc1
 v_mfma_f32_16x16x32_bf16 v[132:135], a[124:127], a[44:47], v[132:135]
 v_mfma_f32_16x16x32_bf16 v[128:131], a[124:127], a[36:39], v[128:131]
 buffer_load_dwordx4 a[148:151], v46, s[20:23], s31 offen offset:1024 sc1
 v_mfma_f32_16x16x32_bf16 v[128:131], a[120:123], a[32:35], v[128:131]
 s_waitcnt lgkmcnt(4)
 v_mfma_f32_16x16x32_bf16 v[144:147], a[96:99], a[32:35], v[144:147]
 ds_read_b64_tr_b16 a[112:113], v54 offset:32768
 v_mfma_f32_16x16x32_bf16 v[144:147], a[100:103], a[36:39], v[144:147]
 ds_read_b64_tr_b16 a[114:115], v54 offset:36864
 v_mfma_f32_16x16x32_bf16 v[148:151], a[100:103], a[44:47], v[148:151]
 ds_read_b64_tr_b16 a[116:117], v54 offset:40960
 v_mfma_f32_16x16x32_bf16 v[148:151], a[96:99], a[40:43], v[148:151]
 ds_read_b64_tr_b16 a[118:119], v54 offset:45056
 v_mfma_f32_16x16x32_bf16 v[152:155], a[96:99], a[48:51], v[152:155]
 buffer_load_dwordx4 a[156:159], v47, s[20:23], s31 offen offset:1024 sc1
 v_mfma_f32_16x16x32_bf16 v[152:155], a[100:103], a[52:55], v[152:155]
 v_mfma_f32_16x16x32_bf16 v[156:159], a[100:103], a[60:63], v[156:159]
 buffer_load_dwordx4 a[152:155], v47, s[20:23], s31 offen offset:0 sc1
 v_mfma_f32_16x16x32_bf16 v[156:159], a[96:99], a[56:59], v[156:159]
 s_waitcnt lgkmcnt(4)
 v_mfma_f32_16x16x32_bf16 v[172:175], a[104:107], a[56:59], v[172:175]
 ds_read_b64_tr_b16 a[120:121], v55 offset:32768
 v_mfma_f32_16x16x32_bf16 v[172:175], a[108:111], a[60:63], v[172:175]
 ds_read_b64_tr_b16 a[122:123], v55 offset:36864
 v_mfma_f32_16x16x32_bf16 v[168:171], a[108:111], a[52:55], v[168:171]
 ds_read_b64_tr_b16 a[124:125], v55 offset:40960
 s_waitcnt vmcnt(8)
 v_cmp_gt_u32 vcc, 1, v17
 v_mfma_f32_16x16x32_bf16 v[168:171], a[104:107], a[48:51], v[168:171]
 ds_read_b64_tr_b16 a[126:127], v55 offset:45056
 s_mov_b32 s31, 32768
 s_cbranch_vccnz L_ph2_wait
L_ph2_ok:
 v_mfma_f32_16x16x32_bf16 v[164:167], a[104:107], a[40:43], v[164:167]
 buffer_load_dwordx4 a[160:163], v44, s[20:23], s31 offen offset:0 sc1
 v_mfma_f32_16x16x32_bf16 v[164:167], a[108:111], a[44:47], v[164:167]
 v_mfma_f32_16x16x32_bf16 v[160:163], a[108:111], a[36:39], v[160:163]
 buffer_load_dwordx4 a[164:167], v44, s[20:23], s31 offen offset:1024 sc1
 v_mfma_f32_16x16x32_bf16 v[160:163], a[104:107], a[32:35], v[160:163]
 s_waitcnt lgkmcnt(4)
 v_mfma_f32_16x16x32_bf16 v[176:179], a[112:115], a[32:35], v[176:179]
 ds_read_b64_tr_b16 a[96:97], v48 offset:49152
 v_mfma_f32_16x16x32_bf16 v[176:179], a[116:119], a[36:39], v[176:179]
 ds_read_b64_tr_b16 a[98:99], v48 offset:53248
 v_mfma_f32_16x16x32_bf16 v[180:183], a[116:119], a[44:47], v[180:183]
 ds_read_b64_tr_b16 a[100:101], v48 offset:57344
 v_mfma_f32_16x16x32_bf16 v[180:183], a[112:115], a[40:43], v[180:183]
 ds_read_b64_tr_b16 a[102:103], v48 offset:61440
 v_mfma_f32_16x16x32_bf16 v[184:187], a[112:115], a[48:51], v[184:187]
 buffer_load_dwordx4 a[172:175], v45, s[20:23], s31 offen offset:1024 sc1
 v_mfma_f32_16x16x32_bf16 v[184:187], a[116:119], a[52:55], v[184:187]
 v_mfma_f32_16x16x32_bf16 v[188:191], a[116:119], a[60:63], v[188:191]
 buffer_load_dwordx4 a[168:171], v45, s[20:23], s31 offen offset:0 sc1
 v_mfma_f32_16x16x32_bf16 v[188:191], a[112:115], a[56:59], v[188:191]
 s_waitcnt lgkmcnt(4)
 v_mfma_f32_16x16x32_bf16 v[204:207], a[120:123], a[56:59], v[204:207]
 ds_read_b64_tr_b16 a[104:105], v49 offset:49152
 v_mfma_f32_16x16x32_bf16 v[204:207], a[124:127], a[60:63], v[204:207]
 ds_read_b64_tr_b16 a[106:107], v49 offset:53248
 v_mfma_f32_16x16x32_bf16 v[200:203], a[124:127], a[52:55], v[200:203]
 ds_read_b64_tr_b16 a[108:109], v49 offset:57344
 v_mfma_f32_16x16x32_bf16 v[200:203], a[120:123], a[48:51], v[200:203]
 ds_read_b64_tr_b16 a[110:111], v49 offset:61440
 v_mfma_f32_16x16x32_bf16 v[196:199], a[120:123], a[40:43], v[196:199]
 buffer_load_dwordx4 a[176:179], v46, s[20:23], s31 offen offset:0 sc1
 v_mfma_f32_16x16x32_bf16 v[196:199], a[124:127], a[44:47], v[196:199]
 v_mfma_f32_16x16x32_bf16 v[192:195], a[124:127], a[36:39], v[192:195]
 buffer_load_dwordx4 a[180:183], v46, s[20:23], s31 offen offset:1024 sc1
 v_mfma_f32_16x16x32_bf16 v[192:195], a[120:123], a[32:35], v[192:195]
 s_waitcnt lgkmcnt(4)
 v_mfma_f32_16x16x32_bf16 v[80:83], a[96:99], a[64:67], v[80:83]
 ds_read_b64_tr_b16 a[112:113], v50 offset:49152
 s_cmp_le_u32 s63, 2
 s_addc_u32 s33, 2, 0
 v_mfma_f32_16x16x32_bf16 v[80:83], a[100:103], a[68:71], v[80:83]
 ds_read_b64_tr_b16 a[114:115], v50 offset:53248
 s_mul_i32 s33, s33, 229376
 v_mfma_f32_16x16x32_bf16 v[84:87], a[100:103], a[76:79], v[84:87]
 ds_read_b64_tr_b16 a[116:117], v50 offset:57344
 s_add_u32 s32, s33, s59
 v_mfma_f32_16x16x32_bf16 v[84:87], a[96:99], a[72:75], v[84:87]
 ds_read_b64_tr_b16 a[118:119], v50 offset:61440
 s_add_u32 m0, s47, 86016
 v_mfma_f32_16x16x32_bf16 v[88:91], a[96:99], a[80:83], v[88:91]
 buffer_load_dwordx4 v20, s[16:19], s32 offen lds
 v_mfma_f32_16x16x32_bf16 v[88:91], a[100:103], a[84:87], v[88:91]
 s_add_u32 m0, s47, 87040
 v_mfma_f32_16x16x32_bf16 v[92:95], a[100:103], a[92:95], v[92:95]
 buffer_load_dwordx4 v21, s[16:19], s32 offen lds
 s_add_u32 s32, s32, 16384
 v_mfma_f32_16x16x32_bf16 v[92:95], a[96:99], a[88:91], v[92:95]
 s_waitcnt lgkmcnt(4)
 v_mfma_f32_16x16x32_bf16 v[108:111], a[104:107], a[88:91], v[108:111]
 ds_read_b64_tr_b16 a[120:121], v51 offset:49152
 v_mfma_f32_16x16x32_bf16 v[108:111], a[108:111], a[92:95], v[108:111]
 ds_read_b64_tr_b16 a[122:123], v51 offset:53248
 v_mfma_f32_16x16x32_bf16 v[104:107], a[108:111], a[84:87], v[104:107]
 ds_read_b64_tr_b16 a[124:125], v51 offset:57344
 v_mfma_f32_16x16x32_bf16 v[104:107], a[104:107], a[80:83], v[104:107]
 ds_read_b64_tr_b16 a[126:127], v51 offset:61440
 s_add_u32 m0, s47, 88064
 v_mfma_f32_16x16x32_bf16 v[100:103], a[104:107], a[72:75], v[100:103]
 buffer_load_dwordx4 v20, s[16:19], s32 offen lds
 v_mfma_f32_16x16x32_bf16 v[100:103], a[108:111], a[76:79], v[100:103]
 s_add_u32 m0, s47, 89088
 v_mfma_f32_16x16x32_bf16 v[96:99], a[108:111], a[68:71], v[96:99]
 buffer_load_dwordx4 v21, s[16:19], s32 offen lds
 v_mfma_f32_16x16x32_bf16 v[96:99], a[104:107], a[64:67], v[96:99]
 global_load_dword a252, v[22:23], off
 s_waitcnt lgkmcnt(4)
 v_mfma_f32_16x16x32_bf16 v[112:115], a[112:115], a[64:67], v[112:115]
 ds_read_b64_tr_b16 a[96:97], v52 offset:49152
 v_mfma_f32_16x16x32_bf16 v[112:115], a[116:119], a[68:71], v[112:115]
 ds_read_b64_tr_b16 a[98:99], v52 offset:53248
 v_mfma_f32_16x16x32_bf16 v[116:119], a[116:119], a[76:79], v[116:119]
 ds_read_b64_tr_b16 a[100:101], v52 offset:57344
 v_mfma_f32_16x16x32_bf16 v[116:119], a[112:115], a[72:75], v[116:119]
 ds_read_b64_tr_b16 a[102:103], v52 offset:61440
 v_mfma_f32_16x16x32_bf16 v[120:123], a[112:115], a[80:83], v[120:123]
 buffer_load_dwordx4 a[188:191], v47, s[20:23], s31 offen offset:1024 sc1
 v_mfma_f32_16x16x32_bf16 v[120:123], a[116:119], a[84:87], v[120:123]
 v_mfma_f32_16x16x32_bf16 v[124:127], a[116:119], a[92:95], v[124:127]
 v_mfma_f32_16x16x32_bf16 v[124:127], a[112:115], a[88:91], v[124:127]
 s_waitcnt lgkmcnt(4)
 v_mfma_f32_16x16x32_bf16 v[140:143], a[120:123], a[88:91], v[140:143]
 ds_read_b64_tr_b16 a[104:105], v53 offset:49152
 v_mfma_f32_16x16x32_bf16 v[140:143], a[124:127], a[92:95], v[140:143]
 ds_read_b64_tr_b16 a[106:107], v53 offset:53248
 v_mfma_f32_16x16x32_bf16 v[136:139], a[124:127], a[84:87], v[136:139]
 ds_read_b64_tr_b16 a[108:109], v53 offset:57344
 v_mfma_f32_16x16x32_bf16 v[136:139], a[120:123], a[80:83], v[136:139]
 ds_read_b64_tr_b16 a[110:111], v53 offset:61440
 v_mfma_f32_16x16x32_bf16 v[132:135], a[120:123], a[72:75], v[132:135]
 buffer_load_dwordx4 a[184:187], v47, s[20:23], s31 offen offset:0 sc1
 v_mfma_f32_16x16x32_bf16 v[132:135], a[124:127], a[76:79], v[132:135]
L_pg11:
 s_cbranch_execz L_main
 s_mov_b32 s31, 34816
 v_mfma_f32_16x16x32_bf16 v[128:131], a[124:127], a[68:71], v[128:131]
 buffer_load_dwordx4 a[0:3], v44, s[20:23], s31 offen offset:0 sc1
 v_mfma_f32_16x16x32_bf16 v[128:131], a[120:123], a[64:67], v[128:131]
 s_waitcnt lgkmcnt(4)
 v_mfma_f32_16x16x32_bf16 v[144:147], a[96:99], a[64:67], v[144:147]
 ds_read_b64_tr_b16 a[112:113], v54 offset:49152
 v_mfma_f32_16x16x32_bf16 v[144:147], a[100:103], a[68:71], v[144:147]
 ds_read_b64_tr_b16 a[114:115], v54 offset:53248
 v_mfma_f32_16x16x32_bf16 v[148:151], a[100:103], a[76:79], v[148:151]
 ds_read_b64_tr_b16 a[116:117], v54 offset:57344
 v_mfma_f32_16x16x32_bf16 v[148:151], a[96:99], a[72:75], v[148:151]
 ds_read_b64_tr_b16 a[118:119], v54 offset:61440
 v_mfma_f32_16x16x32_bf16 v[152:155], a[96:99], a[80:83], v[152:155]
 buffer_load_dwordx4 a[4:7], v44, s[20:23], s31 offen offset:1024 sc1
 v_mfma_f32_16x16x32_bf16 v[152:155], a[100:103], a[84:87], v[152:155]
 v_mfma_f32_16x16x32_bf16 v[156:159], a[100:103], a[92:95], v[156:159]
 buffer_load_dwordx4 a[12:15], v45, s[20:23], s31 offen offset:1024 sc1
 v_mfma_f32_16x16x32_bf16 v[156:159], a[96:99], a[88:91], v[156:159]
 s_waitcnt lgkmcnt(4)
 v_mfma_f32_16x16x32_bf16 v[172:175], a[104:107], a[88:91], v[172:175]
 ds_read_b64_tr_b16 a[120:121], v55 offset:49152
 v_mfma_f32_16x16x32_bf16 v[172:175], a[108:111], a[92:95], v[172:175]
 ds_read_b64_tr_b16 a[122:123], v55 offset:53248
 v_mfma_f32_16x16x32_bf16 v[168:171], a[108:111], a[84:87], v[168:171]
 ds_read_b64_tr_b16 a[124:125], v55 offset:57344
 v_mfma_f32_16x16x32_bf16 v[168:171], a[104:107], a[80:83], v[168:171]
 ds_read_b64_tr_b16 a[126:127], v55 offset:61440
 v_mfma_f32_16x16x32_bf16 v[164:167], a[104:107], a[72:75], v[164:167]
 v_mfma_f32_16x16x32_bf16 v[164:167], a[108:111], a[76:79], v[164:167]
 v_mfma_f32_16x16x32_bf16 v[160:163], a[108:111], a[68:71], v[160:163]
 buffer_load_dwordx4 a[8:11], v45, s[20:23], s31 offen offset:0 sc1
 v_mfma_f32_16x16x32_bf16 v[160:163], a[104:107], a[64:67], v[160:163]
 s_waitcnt lgkmcnt(4)
 v_mfma_f32_16x16x32_bf16 v[176:179], a[112:115], a[64:67], v[176:179]
 ds_read_b64_tr_b16 a[96:97], v14 offset:0
 v_mfma_f32_16x16x32_bf16 v[176:179], a[116:119], a[68:71], v[176:179]
 ds_read_b64_tr_b16 a[98:99], v14 offset:8192
 v_mfma_f32_16x16x32_bf16 v[180:183], a[116:119], a[76:79], v[180:183]
 ds_read_b64_tr_b16 a[100:101], v14 offset:16384
 v_mfma_f32_16x16x32_bf16 v[180:183], a[112:115], a[72:75], v[180:183]
 ds_read_b64_tr_b16 a[102:103], v14 offset:24576
 v_mfma_f32_16x16x32_bf16 v[184:187], a[112:115], a[80:83], v[184:187]
 buffer_load_dwordx4 a[16:19], v46, s[20:23], s31 offen offset:0 sc1
 v_mfma_f32_16x16x32_bf16 v[184:187], a[116:119], a[84:87], v[184:187]
 v_mfma_f32_16x16x32_bf16 v[188:191], a[116:119], a[92:95], v[188:191]
 buffer_load_dwordx4 a[20:23], v46, s[20:23], s31 offen offset:1024 sc1
 v_mfma_f32_16x16x32_bf16 v[188:191], a[112:115], a[88:91], v[188:191]
 s_waitcnt lgkmcnt(4)
 v_mfma_f32_16x16x32_bf16 v[204:207], a[120:123], a[88:91], v[204:207]
 ds_read_b64_tr_b16 a[104:105], v15 offset:0
 v_mfma_f32_16x16x32_bf16 v[204:207], a[124:127], a[92:95], v[204:207]
 ds_read_b64_tr_b16 a[106:107], v15 offset:8192
 v_mfma_f32_16x16x32_bf16 v[200:203], a[124:127], a[84:87], v[200:203]
 ds_read_b64_tr_b16 a[108:109], v15 offset:16384
 v_mfma_f32_16x16x32_bf16 v[200:203], a[120:123], a[80:83], v[200:203]
 ds_read_b64_tr_b16 a[110:111], v15 offset:24576
 v_mfma_f32_16x16x32_bf16 v[196:199], a[120:123], a[72:75], v[196:199]
 buffer_load_dwordx4 a[28:31], v47, s[20:23], s31 offen offset:1024 sc1
 v_mfma_f32_16x16x32_bf16 v[196:199], a[124:127], a[76:79], v[196:199]
 v_mfma_f32_16x16x32_bf16 v[192:195], a[124:127], a[68:71], v[192:195]
 v_mfma_f32_16x16x32_bf16 v[192:195], a[120:123], a[64:67], v[192:195]
 s_waitcnt lgkmcnt(4)
 v_mfma_f32_16x16x32_bf16 v[80:83], a[96:99], a[128:131], v[80:83]
 ds_read_b64_tr_b16 a[112:113], v4 offset:0
 v_mfma_f32_16x16x32_bf16 v[80:83], a[100:103], a[132:135], v[80:83]
 ds_read_b64_tr_b16 a[114:115], v4 offset:8192
 v_mfma_f32_16x16x32_bf16 v[84:87], a[100:103], a[140:143], v[84:87]
 ds_read_b64_tr_b16 a[116:117], v4 offset:16384
 v_mfma_f32_16x16x32_bf16 v[84:87], a[96:99], a[136:139], v[84:87]
 ds_read_b64_tr_b16 a[118:119], v4 offset:24576
 s_waitcnt vmcnt(20)
 v_mfma_f32_16x16x32_bf16 v[88:91], a[96:99], a[144:147], v[88:91]
 v_mfma_f32_16x16x32_bf16 v[88:91], a[100:103], a[148:151], v[88:91]
 s_barrier
 v_mfma_f32_16x16x32_bf16 v[92:95], a[100:103], a[156:159], v[92:95]
 v_mfma_f32_16x16x32_bf16 v[92:95], a[96:99], a[152:155], v[92:95]
 s_waitcnt lgkmcnt(4)
 v_mfma_f32_16x16x32_bf16 v[108:111], a[104:107], a[152:155], v[108:111]
 ds_read_b64_tr_b16 a[120:121], v5 offset:0
 s_cmp_le_u32 s63, 3
 s_addc_u32 s33, 3, 0
 v_mfma_f32_16x16x32_bf16 v[108:111], a[108:111], a[156:159], v[108:111]
 ds_read_b64_tr_b16 a[122:123], v5 offset:8192
 s_mul_i32 s33, s33, 229376
 v_mfma_f32_16x16x32_bf16 v[104:107], a[108:111], a[148:151], v[104:107]
 ds_read_b64_tr_b16 a[124:125], v5 offset:16384
 s_add_u32 s32, s33, s59
 v_mfma_f32_16x16x32_bf16 v[104:107], a[104:107], a[144:147], v[104:107]
 ds_read_b64_tr_b16 a[126:127], v5 offset:24576
 s_add_u32 m0, s47, 102400
 v_mfma_f32_16x16x32_bf16 v[100:103], a[104:107], a[136:139], v[100:103]
 buffer_load_dwordx4 v20, s[16:19], s32 offen lds
 v_mfma_f32_16x16x32_bf16 v[100:103], a[108:111], a[140:143], v[100:103]
 s_add_u32 m0, s47, 103424
 v_mfma_f32_16x16x32_bf16 v[96:99], a[108:111], a[132:135], v[96:99]
 buffer_load_dwordx4 v21, s[16:19], s32 offen lds
 s_add_u32 s32, s32, 16384
 v_mfma_f32_16x16x32_bf16 v[96:99], a[104:107], a[128:131], v[96:99]
 s_waitcnt lgkmcnt(4)
 v_mfma_f32_16x16x32_bf16 v[112:115], a[112:115], a[128:131], v[112:115]
 ds_read_b64_tr_b16 a[96:97], v6 offset:0
 v_mfma_f32_16x16x32_bf16 v[112:115], a[116:119], a[132:135], v[112:115]
 ds_read_b64_tr_b16 a[98:99], v6 offset:8192
 v_mfma_f32_16x16x32_bf16 v[116:119], a[116:119], a[140:143], v[116:119]
 ds_read_b64_tr_b16 a[100:101], v6 offset:16384
 v_mfma_f32_16x16x32_bf16 v[116:119], a[112:115], a[136:139], v[116:119]
 ds_read_b64_tr_b16 a[102:103], v6 offset:24576
 s_add_u32 m0, s47, 104448
 v_mfma_f32_16x16x32_bf16 v[120:123], a[112:115], a[144:147], v[120:123]
 buffer_load_dwordx4 v20, s[16:19], s32 offen lds
 v_mfma_f32_16x16x32_bf16 v[120:123], a[116:119], a[148:151], v[120:123]
 s_add_u32 m0, s47, 105472
 v_mfma_f32_16x16x32_bf16 v[124:127], a[116:119], a[156:159], v[124:127]
 buffer_load_dwordx4 v21, s[16:19], s32 offen lds
 v_mfma_f32_16x16x32_bf16 v[124:127], a[112:115], a[152:155], v[124:127]
 s_waitcnt lgkmcnt(4)
 v_mfma_f32_16x16x32_bf16 v[140:143], a[120:123], a[152:155], v[140:143]
 ds_read_b64_tr_b16 a[104:105], v7 offset:0
 v_mfma_f32_16x16x32_bf16 v[140:143], a[124:127], a[156:159], v[140:143]
 ds_read_b64_tr_b16 a[106:107], v7 offset:8192
 v_mfma_f32_16x16x32_bf16 v[136:139], a[124:127], a[148:151], v[136:139]
 ds_read_b64_tr_b16 a[108:109], v7 offset:16384
 v_mfma_f32_16x16x32_bf16 v[136:139], a[120:123], a[144:147], v[136:139]
 ds_read_b64_tr_b16 a[110:111], v7 offset:24576
 v_mfma_f32_16x16x32_bf16 v[132:135], a[120:123], a[136:139], v[132:135]
 buffer_load_dwordx4 a[24:27], v47, s[20:23], s31 offen offset:0 sc1
 s_cmp_le_u32 s63, 0
 s_addc_u32 s37, 0, 0
 v_mfma_f32_16x16x32_bf16 v[132:135], a[124:127], a[140:143], v[132:135]
 s_lshl_b32 s31, s37, 12
 v_mfma_f32_16x16x32_bf16 v[128:131], a[124:127], a[132:135], v[128:131]
 buffer_load_dwordx4 a[32:35], v44, s[20:23], s31 offen offset:2048 sc1
 v_mfma_f32_16x16x32_bf16 v[128:131], a[120:123], a[128:131], v[128:131]
 s_waitcnt lgkmcnt(4)
 v_mfma_f32_16x16x32_bf16 v[144:147], a[96:99], a[128:131], v[144:147]
 ds_read_b64_tr_b16 a[112:113], v9 offset:0
 s_waitcnt vmcnt(25)
 v_accvgpr_read_b32 v40, a162
 v_mfma_f32_16x16x32_bf16 v[144:147], a[100:103], a[132:135], v[144:147]
 ds_read_b64_tr_b16 a[114:115], v9 offset:8192
 v_accvgpr_read_b32 v41, a163
 v_mfma_f32_16x16x32_bf16 v[148:151], a[100:103], a[140:143], v[148:151]
 ds_read_b64_tr_b16 a[116:117], v9 offset:16384
 s_waitcnt vmcnt(22)
 v_accvgpr_mov_b32 a162, a168
 v_mfma_f32_16x16x32_bf16 v[148:151], a[96:99], a[136:139], v[148:151]
 ds_read_b64_tr_b16 a[118:119], v9 offset:24576
 v_accvgpr_mov_b32 a163, a169
 v_mfma_f32_16x16x32_bf16 v[152:155], a[96:99], a[144:147], v[152:155]
 buffer_load_dwordx4 a[36:39], v44, s[20:23], s31 offen offset:3072 sc1
 v_accvgpr_write_b32 a168, v40
 v_mfma_f32_16x16x32_bf16 v[152:155], a[100:103], a[148:151], v[152:155]
 v_accvgpr_write_b32 a169, v41
 v_mfma_f32_16x16x32_bf16 v[156:159], a[100:103], a[156:159], v[156:159]
 buffer_load_dwordx4 a[44:47], v45, s[20:23], s31 offen offset:3072 sc1
 v_accvgpr_read_b32 v40, a166
 v_mfma_f32_16x16x32_bf16 v[156:159], a[96:99], a[152:155], v[156:159]
 s_waitcnt lgkmcnt(4)
 v_accvgpr_read_b32 v41, a167
 v_mfma_f32_16x16x32_bf16 v[172:175], a[104:107], a[152:155], v[172:175]
 ds_read_b64_tr_b16 a[120:121], v10 offset:0
 v_accvgpr_mov_b32 a166, a172
 v_mfma_f32_16x16x32_bf16 v[172:175], a[108:111], a[156:159], v[172:175]
 ds_read_b64_tr_b16 a[122:123], v10 offset:8192
 v_accvgpr_mov_b32 a167, a173
 v_mfma_f32_16x16x32_bf16 v[168:171], a[108:111], a[148:151], v[168:171]
 ds_read_b64_tr_b16 a[124:125], v10 offset:16384
 v_accvgpr_write_b32 a172, v40
 v_mfma_f32_16x16x32_bf16 v[168:171], a[104:107], a[144:147], v[168:171]
 ds_read_b64_tr_b16 a[126:127], v10 offset:24576
 v_accvgpr_write_b32 a173, v41
 v_mfma_f32_16x16x32_bf16 v[164:167], a[104:107], a[136:139], v[164:167]
 buffer_load_dwordx4 a[40:43], v45, s[20:23], s31 offen offset:2048 sc1
 s_waitcnt vmcnt(24)
 v_accvgpr_read_b32 v40, a178
 v_mfma_f32_16x16x32_bf16 v[164:167], a[108:111], a[140:143], v[164:167]
 v_accvgpr_read_b32 v41, a179
 v_mfma_f32_16x16x32_bf16 v[160:163], a[108:111], a[132:135], v[160:163]
 buffer_load_dwordx4 a[48:51], v46, s[20:23], s31 offen offset:2048 sc1
 s_waitcnt vmcnt(17)
 v_accvgpr_mov_b32 a178, a184
 v_mfma_f32_16x16x32_bf16 v[160:163], a[104:107], a[128:131], v[160:163]
 s_waitcnt lgkmcnt(4)
 v_accvgpr_mov_b32 a179, a185
 v_mfma_f32_16x16x32_bf16 v[176:179], a[112:115], a[128:131], v[176:179]
 ds_read_b64_tr_b16 a[96:97], v14 offset:4096
 v_accvgpr_write_b32 a184, v40
 v_mfma_f32_16x16x32_bf16 v[176:179], a[116:119], a[132:135], v[176:179]
 ds_read_b64_tr_b16 a[98:99], v14 offset:12288
 v_accvgpr_write_b32 a185, v41
 v_mfma_f32_16x16x32_bf16 v[180:183], a[116:119], a[140:143], v[180:183]
 ds_read_b64_tr_b16 a[100:101], v14 offset:20480
 v_accvgpr_read_b32 v40, a182
 v_mfma_f32_16x16x32_bf16 v[180:183], a[112:115], a[136:139], v[180:183]
 ds_read_b64_tr_b16 a[102:103], v14 offset:28672
 v_accvgpr_read_b32 v41, a183
 v_mfma_f32_16x16x32_bf16 v[184:187], a[112:115], a[144:147], v[184:187]
 buffer_load_dwordx4 a[52:55], v46, s[20:23], s31 offen offset:3072 sc1
 v_accvgpr_mov_b32 a182, a188
 v_mfma_f32_16x16x32_bf16 v[184:187], a[116:119], a[148:151], v[184:187]
 v_accvgpr_mov_b32 a183, a189
 v_mfma_f32_16x16x32_bf16 v[188:191], a[116:119], a[156:159], v[188:191]
 buffer_load_dwordx4 a[60:63], v47, s[20:23], s31 offen offset:3072 sc1
 v_accvgpr_write_b32 a188, v40
 v_mfma_f32_16x16x32_bf16 v[188:191], a[112:115], a[152:155], v[188:191]
 s_waitcnt lgkmcnt(4)
 v_accvgpr_write_b32 a189, v41
 v_mfma_f32_16x16x32_bf16 v[204:207], a[120:123], a[152:155], v[204:207]
 ds_read_b64_tr_b16 a[104:105], v15 offset:4096
 v_mfma_f32_16x16x32_bf16 v[204:207], a[124:127], a[156:159], v[204:207]
 ds_read_b64_tr_b16 a[106:107], v15 offset:12288
 v_mfma_f32_16x16x32_bf16 v[200:203], a[124:127], a[148:151], v[200:203]
 ds_read_b64_tr_b16 a[108:109], v15 offset:20480
 v_mfma_f32_16x16x32_bf16 v[200:203], a[120:123], a[144:147], v[200:203]
 ds_read_b64_tr_b16 a[110:111], v15 offset:28672
 v_mfma_f32_16x16x32_bf16 v[196:199], a[120:123], a[136:139], v[196:199]
 buffer_load_dwordx4 a[56:59], v47, s[20:23], s31 offen offset:2048 sc1
 v_mfma_f32_16x16x32_bf16 v[196:199], a[124:127], a[140:143], v[196:199]
 v_mfma_f32_16x16x32_bf16 v[192:195], a[124:127], a[132:135], v[192:195]
 v_mfma_f32_16x16x32_bf16 v[192:195], a[120:123], a[128:131], v[192:195]
 s_waitcnt lgkmcnt(4)
 v_mfma_f32_16x16x32_bf16 v[80:83], a[96:99], a[160:163], v[80:83]
 ds_read_b64_tr_b16 a[112:113], v4 offset:4096
 s_cmp_le_u32 s63, 4
 s_addc_u32 s33, 4, 0
 v_mfma_f32_16x16x32_bf16 v[80:83], a[100:103], a[164:167], v[80:83]
 ds_read_b64_tr_b16 a[114:115], v4 offset:12288
 s_mul_i32 s33, s33, 229376
 v_mfma_f32_16x16x32_bf16 v[84:87], a[100:103], a[172:175], v[84:87]
 ds_read_b64_tr_b16 a[116:117], v4 offset:20480
 s_add_u32 s32, s33, s59
 v_mfma_f32_16x16x32_bf16 v[84:87], a[96:99], a[168:171], v[84:87]
 ds_read_b64_tr_b16 a[118:119], v4 offset:28672
 s_add_u32 m0, s47, 118784
 v_mfma_f32_16x16x32_bf16 v[88:91], a[96:99], a[176:179], v[88:91]
 buffer_load_dwordx4 v20, s[16:19], s32 offen lds
 v_mfma_f32_16x16x32_bf16 v[88:91], a[100:103], a[180:183], v[88:91]
 s_add_u32 m0, s47, 119808
 v_mfma_f32_16x16x32_bf16 v[92:95], a[100:103], a[188:191], v[92:95]
 buffer_load_dwordx4 v21, s[16:19], s32 offen lds
 s_add_u32 s32, s32, 16384
 v_mfma_f32_16x16x32_bf16 v[92:95], a[96:99], a[184:187], v[92:95]
 s_waitcnt lgkmcnt(4)
 v_mfma_f32_16x16x32_bf16 v[108:111], a[104:107], a[184:187], v[108:111]
 ds_read_b64_tr_b16 a[120:121], v5 offset:4096
 v_mfma_f32_16x16x32_bf16 v[108:111], a[108:111], a[188:191], v[108:111]
 ds_read_b64_tr_b16 a[122:123], v5 offset:12288
 v_mfma_f32_16x16x32_bf16 v[104:107], a[108:111], a[180:183], v[104:107]
 ds_read_b64_tr_b16 a[124:125], v5 offset:20480
 v_mfma_f32_16x16x32_bf16 v[104:107], a[104:107], a[176:179], v[104:107]
 ds_read_b64_tr_b16 a[126:127], v5 offset:28672
 s_add_u32 m0, s47, 120832
 v_mfma_f32_16x16x32_bf16 v[100:103], a[104:107], a[168:171], v[100:103]
 buffer_load_dwordx4 v20, s[16:19], s32 offen lds
 v_mfma_f32_16x16x32_bf16 v[100:103], a[108:111], a[172:175], v[100:103]
 s_add_u32 m0, s47, 121856
 v_mfma_f32_16x16x32_bf16 v[96:99], a[108:111], a[164:167], v[96:99]
 buffer_load_dwordx4 v21, s[16:19], s32 offen lds
 s_cmp_le_u32 s63, 1
 s_addc_u32 s37, 1, 0
 v_mfma_f32_16x16x32_bf16 v[96:99], a[104:107], a[160:163], v[96:99]
 s_waitcnt lgkmcnt(4)
 v_mfma_f32_16x16x32_bf16 v[112:115], a[112:115], a[160:163], v[112:115]
 ds_read_b64_tr_b16 a[96:97], v6 offset:4096
 v_mfma_f32_16x16x32_bf16 v[112:115], a[116:119], a[164:167], v[112:115]
 ds_read_b64_tr_b16 a[98:99], v6 offset:12288
 v_mfma_f32_16x16x32_bf16 v[116:119], a[116:119], a[172:175], v[116:119]
 ds_read_b64_tr_b16 a[100:101], v6 offset:20480
 v_mfma_f32_16x16x32_bf16 v[116:119], a[112:115], a[168:171], v[116:119]
 ds_read_b64_tr_b16 a[102:103], v6 offset:28672
 s_lshl_b32 s31, s37, 12
 v_mfma_f32_16x16x32_bf16 v[120:123], a[112:115], a[176:179], v[120:123]
 buffer_load_dwordx4 a[64:67], v44, s[20:23], s31 offen offset:2048 sc1
 v_mfma_f32_16x16x32_bf16 v[120:123], a[116:119], a[180:183], v[120:123]
 v_mfma_f32_16x16x32_bf16 v[124:127], a[116:119], a[188:191], v[124:127]
 v_mfma_f32_16x16x32_bf16 v[124:127], a[112:115], a[184:187], v[124:127]
 s_waitcnt lgkmcnt(4)
 v_mfma_f32_16x16x32_bf16 v[140:143], a[120:123], a[184:187], v[140:143]
 ds_read_b64_tr_b16 a[104:105], v7 offset:4096
 v_mfma_f32_16x16x32_bf16 v[140:143], a[124:127], a[188:191], v[140:143]
 ds_read_b64_tr_b16 a[106:107], v7 offset:12288
 v_mfma_f32_16x16x32_bf16 v[136:139], a[124:127], a[180:183], v[136:139]
 ds_read_b64_tr_b16 a[108:109], v7 offset:20480
 v_mfma_f32_16x16x32_bf16 v[136:139], a[120:123], a[176:179], v[136:139]
 ds_read_b64_tr_b16 a[110:111], v7 offset:28672
 v_mfma_f32_16x16x32_bf16 v[132:135], a[120:123], a[168:171], v[132:135]
 buffer_load_dwordx4 a[68:71], v44, s[20:23], s31 offen offset:3072 sc1
 v_mfma_f32_16x16x32_bf16 v[132:135], a[124:127], a[172:175], v[132:135]
 v_mfma_f32_16x16x32_bf16 v[128:131], a[124:127], a[164:167], v[128:131]
 buffer_load_dwordx4 a[76:79], v45, s[20:23], s31 offen offset:3072 sc1
 v_mfma_f32_16x16x32_bf16 v[128:131], a[120:123], a[160:163], v[128:131]
 s_waitcnt lgkmcnt(4)
 v_mfma_f32_16x16x32_bf16 v[144:147], a[96:99], a[160:163], v[144:147]
 ds_read_b64_tr_b16 a[112:113], v9 offset:4096
 s_waitcnt vmcnt(26)
 v_accvgpr_read_b32 v40, a2
 v_mfma_f32_16x16x32_bf16 v[144:147], a[100:103], a[164:167], v[144:147]
 ds_read_b64_tr_b16 a[114:115], v9 offset:12288
 v_accvgpr_read_b32 v41, a3
 v_mfma_f32_16x16x32_bf16 v[148:151], a[100:103], a[172:175], v[148:151]
 ds_read_b64_tr_b16 a[116:117], v9 offset:20480
 s_waitcnt vmcnt(23)
 v_accvgpr_mov_b32 a2, a8
 v_mfma_f32_16x16x32_bf16 v[148:151], a[96:99], a[168:171], v[148:151]
 ds_read_b64_tr_b16 a[118:119], v9 offset:28672
 v_accvgpr_mov_b32 a3, a9
 v_mfma_f32_16x16x32_bf16 v[152:155], a[96:99], a[176:179], v[152:155]
 buffer_load_dwordx4 a[72:75], v45, s[20:23], s31 offen offset:2048 sc1
 v_accvgpr_write_b32 a8, v40
 v_mfma_f32_16x16x32_bf16 v[152:155], a[100:103], a[180:183], v[152:155]
 v_accvgpr_write_b32 a9, v41
 v_mfma_f32_16x16x32_bf16 v[156:159], a[100:103], a[188:191], v[156:159]
 buffer_load_dwordx4 a[80:83], v46, s[20:23], s31 offen offset:2048 sc1
 v_accvgpr_read_b32 v40, a6
 v_mfma_f32_16x16x32_bf16 v[156:159], a[96:99], a[184:187], v[156:159]
 s_waitcnt lgkmcnt(4)
 v_accvgpr_read_b32 v41, a7
 v_mfma_f32_16x16x32_bf16 v[172:175], a[104:107], a[184:187], v[172:175]
 ds_read_b64_tr_b16 a[120:121], v10 offset:4096
 v_accvgpr_mov_b32 a6, a12
 v_mfma_f32_16x16x32_bf16 v[172:175], a[108:111], a[188:191], v[172:175]
 ds_read_b64_tr_b16 a[122:123], v10 offset:12288
 v_accvgpr_mov_b32 a7, a13
 v_mfma_f32_16x16x32_bf16 v[168:171], a[108:111], a[180:183], v[168:171]
 ds_read_b64_tr_b16 a[124:125], v10 offset:20480
 v_accvgpr_write_b32 a12, v40
 v_mfma_f32_16x16x32_bf16 v[168:171], a[104:107], a[176:179], v[168:171]
 ds_read_b64_tr_b16 a[126:127], v10 offset:28672
 v_accvgpr_write_b32 a13, v41
 v_mfma_f32_16x16x32_bf16 v[164:167], a[104:107], a[168:171], v[164:167]
 s_waitcnt vmcnt(24)
 v_accvgpr_read_b32 v40, a18
 v_mfma_f32_16x16x32_bf16 v[164:167], a[108:111], a[172:175], v[164:167]
 v_accvgpr_read_b32 v41, a19
 v_mfma_f32_16x16x32_bf16 v[160:163], a[108:111], a[164:167], v[160:163]
 buffer_load_dwordx4 a[84:87], v46, s[20:23], s31 offen offset:3072 sc1
 s_waitcnt vmcnt(18)
 v_accvgpr_mov_b32 a18, a24
 v_mfma_f32_16x16x32_bf16 v[160:163], a[104:107], a[160:163], v[160:163]
 s_waitcnt lgkmcnt(4)
 v_accvgpr_mov_b32 a19, a25
 v_mfma_f32_16x16x32_bf16 v[176:179], a[112:115], a[160:163], v[176:179]
 ds_read_b64_tr_b16 a[96:97], v14 offset:32768
 v_accvgpr_write_b32 a24, v40
 v_mfma_f32_16x16x32_bf16 v[176:179], a[116:119], a[164:167], v[176:179]
 ds_read_b64_tr_b16 a[98:99], v14 offset:40960
 v_accvgpr_write_b32 a25, v41
 v_mfma_f32_16x16x32_bf16 v[180:183], a[116:119], a[172:175], v[180:183]
 ds_read_b64_tr_b16 a[100:101], v14 offset:49152
 v_accvgpr_read_b32 v40, a22
 v_mfma_f32_16x16x32_bf16 v[180:183], a[112:115], a[168:171], v[180:183]
 ds_read_b64_tr_b16 a[102:103], v14 offset:57344
 v_accvgpr_read_b32 v41, a23
 v_mfma_f32_16x16x32_bf16 v[184:187], a[112:115], a[176:179], v[184:187]
 buffer_load_dwordx4 a[92:95], v47, s[20:23], s31 offen offset:3072 sc1
 v_accvgpr_mov_b32 a22, a28
 v_mfma_f32_16x16x32_bf16 v[184:187], a[116:119], a[180:183], v[184:187]
 v_accvgpr_mov_b32 a23, a29
 v_mfma_f32_16x16x32_bf16 v[188:191], a[116:119], a[188:191], v[188:191]
 buffer_load_dwordx4 a[88:91], v47, s[20:23], s31 offen offset:2048 sc1
 s_cmp_le_u32 s63, 2
 s_addc_u32 s37, 2, 0
 v_mfma_f32_16x16x32_bf16 v[188:191], a[112:115], a[184:187], v[188:191]
 s_waitcnt lgkmcnt(4)
 v_accvgpr_write_b32 a28, v40
 v_mfma_f32_16x16x32_bf16 v[204:207], a[120:123], a[184:187], v[204:207]
 ds_read_b64_tr_b16 a[104:105], v15 offset:32768
 v_accvgpr_write_b32 a29, v41
 v_mfma_f32_16x16x32_bf16 v[204:207], a[124:127], a[188:191], v[204:207]
 ds_read_b64_tr_b16 a[106:107], v15 offset:40960
 v_mfma_f32_16x16x32_bf16 v[200:203], a[124:127], a[180:183], v[200:203]
 ds_read_b64_tr_b16 a[108:109], v15 offset:49152
 v_mfma_f32_16x16x32_bf16 v[200:203], a[120:123], a[176:179], v[200:203]
 ds_read_b64_tr_b16 a[110:111], v15 offset:57344
 s_lshl_b32 s31, s37, 12
 v_mfma_f32_16x16x32_bf16 v[196:199], a[120:123], a[168:171], v[196:199]
 buffer_load_dwordx4 a[128:131], v44, s[20:23], s31 offen offset:2048 sc1
 v_mfma_f32_16x16x32_bf16 v[196:199], a[124:127], a[172:175], v[196:199]
 v_mfma_f32_16x16x32_bf16 v[192:195], a[124:127], a[164:167], v[192:195]
 v_mfma_f32_16x16x32_bf16 v[192:195], a[120:123], a[160:163], v[192:195]
 s_waitcnt lgkmcnt(4)
 v_mfma_f32_16x16x32_bf16 v[80:83], a[96:99], a[0:3], v[80:83]
 ds_read_b64_tr_b16 a[112:113], v4 offset:32768
 v_mfma_f32_16x16x32_bf16 v[80:83], a[100:103], a[4:7], v[80:83]
 ds_read_b64_tr_b16 a[114:115], v4 offset:40960
 v_mfma_f32_16x16x32_bf16 v[84:87], a[100:103], a[12:15], v[84:87]
 ds_read_b64_tr_b16 a[116:117], v4 offset:49152
 v_mfma_f32_16x16x32_bf16 v[84:87], a[96:99], a[8:11], v[84:87]
 ds_read_b64_tr_b16 a[118:119], v4 offset:57344
 v_mfma_f32_16x16x32_bf16 v[88:91], a[96:99], a[16:19], v[88:91]
 v_mfma_f32_16x16x32_bf16 v[88:91], a[100:103], a[20:23], v[88:91]
 s_barrier
 v_mfma_f32_16x16x32_bf16 v[92:95], a[100:103], a[28:31], v[92:95]
 v_mfma_f32_16x16x32_bf16 v[92:95], a[96:99], a[24:27], v[92:95]
 s_waitcnt lgkmcnt(4)
 v_mfma_f32_16x16x32_bf16 v[108:111], a[104:107], a[24:27], v[108:111]
 ds_read_b64_tr_b16 a[120:121], v5 offset:32768
 s_cmp_le_u32 s63, 5
 s_addc_u32 s33, 5, 0
 v_mfma_f32_16x16x32_bf16 v[108:111], a[108:111], a[28:31], v[108:111]
 ds_read_b64_tr_b16 a[122:123], v5 offset:40960
 s_mul_i32 s33, s33, 229376
 v_mfma_f32_16x16x32_bf16 v[104:107], a[108:111], a[20:23], v[104:107]
 ds_read_b64_tr_b16 a[124:125], v5 offset:49152
 s_add_u32 s32, s33, s59
 v_mfma_f32_16x16x32_bf16 v[104:107], a[104:107], a[16:19], v[104:107]
 ds_read_b64_tr_b16 a[126:127], v5 offset:57344
 s_add_u32 m0, s39, 0
 v_mfma_f32_16x16x32_bf16 v[100:103], a[104:107], a[8:11], v[100:103]
 buffer_load_dwordx4 v20, s[16:19], s32 offen lds
 v_mfma_f32_16x16x32_bf16 v[100:103], a[108:111], a[12:15], v[100:103]
 s_add_u32 m0, s39, 1024
 v_mfma_f32_16x16x32_bf16 v[96:99], a[108:111], a[4:7], v[96:99]
 buffer_load_dwordx4 v21, s[16:19], s32 offen lds
 s_add_u32 s32, s32, 16384
 v_mfma_f32_16x16x32_bf16 v[96:99], a[104:107], a[0:3], v[96:99]
 s_waitcnt lgkmcnt(4)
 v_mfma_f32_16x16x32_bf16 v[112:115], a[112:115], a[0:3], v[112:115]
 ds_read_b64_tr_b16 a[96:97], v6 offset:32768
 v_mfma_f32_16x16x32_bf16 v[112:115], a[116:119], a[4:7], v[112:115]
 ds_read_b64_tr_b16 a[98:99], v6 offset:40960
 v_mfma_f32_16x16x32_bf16 v[116:119], a[116:119], a[12:15], v[116:119]
 ds_read_b64_tr_b16 a[100:101], v6 offset:49152
 v_mfma_f32_16x16x32_bf16 v[116:119], a[112:115], a[8:11], v[116:119]
 ds_read_b64_tr_b16 a[102:103], v6 offset:57344
 s_add_u32 m0, s39, 2048
 v_mfma_f32_16x16x32_bf16 v[120:123], a[112:115], a[16:19], v[120:123]
 buffer_load_dwordx4 v20, s[16:19], s32 offen lds
 v_mfma_f32_16x16x32_bf16 v[120:123], a[116:119], a[20:23], v[120:123]
 s_add_u32 m0, s39, 3072
 v_mfma_f32_16x16x32_bf16 v[124:127], a[116:119], a[28:31], v[124:127]
 buffer_load_dwordx4 v21, s[16:19], s32 offen lds
 v_mfma_f32_16x16x32_bf16 v[124:127], a[112:115], a[24:27], v[124:127]
 s_waitcnt lgkmcnt(4)
 v_mfma_f32_16x16x32_bf16 v[140:143], a[120:123], a[24:27], v[140:143]
 ds_read_b64_tr_b16 a[104:105], v7 offset:32768
 v_mfma_f32_16x16x32_bf16 v[140:143], a[124:127], a[28:31], v[140:143]
 ds_read_b64_tr_b16 a[106:107], v7 offset:40960
 v_mfma_f32_16x16x32_bf16 v[136:139], a[124:127], a[20:23], v[136:139]
 ds_read_b64_tr_b16 a[108:109], v7 offset:49152
 v_mfma_f32_16x16x32_bf16 v[136:139], a[120:123], a[16:19], v[136:139]
 ds_read_b64_tr_b16 a[110:111], v7 offset:57344
 v_mfma_f32_16x16x32_bf16 v[132:135], a[120:123], a[8:11], v[132:135]
 buffer_load_dwordx4 a[132:135], v44, s[20:23], s31 offen offset:3072 sc1
 v_mfma_f32_16x16x32_bf16 v[132:135], a[124:127], a[12:15], v[132:135]
 v_mfma_f32_16x16x32_bf16 v[128:131], a[124:127], a[4:7], v[128:131]
 buffer_load_dwordx4 a[140:143], v45, s[20:23], s31 offen offset:3072 sc1
 v_mfma_f32_16x16x32_bf16 v[128:131], a[120:123], a[0:3], v[128:131]
 s_waitcnt lgkmcnt(4)
 v_mfma_f32_16x16x32_bf16 v[144:147], a[96:99], a[0:3], v[144:147]
 ds_read_b64_tr_b16 a[112:113], v9 offset:32768
 v_mfma_f32_16x16x32_bf16 v[144:147], a[100:103], a[4:7], v[144:147]
 ds_read_b64_tr_b16 a[114:115], v9 offset:40960
 v_mfma_f32_16x16x32_bf16 v[148:151], a[100:103], a[12:15], v[148:151]
 ds_read_b64_tr_b16 a[116:117], v9 offset:49152
 v_mfma_f32_16x16x32_bf16 v[148:151], a[96:99], a[8:11], v[148:151]
 ds_read_b64_tr_b16 a[118:119], v9 offset:57344
 v_mfma_f32_16x16x32_bf16 v[152:155], a[96:99], a[16:19], v[152:155]
 buffer_load_dwordx4 a[136:139], v45, s[20:23], s31 offen offset:2048 sc1
 v_mfma_f32_16x16x32_bf16 v[152:155], a[100:103], a[20:23], v[152:155]
 v_mfma_f32_16x16x32_bf16 v[156:159], a[100:103], a[28:31], v[156:159]
 buffer_load_dwordx4 a[144:147], v46, s[20:23], s31 offen offset:2048 sc1
 v_mfma_f32_16x16x32_bf16 v[156:159], a[96:99], a[24:27], v[156:159]
 s_waitcnt lgkmcnt(4)
 v_mfma_f32_16x16x32_bf16 v[172:175], a[104:107], a[24:27], v[172:175]
 ds_read_b64_tr_b16 a[120:121], v10 offset:32768
 v_mfma_f32_16x16x32_bf16 v[172:175], a[108:111], a[28:31], v[172:175]
 ds_read_b64_tr_b16 a[122:123], v10 offset:40960
 v_mfma_f32_16x16x32_bf16 v[168:171], a[108:111], a[20:23], v[168:171]
 ds_read_b64_tr_b16 a[124:125], v10 offset:49152
 v_mfma_f32_16x16x32_bf16 v[168:171], a[104:107], a[16:19], v[168:171]
 ds_read_b64_tr_b16 a[126:127], v10 offset:57344
 v_mfma_f32_16x16x32_bf16 v[164:167], a[104:107], a[8:11], v[164:167]
 buffer_load_dwordx4 a[148:151], v46, s[20:23], s31 offen offset:3072 sc1
 v_mfma_f32_16x16x32_bf16 v[164:167], a[108:111], a[12:15], v[164:167]
 v_mfma_f32_16x16x32_bf16 v[160:163], a[108:111], a[4:7], v[160:163]
 buffer_load_dwordx4 a[156:159], v47, s[20:23], s31 offen offset:3072 sc1
 v_mfma_f32_16x16x32_bf16 v[160:163], a[104:107], a[0:3], v[160:163]
 s_waitcnt lgkmcnt(4)
 v_mfma_f32_16x16x32_bf16 v[176:179], a[112:115], a[0:3], v[176:179]
 ds_read_b64_tr_b16 a[96:97], v14 offset:36864
 v_mfma_f32_16x16x32_bf16 v[176:179], a[116:119], a[4:7], v[176:179]
 ds_read_b64_tr_b16 a[98:99], v14 offset:45056
 v_mfma_f32_16x16x32_bf16 v[180:183], a[116:119], a[12:15], v[180:183]
 ds_read_b64_tr_b16 a[100:101], v14 offset:53248
 v_mfma_f32_16x16x32_bf16 v[180:183], a[112:115], a[8:11], v[180:183]
 ds_read_b64_tr_b16 a[102:103], v14 offset:61440
 v_mfma_f32_16x16x32_bf16 v[184:187], a[112:115], a[16:19], v[184:187]
 buffer_load_dwordx4 a[152:155], v47, s[20:23], s31 offen offset:2048 sc1
 s_cmp_le_u32 s63, 3
 s_addc_u32 s37, 3, 0
 v_mfma_f32_16x16x32_bf16 v[184:187], a[116:119], a[20:23], v[184:187]
 s_lshl_b32 s31, s37, 12
 v_mfma_f32_16x16x32_bf16 v[188:191], a[116:119], a[28:31], v[188:191]
 buffer_load_dwordx4 a[160:163], v44, s[20:23], s31 offen offset:2048 sc1
 v_mfma_f32_16x16x32_bf16 v[188:191], a[112:115], a[24:27], v[188:191]
 s_waitcnt lgkmcnt(4)
 v_mfma_f32_16x16x32_bf16 v[204:207], a[120:123], a[24:27], v[204:207]
 ds_read_b64_tr_b16 a[104:105], v15 offset:36864
 v_mfma_f32_16x16x32_bf16 v[204:207], a[124:127], a[28:31], v[204:207]
 ds_read_b64_tr_b16 a[106:107], v15 offset:45056
 v_mfma_f32_16x16x32_bf16 v[200:203], a[124:127], a[20:23], v[200:203]
 ds_read_b64_tr_b16 a[108:109], v15 offset:53248
 v_mfma_f32_16x16x32_bf16 v[200:203], a[120:123], a[16:19], v[200:203]
 ds_read_b64_tr_b16 a[110:111], v15 offset:61440
 v_mfma_f32_16x16x32_bf16 v[196:199], a[120:123], a[8:11], v[196:199]
 buffer_load_dwordx4 a[164:167], v44, s[20:23], s31 offen offset:3072 sc1
 v_mfma_f32_16x16x32_bf16 v[196:199], a[124:127], a[12:15], v[196:199]
 v_mfma_f32_16x16x32_bf16 v[192:195], a[124:127], a[4:7], v[192:195]
 v_mfma_f32_16x16x32_bf16 v[192:195], a[120:123], a[0:3], v[192:195]
 s_waitcnt vmcnt(30) lgkmcnt(4)
 v_mfma_f32_16x16x32_bf16 v[80:83], a[96:99], a[32:35], v[80:83]
 ds_read_b64_tr_b16 a[112:113], v4 offset:36864
 s_cmp_le_u32 s63, 6
 s_addc_u32 s33, 6, 0
 v_mfma_f32_16x16x32_bf16 v[80:83], a[100:103], a[36:39], v[80:83]
 ds_read_b64_tr_b16 a[114:115], v4 offset:45056
 s_mul_i32 s33, s33, 229376
 v_mfma_f32_16x16x32_bf16 v[84:87], a[100:103], a[44:47], v[84:87]
 ds_read_b64_tr_b16 a[116:117], v4 offset:53248
 s_add_u32 s32, s33, s59
 v_mfma_f32_16x16x32_bf16 v[84:87], a[96:99], a[40:43], v[84:87]
 ds_read_b64_tr_b16 a[118:119], v4 offset:61440
 s_add_u32 m0, s39, 4096
 s_waitcnt vmcnt(26)
 v_mfma_f32_16x16x32_bf16 v[88:91], a[96:99], a[48:51], v[88:91]
 buffer_load_dwordx4 v20, s[16:19], s32 offen lds
 v_mfma_f32_16x16x32_bf16 v[88:91], a[100:103], a[52:55], v[88:91]
 s_add_u32 m0, s39, 5120
 v_mfma_f32_16x16x32_bf16 v[92:95], a[100:103], a[60:63], v[92:95]
 buffer_load_dwordx4 v21, s[16:19], s32 offen lds
 s_add_u32 s32, s32, 16384
 v_mfma_f32_16x16x32_bf16 v[92:95], a[96:99], a[56:59], v[92:95]
 s_waitcnt lgkmcnt(4)
 v_mfma_f32_16x16x32_bf16 v[108:111], a[104:107], a[56:59], v[108:111]
 ds_read_b64_tr_b16 a[120:121], v5 offset:36864
 v_mfma_f32_16x16x32_bf16 v[108:111], a[108:111], a[60:63], v[108:111]
 ds_read_b64_tr_b16 a[122:123], v5 offset:45056
 v_mfma_f32_16x16x32_bf16 v[104:107], a[108:111], a[52:55], v[104:107]
 ds_read_b64_tr_b16 a[124:125], v5 offset:53248
 v_mfma_f32_16x16x32_bf16 v[104:107], a[104:107], a[48:51], v[104:107]
 ds_read_b64_tr_b16 a[126:127], v5 offset:61440
 s_add_u32 m0, s39, 6144
 v_mfma_f32_16x16x32_bf16 v[100:103], a[104:107], a[40:43], v[100:103]
 buffer_load_dwordx4 v20, s[16:19], s32 offen lds
 v_mfma_f32_16x16x32_bf16 v[100:103], a[108:111], a[44:47], v[100:103]
 v_mfma_f32_16x16x32_bf16 v[96:99], a[108:111], a[36:39], v[96:99]
L_pg12:
 s_cbranch_execz L_main
 v_mfma_f32_16x16x32_bf16 v[96:99], a[104:107], a[32:35], v[96:99]
 s_waitcnt lgkmcnt(4)
 v_mfma_f32_16x16x32_bf16 v[112:115], a[112:115], a[32:35], v[112:115]
 ds_read_b64_tr_b16 a[96:97], v6 offset:36864
 v_mfma_f32_16x16x32_bf16 v[112:115], a[116:119], a[36:39], v[112:115]
 ds_read_b64_tr_b16 a[98:99], v6 offset:45056
 v_mfma_f32_16x16x32_bf16 v[116:119], a[116:119], a[44:47], v[116:119]
 ds_read_b64_tr_b16 a[100:101], v6 offset:53248
 v_mfma_f32_16x16x32_bf16 v[116:119], a[112:115], a[40:43], v[116:119]
 ds_read_b64_tr_b16 a[102:103], v6 offset:61440
 s_add_u32 m0, s39, 7168
 v_mfma_f32_16x16x32_bf16 v[120:123], a[112:115], a[48:51], v[120:123]
 buffer_load_dwordx4 v21, s[16:19], s32 offen lds
 v_mfma_f32_16x16x32_bf16 v[120:123], a[116:119], a[52:55], v[120:123]
 v_mfma_f32_16x16x32_bf16 v[124:127], a[116:119], a[60:63], v[124:127]
 buffer_load_dwordx4 a[172:175], v45, s[20:23], s31 offen offset:3072 sc1
 v_mfma_f32_16x16x32_bf16 v[124:127], a[112:115], a[56:59], v[124:127]
 s_waitcnt lgkmcnt(4)
 v_mfma_f32_16x16x32_bf16 v[140:143], a[120:123], a[56:59], v[140:143]
 ds_read_b64_tr_b16 a[104:105], v7 offset:36864
 v_mfma_f32_16x16x32_bf16 v[140:143], a[124:127], a[60:63], v[140:143]
 ds_read_b64_tr_b16 a[106:107], v7 offset:45056
 v_mfma_f32_16x16x32_bf16 v[136:139], a[124:127], a[52:55], v[136:139]
 ds_read_b64_tr_b16 a[108:109], v7 offset:53248
 v_mfma_f32_16x16x32_bf16 v[136:139], a[120:123], a[48:51], v[136:139]
 ds_read_b64_tr_b16 a[110:111], v7 offset:61440
 v_mfma_f32_16x16x32_bf16 v[132:135], a[120:123], a[40:43], v[132:135]
 buffer_load_dwordx4 a[168:171], v45, s[20:23], s31 offen offset:2048 sc1
 v_mfma_f32_16x16x32_bf16 v[132:135], a[124:127], a[44:47], v[132:135]
 v_mfma_f32_16x16x32_bf16 v[128:131], a[124:127], a[36:39], v[128:131]
 v_mfma_f32_16x16x32_bf16 v[128:131], a[120:123], a[32:35], v[128:131]
 s_waitcnt lgkmcnt(4)
 v_mfma_f32_16x16x32_bf16 v[144:147], a[96:99], a[32:35], v[144:147]
 ds_read_b64_tr_b16 a[112:113], v9 offset:36864
 v_mfma_f32_16x16x32_bf16 v[144:147], a[100:103], a[36:39], v[144:147]
 ds_read_b64_tr_b16 a[114:115], v9 offset:45056
 v_mfma_f32_16x16x32_bf16 v[148:151], a[100:103], a[44:47], v[148:151]
 ds_read_b64_tr_b16 a[116:117], v9 offset:53248
 v_mfma_f32_16x16x32_bf16 v[148:151], a[96:99], a[40:43], v[148:151]
 ds_read_b64_tr_b16 a[118:119], v9 offset:61440
 v_mfma_f32_16x16x32_bf16 v[152:155], a[96:99], a[48:51], v[152:155]
 buffer_load_dwordx4 a[176:179], v46, s[20:23], s31 offen offset:2048 sc1
 v_mfma_f32_16x16x32_bf16 v[152:155], a[100:103], a[52:55], v[152:155]
 v_mfma_f32_16x16x32_bf16 v[156:159], a[100:103], a[60:63], v[156:159]
 buffer_load_dwordx4 a[180:183], v46, s[20:23], s31 offen offset:3072 sc1
 v_mfma_f32_16x16x32_bf16 v[156:159], a[96:99], a[56:59], v[156:159]
 s_waitcnt lgkmcnt(4)
 v_mfma_f32_16x16x32_bf16 v[172:175], a[104:107], a[56:59], v[172:175]
 ds_read_b64_tr_b16 a[120:121], v10 offset:36864
 v_mfma_f32_16x16x32_bf16 v[172:175], a[108:111], a[60:63], v[172:175]
 ds_read_b64_tr_b16 a[122:123], v10 offset:45056
 v_mfma_f32_16x16x32_bf16 v[168:171], a[108:111], a[52:55], v[168:171]
 ds_read_b64_tr_b16 a[124:125], v10 offset:53248
 v_mfma_f32_16x16x32_bf16 v[168:171], a[104:107], a[48:51], v[168:171]
 ds_read_b64_tr_b16 a[126:127], v10 offset:61440
 v_mfma_f32_16x16x32_bf16 v[164:167], a[104:107], a[40:43], v[164:167]
 buffer_load_dwordx4 a[188:191], v47, s[20:23], s31 offen offset:3072 sc1
 v_mfma_f32_16x16x32_bf16 v[164:167], a[108:111], a[44:47], v[164:167]
 v_mfma_f32_16x16x32_bf16 v[160:163], a[108:111], a[36:39], v[160:163]
 v_mfma_f32_16x16x32_bf16 v[160:163], a[104:107], a[32:35], v[160:163]
 s_waitcnt lgkmcnt(4)
 v_mfma_f32_16x16x32_bf16 v[176:179], a[112:115], a[32:35], v[176:179]
 ds_read_b64_tr_b16 a[96:97], v48 offset:0
 v_mfma_f32_16x16x32_bf16 v[176:179], a[116:119], a[36:39], v[176:179]
 ds_read_b64_tr_b16 a[98:99], v48 offset:4096
 v_mfma_f32_16x16x32_bf16 v[180:183], a[116:119], a[44:47], v[180:183]
 ds_read_b64_tr_b16 a[100:101], v48 offset:8192
 v_mfma_f32_16x16x32_bf16 v[180:183], a[112:115], a[40:43], v[180:183]
 ds_read_b64_tr_b16 a[102:103], v48 offset:12288
 v_mfma_f32_16x16x32_bf16 v[184:187], a[112:115], a[48:51], v[184:187]
 buffer_load_dwordx4 a[184:187], v47, s[20:23], s31 offen offset:2048 sc1
 s_cmp_le_u32 s63, 4
 s_addc_u32 s37, 4, 0
 v_mfma_f32_16x16x32_bf16 v[184:187], a[116:119], a[52:55], v[184:187]
 s_lshl_b32 s31, s37, 12
 v_mfma_f32_16x16x32_bf16 v[188:191], a[116:119], a[60:63], v[188:191]
 buffer_load_dwordx4 a[0:3], v44, s[20:23], s31 offen offset:2048 sc1
 v_mfma_f32_16x16x32_bf16 v[188:191], a[112:115], a[56:59], v[188:191]
 s_waitcnt lgkmcnt(4)
 v_mfma_f32_16x16x32_bf16 v[204:207], a[120:123], a[56:59], v[204:207]
 ds_read_b64_tr_b16 a[104:105], v49 offset:0
 v_mfma_f32_16x16x32_bf16 v[204:207], a[124:127], a[60:63], v[204:207]
 ds_read_b64_tr_b16 a[106:107], v49 offset:4096
 v_mfma_f32_16x16x32_bf16 v[200:203], a[124:127], a[52:55], v[200:203]
 ds_read_b64_tr_b16 a[108:109], v49 offset:8192
 v_mfma_f32_16x16x32_bf16 v[200:203], a[120:123], a[48:51], v[200:203]
 ds_read_b64_tr_b16 a[110:111], v49 offset:12288
 v_mfma_f32_16x16x32_bf16 v[196:199], a[120:123], a[40:43], v[196:199]
 buffer_load_dwordx4 a[4:7], v44, s[20:23], s31 offen offset:3072 sc1
 v_mfma_f32_16x16x32_bf16 v[196:199], a[124:127], a[44:47], v[196:199]
 v_mfma_f32_16x16x32_bf16 v[192:195], a[124:127], a[36:39], v[192:195]
 v_mfma_f32_16x16x32_bf16 v[192:195], a[120:123], a[32:35], v[192:195]
 s_waitcnt vmcnt(30) lgkmcnt(4)
 v_mfma_f32_16x16x32_bf16 v[80:83], a[96:99], a[64:67], v[80:83]
 ds_read_b64_tr_b16 a[112:113], v50 offset:0
 v_mfma_f32_16x16x32_bf16 v[80:83], a[100:103], a[68:71], v[80:83]
 ds_read_b64_tr_b16 a[114:115], v50 offset:4096
 v_mfma_f32_16x16x32_bf16 v[84:87], a[100:103], a[76:79], v[84:87]
 ds_read_b64_tr_b16 a[116:117], v50 offset:8192
 v_mfma_f32_16x16x32_bf16 v[84:87], a[96:99], a[72:75], v[84:87]
 ds_read_b64_tr_b16 a[118:119], v50 offset:12288
 s_waitcnt vmcnt(26)
 v_mfma_f32_16x16x32_bf16 v[88:91], a[96:99], a[80:83], v[88:91]
 buffer_load_dwordx4 a[12:15], v45, s[20:23], s31 offen offset:3072 sc1
 v_mfma_f32_16x16x32_bf16 v[88:91], a[100:103], a[84:87], v[88:91]
 v_mfma_f32_16x16x32_bf16 v[92:95], a[100:103], a[92:95], v[92:95]
 buffer_load_dwordx4 a[8:11], v45, s[20:23], s31 offen offset:2048 sc1
 v_mfma_f32_16x16x32_bf16 v[92:95], a[96:99], a[88:91], v[92:95]
 s_waitcnt lgkmcnt(4)
 v_mfma_f32_16x16x32_bf16 v[108:111], a[104:107], a[88:91], v[108:111]
 ds_read_b64_tr_b16 a[120:121], v51 offset:0
 v_mfma_f32_16x16x32_bf16 v[108:111], a[108:111], a[92:95], v[108:111]
 ds_read_b64_tr_b16 a[122:123], v51 offset:4096
 v_mfma_f32_16x16x32_bf16 v[104:107], a[108:111], a[84:87], v[104:107]
 ds_read_b64_tr_b16 a[124:125], v51 offset:8192
 v_mfma_f32_16x16x32_bf16 v[104:107], a[104:107], a[80:83], v[104:107]
 ds_read_b64_tr_b16 a[126:127], v51 offset:12288
 v_mfma_f32_16x16x32_bf16 v[100:103], a[104:107], a[72:75], v[100:103]
 buffer_load_dwordx4 a[16:19], v46, s[20:23], s31 offen offset:2048 sc1
 v_mfma_f32_16x16x32_bf16 v[100:103], a[108:111], a[76:79], v[100:103]
 v_mfma_f32_16x16x32_bf16 v[96:99], a[108:111], a[68:71], v[96:99]
 buffer_load_dwordx4 a[20:23], v46, s[20:23], s31 offen offset:3072 sc1
 v_mfma_f32_16x16x32_bf16 v[96:99], a[104:107], a[64:67], v[96:99]
 s_waitcnt lgkmcnt(4)
 v_mfma_f32_16x16x32_bf16 v[112:115], a[112:115], a[64:67], v[112:115]
 ds_read_b64_tr_b16 a[96:97], v52 offset:0
 v_mfma_f32_16x16x32_bf16 v[112:115], a[116:119], a[68:71], v[112:115]
 ds_read_b64_tr_b16 a[98:99], v52 offset:4096
 v_mfma_f32_16x16x32_bf16 v[116:119], a[116:119], a[76:79], v[116:119]
 ds_read_b64_tr_b16 a[100:101], v52 offset:8192
 v_mfma_f32_16x16x32_bf16 v[116:119], a[112:115], a[72:75], v[116:119]
 ds_read_b64_tr_b16 a[102:103], v52 offset:12288
 v_mfma_f32_16x16x32_bf16 v[120:123], a[112:115], a[80:83], v[120:123]
 buffer_load_dwordx4 a[28:31], v47, s[20:23], s31 offen offset:3072 sc1
 v_mfma_f32_16x16x32_bf16 v[120:123], a[116:119], a[84:87], v[120:123]
 v_mfma_f32_16x16x32_bf16 v[124:127], a[116:119], a[92:95], v[124:127]
 buffer_load_dwordx4 a[24:27], v47, s[20:23], s31 offen offset:2048 sc1
 s_cmp_le_u32 s63, 5
 s_addc_u32 s37, 5, 0
 v_mfma_f32_16x16x32_bf16 v[124:127], a[112:115], a[88:91], v[124:127]
 s_waitcnt lgkmcnt(4)
 v_mfma_f32_16x16x32_bf16 v[140:143], a[120:123], a[88:91], v[140:143]
 ds_read_b64_tr_b16 a[104:105], v53 offset:0
 v_mfma_f32_16x16x32_bf16 v[140:143], a[124:127], a[92:95], v[140:143]
 ds_read_b64_tr_b16 a[106:107], v53 offset:4096
 v_mfma_f32_16x16x32_bf16 v[136:139], a[124:127], a[84:87], v[136:139]
 ds_read_b64_tr_b16 a[108:109], v53 offset:8192
 v_mfma_f32_16x16x32_bf16 v[136:139], a[120:123], a[80:83], v[136:139]
 ds_read_b64_tr_b16 a[110:111], v53 offset:12288
 s_lshl_b32 s31, s37, 12
 v_mfma_f32_16x16x32_bf16 v[132:135], a[120:123], a[72:75], v[132:135]
 buffer_load_dwordx4 a[32:35], v44, s[20:23], s31 offen offset:2048 sc1
 v_mfma_f32_16x16x32_bf16 v[132:135], a[124:127], a[76:79], v[132:135]
 v_mfma_f32_16x16x32_bf16 v[128:131], a[124:127], a[68:71], v[128:131]
 v_mfma_f32_16x16x32_bf16 v[128:131], a[120:123], a[64:67], v[128:131]
 s_waitcnt lgkmcnt(4)
 v_mfma_f32_16x16x32_bf16 v[144:147], a[96:99], a[64:67], v[144:147]
 ds_read_b64_tr_b16 a[112:113], v54 offset:0
 v_mfma_f32_16x16x32_bf16 v[144:147], a[100:103], a[68:71], v[144:147]
 ds_read_b64_tr_b16 a[114:115], v54 offset:4096
 v_mfma_f32_16x16x32_bf16 v[148:151], a[100:103], a[76:79], v[148:151]
 ds_read_b64_tr_b16 a[116:117], v54 offset:8192
 v_mfma_f32_16x16x32_bf16 v[148:151], a[96:99], a[72:75], v[148:151]
 ds_read_b64_tr_b16 a[118:119], v54 offset:12288
 v_mfma_f32_16x16x32_bf16 v[152:155], a[96:99], a[80:83], v[152:155]
 buffer_load_dwordx4 a[36:39], v44, s[20:23], s31 offen offset:3072 sc1
 v_mfma_f32_16x16x32_bf16 v[152:155], a[100:103], a[84:87], v[152:155]
 v_mfma_f32_16x16x32_bf16 v[156:159], a[100:103], a[92:95], v[156:159]
 buffer_load_dwordx4 a[44:47], v45, s[20:23], s31 offen offset:3072 sc1
 v_mfma_f32_16x16x32_bf16 v[156:159], a[96:99], a[88:91], v[156:159]
 s_waitcnt lgkmcnt(4)
 v_mfma_f32_16x16x32_bf16 v[172:175], a[104:107], a[88:91], v[172:175]
 ds_read_b64_tr_b16 a[120:121], v55 offset:0
 v_mfma_f32_16x16x32_bf16 v[172:175], a[108:111], a[92:95], v[172:175]
 ds_read_b64_tr_b16 a[122:123], v55 offset:4096
 v_mfma_f32_16x16x32_bf16 v[168:171], a[108:111], a[84:87], v[168:171]
 ds_read_b64_tr_b16 a[124:125], v55 offset:8192
 v_mfma_f32_16x16x32_bf16 v[168:171], a[104:107], a[80:83], v[168:171]
 ds_read_b64_tr_b16 a[126:127], v55 offset:12288
 v_mfma_f32_16x16x32_bf16 v[164:167], a[104:107], a[72:75], v[164:167]
 buffer_load_dwordx4 a[40:43], v45, s[20:23], s31 offen offset:2048 sc1
 v_mfma_f32_16x16x32_bf16 v[164:167], a[108:111], a[76:79], v[164:167]
 v_mfma_f32_16x16x32_bf16 v[160:163], a[108:111], a[68:71], v[160:163]
 buffer_load_dwordx4 a[48:51], v46, s[20:23], s31 offen offset:2048 sc1
 v_mfma_f32_16x16x32_bf16 v[160:163], a[104:107], a[64:67], v[160:163]
 s_waitcnt lgkmcnt(4)
 v_mfma_f32_16x16x32_bf16 v[176:179], a[112:115], a[64:67], v[176:179]
 ds_read_b64_tr_b16 a[96:97], v48 offset:16384
 v_mfma_f32_16x16x32_bf16 v[176:179], a[116:119], a[68:71], v[176:179]
 ds_read_b64_tr_b16 a[98:99], v48 offset:20480
 v_mfma_f32_16x16x32_bf16 v[180:183], a[116:119], a[76:79], v[180:183]
 ds_read_b64_tr_b16 a[100:101], v48 offset:24576
 v_mfma_f32_16x16x32_bf16 v[180:183], a[112:115], a[72:75], v[180:183]
 ds_read_b64_tr_b16 a[102:103], v48 offset:28672
 v_mfma_f32_16x16x32_bf16 v[184:187], a[112:115], a[80:83], v[184:187]
 buffer_load_dwordx4 a[52:55], v46, s[20:23], s31 offen offset:3072 sc1
 v_mfma_f32_16x16x32_bf16 v[184:187], a[116:119], a[84:87], v[184:187]
 v_mfma_f32_16x16x32_bf16 v[188:191], a[116:119], a[92:95], v[188:191]
 buffer_load_dwordx4 a[60:63], v47, s[20:23], s31 offen offset:3072 sc1
 v_mfma_f32_16x16x32_bf16 v[188:191], a[112:115], a[88:91], v[188:191]
 s_waitcnt lgkmcnt(4)
 v_mfma_f32_16x16x32_bf16 v[204:207], a[120:123], a[88:91], v[204:207]
 ds_read_b64_tr_b16 a[104:105], v49 offset:16384
 v_mfma_f32_16x16x32_bf16 v[204:207], a[124:127], a[92:95], v[204:207]
 ds_read_b64_tr_b16 a[106:107], v49 offset:20480
 v_mfma_f32_16x16x32_bf16 v[200:203], a[124:127], a[84:87], v[200:203]
 ds_read_b64_tr_b16 a[108:109], v49 offset:24576
 v_mfma_f32_16x16x32_bf16 v[200:203], a[120:123], a[80:83], v[200:203]
 ds_read_b64_tr_b16 a[110:111], v49 offset:28672
 v_mfma_f32_16x16x32_bf16 v[196:199], a[120:123], a[72:75], v[196:199]
 buffer_load_dwordx4 a[56:59], v47, s[20:23], s31 offen offset:2048 sc1
 v_mfma_f32_16x16x32_bf16 v[196:199], a[124:127], a[76:79], v[196:199]
 v_mfma_f32_16x16x32_bf16 v[192:195], a[124:127], a[68:71], v[192:195]
 v_mfma_f32_16x16x32_bf16 v[192:195], a[120:123], a[64:67], v[192:195]
 s_waitcnt vmcnt(32) lgkmcnt(4)
 v_mfma_f32_16x16x32_bf16 v[80:83], a[96:99], a[128:131], v[80:83]
 ds_read_b64_tr_b16 a[112:113], v48 offset:32768
 s_cmp_le_u32 s63, 6
 s_addc_u32 s37, 6, 0
 v_mfma_f32_16x16x32_bf16 v[80:83], a[100:103], a[132:135], v[80:83]
 ds_read_b64_tr_b16 a[114:115], v48 offset:36864
 v_mfma_f32_16x16x32_bf16 v[84:87], a[100:103], a[140:143], v[84:87]
 ds_read_b64_tr_b16 a[116:117], v48 offset:40960
 v_mfma_f32_16x16x32_bf16 v[84:87], a[96:99], a[136:139], v[84:87]
 ds_read_b64_tr_b16 a[118:119], v48 offset:45056
 s_lshl_b32 s31, s37, 12
 s_waitcnt vmcnt(28)
 v_mfma_f32_16x16x32_bf16 v[88:91], a[96:99], a[144:147], v[88:91]
 buffer_load_dwordx4 a[64:67], v44, s[20:23], s31 offen offset:2048 sc1
 v_mfma_f32_16x16x32_bf16 v[88:91], a[100:103], a[148:151], v[88:91]
 s_waitcnt vmcnt(23)
 s_barrier
 v_mfma_f32_16x16x32_bf16 v[92:95], a[100:103], a[156:159], v[92:95]
 buffer_load_dwordx4 a[68:71], v44, s[20:23], s31 offen offset:3072 sc1
 v_accvgpr_read_b32 v39, a192
 v_mfma_f32_16x16x32_bf16 v[92:95], a[96:99], a[152:155], v[92:95]
 s_waitcnt lgkmcnt(4)
 v_lshlrev_b32 v38, 16, v39
 v_mfma_f32_16x16x32_bf16 v[108:111], a[104:107], a[152:155], v[108:111]
 ds_read_b64_tr_b16 a[120:121], v49 offset:32768
 v_and_b32 v39, 0xffff0000, v39
 v_mfma_f32_16x16x32_bf16 v[108:111], a[108:111], a[156:159], v[108:111]
 ds_read_b64_tr_b16 a[122:123], v49 offset:36864
 v_add_f32 v38, v38, v68
 v_mfma_f32_16x16x32_bf16 v[104:107], a[108:111], a[148:151], v[104:107]
 ds_read_b64_tr_b16 a[124:125], v49 offset:40960
 v_add_f32 v39, v39, v69
 v_mfma_f32_16x16x32_bf16 v[104:107], a[104:107], a[144:147], v[104:107]
 ds_read_b64_tr_b16 a[126:127], v49 offset:45056
 v_add_f32 v176, v176, v38
 v_mfma_f32_16x16x32_bf16 v[100:103], a[104:107], a[136:139], v[100:103]
 buffer_load_dwordx4 a[76:79], v45, s[20:23], s31 offen offset:3072 sc1
 v_add_f32 v177, v177, v39
 v_mfma_f32_16x16x32_bf16 v[100:103], a[108:111], a[140:143], v[100:103]
 v_accvgpr_read_b32 v39, a193
 v_mfma_f32_16x16x32_bf16 v[96:99], a[108:111], a[132:135], v[96:99]
 buffer_load_dwordx4 a[72:75], v45, s[20:23], s31 offen offset:2048 sc1
 v_lshlrev_b32 v38, 16, v39
 v_mfma_f32_16x16x32_bf16 v[96:99], a[104:107], a[128:131], v[96:99]
 s_waitcnt vmcnt(24) lgkmcnt(4)
 v_and_b32 v39, 0xffff0000, v39
 v_mfma_f32_16x16x32_bf16 v[80:83], a[112:115], a[160:163], v[80:83]
 ds_read_b64_tr_b16 a[96:97], v48 offset:49152
 v_add_f32 v38, v38, v70
 v_mfma_f32_16x16x32_bf16 v[80:83], a[116:119], a[164:167], v[80:83]
 ds_read_b64_tr_b16 a[98:99], v48 offset:53248
 v_add_f32 v39, v39, v71
 v_mfma_f32_16x16x32_bf16 v[84:87], a[116:119], a[172:175], v[84:87]
 ds_read_b64_tr_b16 a[100:101], v48 offset:57344
 v_add_f32 v178, v178, v38
 v_mfma_f32_16x16x32_bf16 v[84:87], a[112:115], a[168:171], v[84:87]
 ds_read_b64_tr_b16 a[102:103], v48 offset:61440
 s_waitcnt vmcnt(20)
 v_add_f32 v179, v179, v39
 v_mfma_f32_16x16x32_bf16 v[88:91], a[112:115], a[176:179], v[88:91]
 buffer_load_dwordx4 a[80:83], v46, s[20:23], s31 offen offset:2048 sc1
 v_accvgpr_read_b32 v39, a194
 v_mfma_f32_16x16x32_bf16 v[88:91], a[116:119], a[180:183], v[88:91]
 v_lshlrev_b32 v38, 16, v39
 v_mfma_f32_16x16x32_bf16 v[92:95], a[116:119], a[188:191], v[92:95]
 buffer_load_dwordx4 a[84:87], v46, s[20:23], s31 offen offset:3072 sc1
 v_and_b32 v39, 0xffff0000, v39
 v_mfma_f32_16x16x32_bf16 v[92:95], a[112:115], a[184:187], v[92:95]
 s_waitcnt lgkmcnt(4)
 v_add_f32 v38, v38, v72
 v_mfma_f32_16x16x32_bf16 v[108:111], a[120:123], a[184:187], v[108:111]
 ds_read_b64_tr_b16 a[104:105], v49 offset:49152
 v_add_f32 v39, v39, v73
 v_mfma_f32_16x16x32_bf16 v[108:111], a[124:127], a[188:191], v[108:111]
 ds_read_b64_tr_b16 a[106:107], v49 offset:53248
 v_add_f32 v192, v192, v38
 v_mfma_f32_16x16x32_bf16 v[104:107], a[124:127], a[180:183], v[104:107]
 ds_read_b64_tr_b16 a[108:109], v49 offset:57344
 v_add_f32 v193, v193, v39
 v_mfma_f32_16x16x32_bf16 v[104:107], a[120:123], a[176:179], v[104:107]
 ds_read_b64_tr_b16 a[110:111], v49 offset:61440
 v_accvgpr_read_b32 v39, a195
 v_mfma_f32_16x16x32_bf16 v[100:103], a[120:123], a[168:171], v[100:103]
 buffer_load_dwordx4 a[92:95], v47, s[20:23], s31 offen offset:3072 sc1
 v_lshlrev_b32 v38, 16, v39
 v_mfma_f32_16x16x32_bf16 v[100:103], a[124:127], a[172:175], v[100:103]
 v_and_b32 v39, 0xffff0000, v39
 v_mfma_f32_16x16x32_bf16 v[96:99], a[124:127], a[164:167], v[96:99]
 buffer_load_dwordx4 a[88:91], v47, s[20:23], s31 offen offset:2048 sc1
 v_add_f32 v38, v38, v74
 v_mfma_f32_16x16x32_bf16 v[96:99], a[120:123], a[160:163], v[96:99]
 s_waitcnt vmcnt(20) lgkmcnt(4)
 v_add_f32 v39, v39, v75
 v_mfma_f32_16x16x32_bf16 v[80:83], a[96:99], a[0:3], v[80:83]
 ds_read_b64_tr_b16 a[112:113], v14 offset:0
 v_add_f32 v194, v194, v38
 v_mfma_f32_16x16x32_bf16 v[80:83], a[100:103], a[4:7], v[80:83]
 ds_read_b64_tr_b16 a[114:115], v14 offset:8192
 v_add_f32 v195, v195, v39
 v_mfma_f32_16x16x32_bf16 v[84:87], a[100:103], a[12:15], v[84:87]
 ds_read_b64_tr_b16 a[116:117], v14 offset:16384
 v_accvgpr_read_b32 v39, a196
 v_mfma_f32_16x16x32_bf16 v[84:87], a[96:99], a[8:11], v[84:87]
 ds_read_b64_tr_b16 a[118:119], v14 offset:24576
 s_waitcnt vmcnt(16)
 v_lshlrev_b32 v38, 16, v39
 v_mfma_f32_16x16x32_bf16 v[88:91], a[96:99], a[16:19], v[88:91]
 v_and_b32 v39, 0xffff0000, v39
 v_mfma_f32_16x16x32_bf16 v[88:91], a[100:103], a[20:23], v[88:91]
 v_add_f32 v38, v38, v68
 v_mfma_f32_16x16x32_bf16 v[92:95], a[100:103], a[28:31], v[92:95]
 v_add_f32 v39, v39, v69
 v_mfma_f32_16x16x32_bf16 v[92:95], a[96:99], a[24:27], v[92:95]
 s_waitcnt lgkmcnt(4)
 v_add_f32 v180, v180, v38
 v_mfma_f32_16x16x32_bf16 v[108:111], a[104:107], a[24:27], v[108:111]
 ds_read_b64_tr_b16 a[120:121], v15 offset:0
 v_add_f32 v181, v181, v39
 v_mfma_f32_16x16x32_bf16 v[108:111], a[108:111], a[28:31], v[108:111]
 ds_read_b64_tr_b16 a[122:123], v15 offset:8192
 v_accvgpr_read_b32 v39, a197
 v_mfma_f32_16x16x32_bf16 v[104:107], a[108:111], a[20:23], v[104:107]
 ds_read_b64_tr_b16 a[124:125], v15 offset:16384
 v_lshlrev_b32 v38, 16, v39
 v_mfma_f32_16x16x32_bf16 v[104:107], a[104:107], a[16:19], v[104:107]
 ds_read_b64_tr_b16 a[126:127], v15 offset:24576
 v_and_b32 v39, 0xffff0000, v39
 v_mfma_f32_16x16x32_bf16 v[100:103], a[104:107], a[8:11], v[100:103]
 v_add_f32 v38, v38, v70
 v_mfma_f32_16x16x32_bf16 v[100:103], a[108:111], a[12:15], v[100:103]
 v_add_f32 v39, v39, v71
 v_mfma_f32_16x16x32_bf16 v[96:99], a[108:111], a[4:7], v[96:99]
 v_add_f32 v182, v182, v38
 v_mfma_f32_16x16x32_bf16 v[96:99], a[104:107], a[0:3], v[96:99]
 s_waitcnt vmcnt(12) lgkmcnt(4)
 v_add_f32 v183, v183, v39
 v_mfma_f32_16x16x32_bf16 v[80:83], a[112:115], a[32:35], v[80:83]
 ds_read_b64_tr_b16 a[96:97], v14 offset:4096
 v_accvgpr_read_b32 v39, a198
 v_mfma_f32_16x16x32_bf16 v[80:83], a[116:119], a[36:39], v[80:83]
 ds_read_b64_tr_b16 a[98:99], v14 offset:12288
 v_lshlrev_b32 v38, 16, v39
 v_mfma_f32_16x16x32_bf16 v[84:87], a[116:119], a[44:47], v[84:87]
 ds_read_b64_tr_b16 a[100:101], v14 offset:20480
 v_and_b32 v39, 0xffff0000, v39
 v_mfma_f32_16x16x32_bf16 v[84:87], a[112:115], a[40:43], v[84:87]
 ds_read_b64_tr_b16 a[102:103], v14 offset:28672
 s_waitcnt vmcnt(8)
 v_add_f32 v38, v38, v72
 v_mfma_f32_16x16x32_bf16 v[88:91], a[112:115], a[48:51], v[88:91]
 v_add_f32 v39, v39, v73
 v_mfma_f32_16x16x32_bf16 v[88:91], a[116:119], a[52:55], v[88:91]
 v_add_f32 v196, v196, v38
 v_mfma_f32_16x16x32_bf16 v[92:95], a[116:119], a[60:63], v[92:95]
 v_add_f32 v197, v197, v39
 v_mfma_f32_16x16x32_bf16 v[92:95], a[112:115], a[56:59], v[92:95]
 s_waitcnt lgkmcnt(4)
 v_accvgpr_read_b32 v39, a199
 v_mfma_f32_16x16x32_bf16 v[108:111], a[120:123], a[56:59], v[108:111]
 ds_read_b64_tr_b16 a[104:105], v15 offset:4096
 v_lshlrev_b32 v38, 16, v39
 v_mfma_f32_16x16x32_bf16 v[108:111], a[124:127], a[60:63], v[108:111]
 ds_read_b64_tr_b16 a[106:107], v15 offset:12288
 v_and_b32 v39, 0xffff0000, v39
 v_mfma_f32_16x16x32_bf16 v[104:107], a[124:127], a[52:55], v[104:107]
 ds_read_b64_tr_b16 a[108:109], v15 offset:20480
 v_add_f32 v38, v38, v74
 v_mfma_f32_16x16x32_bf16 v[104:107], a[120:123], a[48:51], v[104:107]
 ds_read_b64_tr_b16 a[110:111], v15 offset:28672
 v_add_f32 v39, v39, v75
 v_mfma_f32_16x16x32_bf16 v[100:103], a[120:123], a[40:43], v[100:103]
 v_add_f32 v198, v198, v38
 v_mfma_f32_16x16x32_bf16 v[100:103], a[124:127], a[44:47], v[100:103]
 v_add_f32 v199, v199, v39
 v_mfma_f32_16x16x32_bf16 v[96:99], a[124:127], a[36:39], v[96:99]
 v_accvgpr_read_b32 v39, a200
 v_mfma_f32_16x16x32_bf16 v[96:99], a[120:123], a[32:35], v[96:99]
 s_waitcnt vmcnt(4) lgkmcnt(4)
 v_lshlrev_b32 v38, 16, v39
 v_mfma_f32_16x16x32_bf16 v[80:83], a[96:99], a[64:67], v[80:83]
 ds_read_b64_tr_b16 a[112:113], v50 offset:16384
 v_and_b32 v39, 0xffff0000, v39
 v_mfma_f32_16x16x32_bf16 v[80:83], a[100:103], a[68:71], v[80:83]
 ds_read_b64_tr_b16 a[114:115], v50 offset:20480
 v_add_f32 v38, v38, v68
 v_mfma_f32_16x16x32_bf16 v[84:87], a[100:103], a[76:79], v[84:87]
 ds_read_b64_tr_b16 a[116:117], v50 offset:24576
 v_add_f32 v39, v39, v69
 v_mfma_f32_16x16x32_bf16 v[84:87], a[96:99], a[72:75], v[84:87]
 ds_read_b64_tr_b16 a[118:119], v50 offset:28672
 s_waitcnt vmcnt(0)
 v_add_f32 v184, v184, v38
 v_mfma_f32_16x16x32_bf16 v[88:91], a[96:99], a[80:83], v[88:91]
 v_add_f32 v185, v185, v39
 v_mfma_f32_16x16x32_bf16 v[88:91], a[100:103], a[84:87], v[88:91]
 v_accvgpr_read_b32 v39, a201
 v_mfma_f32_16x16x32_bf16 v[92:95], a[100:103], a[92:95], v[92:95]
 v_lshlrev_b32 v38, 16, v39
 v_mfma_f32_16x16x32_bf16 v[92:95], a[96:99], a[88:91], v[92:95]
 s_waitcnt lgkmcnt(4)
 v_and_b32 v39, 0xffff0000, v39
 v_mfma_f32_16x16x32_bf16 v[108:111], a[104:107], a[88:91], v[108:111]
 ds_read_b64_tr_b16 a[120:121], v51 offset:16384
 v_add_f32 v38, v38, v70
 v_mfma_f32_16x16x32_bf16 v[108:111], a[108:111], a[92:95], v[108:111]
 ds_read_b64_tr_b16 a[122:123], v51 offset:20480
 v_add_f32 v39, v39, v71
 v_mfma_f32_16x16x32_bf16 v[104:107], a[108:111], a[84:87], v[104:107]
 ds_read_b64_tr_b16 a[124:125], v51 offset:24576
 v_add_f32 v186, v186, v38
 v_mfma_f32_16x16x32_bf16 v[104:107], a[104:107], a[80:83], v[104:107]
 ds_read_b64_tr_b16 a[126:127], v51 offset:28672
 v_add_f32 v187, v187, v39
 v_mfma_f32_16x16x32_bf16 v[100:103], a[104:107], a[72:75], v[100:103]
 v_accvgpr_read_b32 v39, a202
 v_mfma_f32_16x16x32_bf16 v[100:103], a[108:111], a[76:79], v[100:103]
 v_lshlrev_b32 v38, 16, v39
 v_mfma_f32_16x16x32_bf16 v[96:99], a[108:111], a[68:71], v[96:99]
 v_and_b32 v39, 0xffff0000, v39
 v_mfma_f32_16x16x32_bf16 v[96:99], a[104:107], a[64:67], v[96:99]
 s_waitcnt lgkmcnt(4)
 v_add_f32 v38, v38, v72
 v_mfma_f32_16x16x32_bf16 v[112:115], a[112:115], a[128:131], v[112:115]
 ds_read_b64_tr_b16 a[96:97], v50 offset:32768
 v_cvt_pk_bf16_f32 v92, v92, v93
 v_mfma_f32_16x16x32_bf16 v[112:115], a[116:119], a[132:135], v[112:115]
 ds_read_b64_tr_b16 a[98:99], v50 offset:36864
 v_cvt_pk_bf16_f32 v93, v94, v95
 v_mfma_f32_16x16x32_bf16 v[116:119], a[116:119], a[140:143], v[116:119]
 ds_read_b64_tr_b16 a[100:101], v50 offset:40960
 v_cvt_pk_bf16_f32 v94, v108, v109
 v_mfma_f32_16x16x32_bf16 v[116:119], a[112:115], a[136:139], v[116:119]
 ds_read_b64_tr_b16 a[102:103], v50 offset:45056
 v_cvt_pk_bf16_f32 v95, v110, v111
 v_mfma_f32_16x16x32_bf16 v[120:123], a[112:115], a[144:147], v[120:123]
 buffer_store_dwordx4 v[92:95], v8, s[20:23], s4 offen offset:3072 sc1
 v_cvt_pk_bf16_f32 v88, v88, v89
 v_mfma_f32_16x16x32_bf16 v[120:123], a[116:119], a[148:151], v[120:123]
 v_cvt_pk_bf16_f32 v89, v90, v91
 v_cvt_pk_bf16_f32 v90, v104, v105
 v_mfma_f32_16x16x32_bf16 v[124:127], a[116:119], a[156:159], v[124:127]
 v_cvt_pk_bf16_f32 v91, v106, v107
 v_cvt_pk_bf16_f32 v84, v84, v85
 v_mfma_f32_16x16x32_bf16 v[124:127], a[112:115], a[152:155], v[124:127]
 buffer_store_dwordx4 v[88:91], v8, s[20:23], s4 offen offset:2048 sc1
 s_waitcnt lgkmcnt(4)
 v_mfma_f32_16x16x32_bf16 v[140:143], a[120:123], a[152:155], v[140:143]
 ds_read_b64_tr_b16 a[104:105], v51 offset:32768
 v_cvt_pk_bf16_f32 v85, v86, v87
 v_mfma_f32_16x16x32_bf16 v[140:143], a[124:127], a[156:159], v[140:143]
 ds_read_b64_tr_b16 a[106:107], v51 offset:36864
 v_cvt_pk_bf16_f32 v86, v100, v101
 v_mfma_f32_16x16x32_bf16 v[136:139], a[124:127], a[148:151], v[136:139]
 ds_read_b64_tr_b16 a[108:109], v51 offset:40960
 v_cvt_pk_bf16_f32 v87, v102, v103
 v_mfma_f32_16x16x32_bf16 v[136:139], a[120:123], a[144:147], v[136:139]
 ds_read_b64_tr_b16 a[110:111], v51 offset:45056
 v_cvt_pk_bf16_f32 v80, v80, v81
 v_mfma_f32_16x16x32_bf16 v[132:135], a[120:123], a[136:139], v[132:135]
 buffer_store_dwordx4 v[84:87], v8, s[20:23], s4 offen offset:1024 sc1
 v_cvt_pk_bf16_f32 v81, v82, v83
 v_mfma_f32_16x16x32_bf16 v[132:135], a[124:127], a[140:143], v[132:135]
 v_cvt_pk_bf16_f32 v82, v96, v97
 v_cvt_pk_bf16_f32 v83, v98, v99
 v_mfma_f32_16x16x32_bf16 v[128:131], a[124:127], a[132:135], v[128:131]
 buffer_store_dwordx4 v[80:83], v8, s[20:23], s4 offen offset:0 sc1
 v_add_f32 v39, v39, v73
 v_mfma_f32_16x16x32_bf16 v[128:131], a[120:123], a[128:131], v[128:131]
 s_waitcnt lgkmcnt(4)
 v_add_f32 v200, v200, v38
 v_mfma_f32_16x16x32_bf16 v[112:115], a[96:99], a[160:163], v[112:115]
 ds_read_b64_tr_b16 a[112:113], v50 offset:49152
 v_add_f32 v201, v201, v39
 v_mfma_f32_16x16x32_bf16 v[112:115], a[100:103], a[164:167], v[112:115]
 ds_read_b64_tr_b16 a[114:115], v50 offset:53248
 v_accvgpr_read_b32 v39, a203
 v_mfma_f32_16x16x32_bf16 v[116:119], a[100:103], a[172:175], v[116:119]
 ds_read_b64_tr_b16 a[116:117], v50 offset:57344
 v_lshlrev_b32 v38, 16, v39
 v_mfma_f32_16x16x32_bf16 v[116:119], a[96:99], a[168:171], v[116:119]
 ds_read_b64_tr_b16 a[118:119], v50 offset:61440
 v_and_b32 v39, 0xffff0000, v39
 v_mfma_f32_16x16x32_bf16 v[120:123], a[96:99], a[176:179], v[120:123]
 v_add_f32 v38, v38, v74
 v_mfma_f32_16x16x32_bf16 v[120:123], a[100:103], a[180:183], v[120:123]
 v_add_f32 v39, v39, v75
 v_mfma_f32_16x16x32_bf16 v[124:127], a[100:103], a[188:191], v[124:127]
 v_add_f32 v202, v202, v38
 v_mfma_f32_16x16x32_bf16 v[124:127], a[96:99], a[184:187], v[124:127]
 s_waitcnt lgkmcnt(4)
 v_add_f32 v203, v203, v39
 v_mfma_f32_16x16x32_bf16 v[140:143], a[104:107], a[184:187], v[140:143]
 ds_read_b64_tr_b16 a[120:121], v51 offset:49152
 v_accvgpr_read_b32 v39, a204
 v_mfma_f32_16x16x32_bf16 v[140:143], a[108:111], a[188:191], v[140:143]
 ds_read_b64_tr_b16 a[122:123], v51 offset:53248
 v_lshlrev_b32 v38, 16, v39
 v_mfma_f32_16x16x32_bf16 v[136:139], a[108:111], a[180:183], v[136:139]
 ds_read_b64_tr_b16 a[124:125], v51 offset:57344
 v_and_b32 v39, 0xffff0000, v39
 v_mfma_f32_16x16x32_bf16 v[136:139], a[104:107], a[176:179], v[136:139]
 ds_read_b64_tr_b16 a[126:127], v51 offset:61440
 v_add_f32 v38, v38, v68
 v_mfma_f32_16x16x32_bf16 v[132:135], a[104:107], a[168:171], v[132:135]
 v_add_f32 v39, v39, v69
 v_mfma_f32_16x16x32_bf16 v[132:135], a[108:111], a[172:175], v[132:135]
 v_add_f32 v188, v188, v38
 v_mfma_f32_16x16x32_bf16 v[128:131], a[108:111], a[164:167], v[128:131]
 v_add_f32 v189, v189, v39
 v_mfma_f32_16x16x32_bf16 v[128:131], a[104:107], a[160:163], v[128:131]
 s_waitcnt lgkmcnt(4)
 v_accvgpr_read_b32 v39, a205
 v_mfma_f32_16x16x32_bf16 v[112:115], a[112:115], a[0:3], v[112:115]
 ds_read_b64_tr_b16 a[96:97], v4 offset:0
 v_lshlrev_b32 v38, 16, v39
 v_mfma_f32_16x16x32_bf16 v[112:115], a[116:119], a[4:7], v[112:115]
 ds_read_b64_tr_b16 a[98:99], v4 offset:8192
 v_and_b32 v39, 0xffff0000, v39
 v_mfma_f32_16x16x32_bf16 v[116:119], a[116:119], a[12:15], v[116:119]
 ds_read_b64_tr_b16 a[100:101], v4 offset:16384
 v_add_f32 v38, v38, v70
 v_mfma_f32_16x16x32_bf16 v[116:119], a[112:115], a[8:11], v[116:119]
 ds_read_b64_tr_b16 a[102:103], v4 offset:24576
 v_add_f32 v39, v39, v71
 v_mfma_f32_16x16x32_bf16 v[120:123], a[112:115], a[16:19], v[120:123]
 v_add_f32 v190, v190, v38
 v_mfma_f32_16x16x32_bf16 v[120:123], a[116:119], a[20:23], v[120:123]
 v_add_f32 v191, v191, v39
 v_mfma_f32_16x16x32_bf16 v[124:127], a[116:119], a[28:31], v[124:127]
 v_accvgpr_read_b32 v39, a206
 v_mfma_f32_16x16x32_bf16 v[124:127], a[112:115], a[24:27], v[124:127]
 s_waitcnt lgkmcnt(4)
 v_lshlrev_b32 v38, 16, v39
 v_mfma_f32_16x16x32_bf16 v[140:143], a[120:123], a[24:27], v[140:143]
 ds_read_b64_tr_b16 a[104:105], v5 offset:0
 v_and_b32 v39, 0xffff0000, v39
 v_mfma_f32_16x16x32_bf16 v[140:143], a[124:127], a[28:31], v[140:143]
 ds_read_b64_tr_b16 a[106:107], v5 offset:8192
 v_add_f32 v38, v38, v72
 v_mfma_f32_16x16x32_bf16 v[136:139], a[124:127], a[20:23], v[136:139]
 ds_read_b64_tr_b16 a[108:109], v5 offset:16384
 v_add_f32 v39, v39, v73
 v_mfma_f32_16x16x32_bf16 v[136:139], a[120:123], a[16:19], v[136:139]
 ds_read_b64_tr_b16 a[110:111], v5 offset:24576
 v_add_f32 v204, v204, v38
 v_mfma_f32_16x16x32_bf16 v[132:135], a[120:123], a[8:11], v[132:135]
 v_add_f32 v205, v205, v39
 v_mfma_f32_16x16x32_bf16 v[132:135], a[124:127], a[12:15], v[132:135]
 v_accvgpr_read_b32 v39, a207
 v_mfma_f32_16x16x32_bf16 v[128:131], a[124:127], a[4:7], v[128:131]
 v_lshlrev_b32 v38, 16, v39
 v_mfma_f32_16x16x32_bf16 v[128:131], a[120:123], a[0:3], v[128:131]
 s_waitcnt lgkmcnt(4)
 v_mfma_f32_16x16x32_bf16 v[112:115], a[96:99], a[32:35], v[112:115]
 ds_read_b64_tr_b16 a[112:113], v4 offset:4096
 v_and_b32 v39, 0xffff0000, v39
 v_mfma_f32_16x16x32_bf16 v[112:115], a[100:103], a[36:39], v[112:115]
 ds_read_b64_tr_b16 a[114:115], v4 offset:12288
 v_add_f32 v38, v38, v74
 v_mfma_f32_16x16x32_bf16 v[116:119], a[100:103], a[44:47], v[116:119]
 ds_read_b64_tr_b16 a[116:117], v4 offset:20480
 v_add_f32 v39, v39, v75
 v_mfma_f32_16x16x32_bf16 v[116:119], a[96:99], a[40:43], v[116:119]
 ds_read_b64_tr_b16 a[118:119], v4 offset:28672
 v_add_f32 v206, v206, v38
 v_mfma_f32_16x16x32_bf16 v[120:123], a[96:99], a[48:51], v[120:123]
 v_add_f32 v207, v207, v39
 v_mfma_f32_16x16x32_bf16 v[120:123], a[100:103], a[52:55], v[120:123]
L_pg13:
 s_cbranch_execz L_main
 v_mfma_f32_16x16x32_bf16 v[124:127], a[100:103], a[60:63], v[124:127]
 v_mfma_f32_16x16x32_bf16 v[124:127], a[96:99], a[56:59], v[124:127]
 s_waitcnt lgkmcnt(4)
 v_mfma_f32_16x16x32_bf16 v[140:143], a[104:107], a[56:59], v[140:143]
 ds_read_b64_tr_b16 a[120:121], v5 offset:4096
 v_mfma_f32_16x16x32_bf16 v[140:143], a[108:111], a[60:63], v[140:143]
 ds_read_b64_tr_b16 a[122:123], v5 offset:12288
 v_mfma_f32_16x16x32_bf16 v[136:139], a[108:111], a[52:55], v[136:139]
 ds_read_b64_tr_b16 a[124:125], v5 offset:20480
 v_mfma_f32_16x16x32_bf16 v[136:139], a[104:107], a[48:51], v[136:139]
 ds_read_b64_tr_b16 a[126:127], v5 offset:28672
 v_mfma_f32_16x16x32_bf16 v[132:135], a[104:107], a[40:43], v[132:135]
 v_mfma_f32_16x16x32_bf16 v[132:135], a[108:111], a[44:47], v[132:135]
 v_mfma_f32_16x16x32_bf16 v[128:131], a[108:111], a[36:39], v[128:131]
 v_mfma_f32_16x16x32_bf16 v[128:131], a[104:107], a[32:35], v[128:131]
 s_waitcnt lgkmcnt(4)
 v_mfma_f32_16x16x32_bf16 v[112:115], a[112:115], a[64:67], v[112:115]
 ds_read_b64_tr_b16 a[96:97], v52 offset:16384
 v_mfma_f32_16x16x32_bf16 v[112:115], a[116:119], a[68:71], v[112:115]
 ds_read_b64_tr_b16 a[98:99], v52 offset:20480
 v_mfma_f32_16x16x32_bf16 v[116:119], a[116:119], a[76:79], v[116:119]
 ds_read_b64_tr_b16 a[100:101], v52 offset:24576
 v_mfma_f32_16x16x32_bf16 v[116:119], a[112:115], a[72:75], v[116:119]
 ds_read_b64_tr_b16 a[102:103], v52 offset:28672
 v_mfma_f32_16x16x32_bf16 v[120:123], a[112:115], a[80:83], v[120:123]
 v_mfma_f32_16x16x32_bf16 v[120:123], a[116:119], a[84:87], v[120:123]
 v_mfma_f32_16x16x32_bf16 v[124:127], a[116:119], a[92:95], v[124:127]
 v_mfma_f32_16x16x32_bf16 v[124:127], a[112:115], a[88:91], v[124:127]
 s_waitcnt lgkmcnt(4)
 v_mfma_f32_16x16x32_bf16 v[140:143], a[120:123], a[88:91], v[140:143]
 ds_read_b64_tr_b16 a[104:105], v53 offset:16384
 v_mfma_f32_16x16x32_bf16 v[140:143], a[124:127], a[92:95], v[140:143]
 ds_read_b64_tr_b16 a[106:107], v53 offset:20480
 v_mfma_f32_16x16x32_bf16 v[136:139], a[124:127], a[84:87], v[136:139]
 ds_read_b64_tr_b16 a[108:109], v53 offset:24576
 v_mfma_f32_16x16x32_bf16 v[136:139], a[120:123], a[80:83], v[136:139]
 ds_read_b64_tr_b16 a[110:111], v53 offset:28672
 v_mfma_f32_16x16x32_bf16 v[132:135], a[120:123], a[72:75], v[132:135]
 s_waitcnt vmcnt(0)
 buffer_store_dword v1, v2, s[20:23], s41 offen offset:0 sc1
 v_mfma_f32_16x16x32_bf16 v[132:135], a[124:127], a[76:79], v[132:135]
 v_mfma_f32_16x16x32_bf16 v[128:131], a[124:127], a[68:71], v[128:131]
 v_mfma_f32_16x16x32_bf16 v[128:131], a[120:123], a[64:67], v[128:131]
 s_waitcnt lgkmcnt(4)
 v_mfma_f32_16x16x32_bf16 v[144:147], a[96:99], a[128:131], v[144:147]
 ds_read_b64_tr_b16 a[112:113], v52 offset:32768
 v_cvt_pk_bf16_f32 v124, v124, v125
 v_mfma_f32_16x16x32_bf16 v[144:147], a[100:103], a[132:135], v[144:147]
 ds_read_b64_tr_b16 a[114:115], v52 offset:36864
 v_cvt_pk_bf16_f32 v125, v126, v127
 v_mfma_f32_16x16x32_bf16 v[148:151], a[100:103], a[140:143], v[148:151]
 ds_read_b64_tr_b16 a[116:117], v52 offset:40960
 v_cvt_pk_bf16_f32 v126, v140, v141
 v_mfma_f32_16x16x32_bf16 v[148:151], a[96:99], a[136:139], v[148:151]
 ds_read_b64_tr_b16 a[118:119], v52 offset:45056
 v_cvt_pk_bf16_f32 v127, v142, v143
 v_mfma_f32_16x16x32_bf16 v[152:155], a[96:99], a[144:147], v[152:155]
 buffer_store_dwordx4 v[124:127], v8, s[20:23], s5 offen offset:3072 sc1
 v_cvt_pk_bf16_f32 v120, v120, v121
 v_mfma_f32_16x16x32_bf16 v[152:155], a[100:103], a[148:151], v[152:155]
 v_cvt_pk_bf16_f32 v121, v122, v123
 v_cvt_pk_bf16_f32 v122, v136, v137
 v_mfma_f32_16x16x32_bf16 v[156:159], a[100:103], a[156:159], v[156:159]
 v_cvt_pk_bf16_f32 v123, v138, v139
 v_cvt_pk_bf16_f32 v116, v116, v117
 v_mfma_f32_16x16x32_bf16 v[156:159], a[96:99], a[152:155], v[156:159]
 buffer_store_dwordx4 v[120:123], v8, s[20:23], s5 offen offset:2048 sc1
 s_waitcnt lgkmcnt(4)
 v_mfma_f32_16x16x32_bf16 v[172:175], a[104:107], a[152:155], v[172:175]
 ds_read_b64_tr_b16 a[120:121], v53 offset:32768
 v_cvt_pk_bf16_f32 v117, v118, v119
 v_mfma_f32_16x16x32_bf16 v[172:175], a[108:111], a[156:159], v[172:175]
 ds_read_b64_tr_b16 a[122:123], v53 offset:36864
 v_cvt_pk_bf16_f32 v118, v132, v133
 v_mfma_f32_16x16x32_bf16 v[168:171], a[108:111], a[148:151], v[168:171]
 ds_read_b64_tr_b16 a[124:125], v53 offset:40960
 v_cvt_pk_bf16_f32 v119, v134, v135
 v_mfma_f32_16x16x32_bf16 v[168:171], a[104:107], a[144:147], v[168:171]
 ds_read_b64_tr_b16 a[126:127], v53 offset:45056
 v_cvt_pk_bf16_f32 v112, v112, v113
 v_mfma_f32_16x16x32_bf16 v[164:167], a[104:107], a[136:139], v[164:167]
 buffer_store_dwordx4 v[116:119], v8, s[20:23], s5 offen offset:1024 sc1
 v_cvt_pk_bf16_f32 v113, v114, v115
 v_mfma_f32_16x16x32_bf16 v[164:167], a[108:111], a[140:143], v[164:167]
 v_cvt_pk_bf16_f32 v114, v128, v129
 v_cvt_pk_bf16_f32 v115, v130, v131
 v_mfma_f32_16x16x32_bf16 v[160:163], a[108:111], a[132:135], v[160:163]
 buffer_store_dwordx4 v[112:115], v8, s[20:23], s5 offen offset:0 sc1
 v_mfma_f32_16x16x32_bf16 v[160:163], a[104:107], a[128:131], v[160:163]
 s_waitcnt lgkmcnt(4)
 v_mfma_f32_16x16x32_bf16 v[144:147], a[112:115], a[160:163], v[144:147]
 ds_read_b64_tr_b16 a[96:97], v52 offset:49152
 v_mfma_f32_16x16x32_bf16 v[144:147], a[116:119], a[164:167], v[144:147]
 ds_read_b64_tr_b16 a[98:99], v52 offset:53248
 v_mfma_f32_16x16x32_bf16 v[148:151], a[116:119], a[172:175], v[148:151]
 ds_read_b64_tr_b16 a[100:101], v52 offset:57344
 v_mfma_f32_16x16x32_bf16 v[148:151], a[112:115], a[168:171], v[148:151]
 ds_read_b64_tr_b16 a[102:103], v52 offset:61440
 v_mfma_f32_16x16x32_bf16 v[152:155], a[112:115], a[176:179], v[152:155]
 v_mfma_f32_16x16x32_bf16 v[152:155], a[116:119], a[180:183], v[152:155]
 v_mfma_f32_16x16x32_bf16 v[156:159], a[116:119], a[188:191], v[156:159]
 v_mfma_f32_16x16x32_bf16 v[156:159], a[112:115], a[184:187], v[156:159]
 s_waitcnt lgkmcnt(4)
 v_mfma_f32_16x16x32_bf16 v[172:175], a[120:123], a[184:187], v[172:175]
 ds_read_b64_tr_b16 a[104:105], v53 offset:49152
 v_mfma_f32_16x16x32_bf16 v[172:175], a[124:127], a[188:191], v[172:175]
 ds_read_b64_tr_b16 a[106:107], v53 offset:53248
 v_mfma_f32_16x16x32_bf16 v[168:171], a[124:127], a[180:183], v[168:171]
 ds_read_b64_tr_b16 a[108:109], v53 offset:57344
 v_mfma_f32_16x16x32_bf16 v[168:171], a[120:123], a[176:179], v[168:171]
 ds_read_b64_tr_b16 a[110:111], v53 offset:61440
 v_mfma_f32_16x16x32_bf16 v[164:167], a[120:123], a[168:171], v[164:167]
 v_mfma_f32_16x16x32_bf16 v[164:167], a[124:127], a[172:175], v[164:167]
 v_mfma_f32_16x16x32_bf16 v[160:163], a[124:127], a[164:167], v[160:163]
 v_mfma_f32_16x16x32_bf16 v[160:163], a[120:123], a[160:163], v[160:163]
 s_waitcnt lgkmcnt(4)
 v_mfma_f32_16x16x32_bf16 v[144:147], a[96:99], a[0:3], v[144:147]
 ds_read_b64_tr_b16 a[112:113], v6 offset:0
 v_mfma_f32_16x16x32_bf16 v[144:147], a[100:103], a[4:7], v[144:147]
 ds_read_b64_tr_b16 a[114:115], v6 offset:8192
 v_mfma_f32_16x16x32_bf16 v[148:151], a[100:103], a[12:15], v[148:151]
 ds_read_b64_tr_b16 a[116:117], v6 offset:16384
 v_mfma_f32_16x16x32_bf16 v[148:151], a[96:99], a[8:11], v[148:151]
 ds_read_b64_tr_b16 a[118:119], v6 offset:24576
 v_mfma_f32_16x16x32_bf16 v[152:155], a[96:99], a[16:19], v[152:155]
 v_mfma_f32_16x16x32_bf16 v[152:155], a[100:103], a[20:23], v[152:155]
 v_mfma_f32_16x16x32_bf16 v[156:159], a[100:103], a[28:31], v[156:159]
 v_mfma_f32_16x16x32_bf16 v[156:159], a[96:99], a[24:27], v[156:159]
 s_waitcnt lgkmcnt(4)
 v_mfma_f32_16x16x32_bf16 v[172:175], a[104:107], a[24:27], v[172:175]
 ds_read_b64_tr_b16 a[120:121], v7 offset:0
 v_mfma_f32_16x16x32_bf16 v[172:175], a[108:111], a[28:31], v[172:175]
 ds_read_b64_tr_b16 a[122:123], v7 offset:8192
 v_mfma_f32_16x16x32_bf16 v[168:171], a[108:111], a[20:23], v[168:171]
 ds_read_b64_tr_b16 a[124:125], v7 offset:16384
 v_mfma_f32_16x16x32_bf16 v[168:171], a[104:107], a[16:19], v[168:171]
 ds_read_b64_tr_b16 a[126:127], v7 offset:24576
 v_mfma_f32_16x16x32_bf16 v[164:167], a[104:107], a[8:11], v[164:167]
 v_mfma_f32_16x16x32_bf16 v[164:167], a[108:111], a[12:15], v[164:167]
 v_mfma_f32_16x16x32_bf16 v[160:163], a[108:111], a[4:7], v[160:163]
 v_mfma_f32_16x16x32_bf16 v[160:163], a[104:107], a[0:3], v[160:163]
 s_waitcnt lgkmcnt(4)
 v_mfma_f32_16x16x32_bf16 v[144:147], a[112:115], a[32:35], v[144:147]
 ds_read_b64_tr_b16 a[96:97], v6 offset:4096
 v_mfma_f32_16x16x32_bf16 v[144:147], a[116:119], a[36:39], v[144:147]
 ds_read_b64_tr_b16 a[98:99], v6 offset:12288
 v_mfma_f32_16x16x32_bf16 v[148:151], a[116:119], a[44:47], v[148:151]
 ds_read_b64_tr_b16 a[100:101], v6 offset:20480
 v_mfma_f32_16x16x32_bf16 v[148:151], a[112:115], a[40:43], v[148:151]
 ds_read_b64_tr_b16 a[102:103], v6 offset:28672
 v_mfma_f32_16x16x32_bf16 v[152:155], a[112:115], a[48:51], v[152:155]
 v_mfma_f32_16x16x32_bf16 v[152:155], a[116:119], a[52:55], v[152:155]
 v_mfma_f32_16x16x32_bf16 v[156:159], a[116:119], a[60:63], v[156:159]
 v_mfma_f32_16x16x32_bf16 v[156:159], a[112:115], a[56:59], v[156:159]
 s_waitcnt lgkmcnt(4)
 v_mfma_f32_16x16x32_bf16 v[172:175], a[120:123], a[56:59], v[172:175]
 ds_read_b64_tr_b16 a[104:105], v7 offset:4096
 v_mfma_f32_16x16x32_bf16 v[172:175], a[124:127], a[60:63], v[172:175]
 ds_read_b64_tr_b16 a[106:107], v7 offset:12288
 v_mfma_f32_16x16x32_bf16 v[168:171], a[124:127], a[52:55], v[168:171]
 ds_read_b64_tr_b16 a[108:109], v7 offset:20480
 v_mfma_f32_16x16x32_bf16 v[168:171], a[120:123], a[48:51], v[168:171]
 ds_read_b64_tr_b16 a[110:111], v7 offset:28672
 v_mfma_f32_16x16x32_bf16 v[164:167], a[120:123], a[40:43], v[164:167]
 v_mfma_f32_16x16x32_bf16 v[164:167], a[124:127], a[44:47], v[164:167]
 v_mfma_f32_16x16x32_bf16 v[160:163], a[124:127], a[36:39], v[160:163]
 buffer_load_dword v17, v78, s[20:23], s87 offen sc1
 v_mfma_f32_16x16x32_bf16 v[160:163], a[120:123], a[32:35], v[160:163]
 s_waitcnt lgkmcnt(4)
 v_mfma_f32_16x16x32_bf16 v[144:147], a[96:99], a[64:67], v[144:147]
 ds_read_b64_tr_b16 a[112:113], v54 offset:16384
 v_mfma_f32_16x16x32_bf16 v[144:147], a[100:103], a[68:71], v[144:147]
 ds_read_b64_tr_b16 a[114:115], v54 offset:20480
 v_mfma_f32_16x16x32_bf16 v[148:151], a[100:103], a[76:79], v[148:151]
 ds_read_b64_tr_b16 a[116:117], v54 offset:24576
 v_mfma_f32_16x16x32_bf16 v[148:151], a[96:99], a[72:75], v[148:151]
 ds_read_b64_tr_b16 a[118:119], v54 offset:28672
 v_mfma_f32_16x16x32_bf16 v[152:155], a[96:99], a[80:83], v[152:155]
 v_mfma_f32_16x16x32_bf16 v[152:155], a[100:103], a[84:87], v[152:155]
 v_mfma_f32_16x16x32_bf16 v[156:159], a[100:103], a[92:95], v[156:159]
 v_mfma_f32_16x16x32_bf16 v[156:159], a[96:99], a[88:91], v[156:159]
 s_waitcnt lgkmcnt(4)
 v_mfma_f32_16x16x32_bf16 v[172:175], a[104:107], a[88:91], v[172:175]
 ds_read_b64_tr_b16 a[120:121], v55 offset:16384
 v_mfma_f32_16x16x32_bf16 v[172:175], a[108:111], a[92:95], v[172:175]
 ds_read_b64_tr_b16 a[122:123], v55 offset:20480
 v_mfma_f32_16x16x32_bf16 v[168:171], a[108:111], a[84:87], v[168:171]
 ds_read_b64_tr_b16 a[124:125], v55 offset:24576
 v_mfma_f32_16x16x32_bf16 v[168:171], a[104:107], a[80:83], v[168:171]
 ds_read_b64_tr_b16 a[126:127], v55 offset:28672
 v_mfma_f32_16x16x32_bf16 v[164:167], a[104:107], a[72:75], v[164:167]
 s_waitcnt vmcnt(1)
 buffer_store_dword v1, v2, s[20:23], s42 offen offset:128 sc1
 v_mfma_f32_16x16x32_bf16 v[164:167], a[108:111], a[76:79], v[164:167]
 v_mfma_f32_16x16x32_bf16 v[160:163], a[108:111], a[68:71], v[160:163]
 v_mfma_f32_16x16x32_bf16 v[160:163], a[104:107], a[64:67], v[160:163]
 s_waitcnt lgkmcnt(4)
 v_mfma_f32_16x16x32_bf16 v[176:179], a[112:115], a[128:131], v[176:179]
 ds_read_b64_tr_b16 a[96:97], v54 offset:32768
 v_cvt_pk_bf16_f32 v156, v156, v157
 v_mfma_f32_16x16x32_bf16 v[176:179], a[116:119], a[132:135], v[176:179]
 ds_read_b64_tr_b16 a[98:99], v54 offset:36864
 v_cvt_pk_bf16_f32 v157, v158, v159
 v_mfma_f32_16x16x32_bf16 v[180:183], a[116:119], a[140:143], v[180:183]
 ds_read_b64_tr_b16 a[100:101], v54 offset:40960
 v_cvt_pk_bf16_f32 v158, v172, v173
 v_mfma_f32_16x16x32_bf16 v[180:183], a[112:115], a[136:139], v[180:183]
 ds_read_b64_tr_b16 a[102:103], v54 offset:45056
 v_cvt_pk_bf16_f32 v159, v174, v175
 v_mfma_f32_16x16x32_bf16 v[184:187], a[112:115], a[144:147], v[184:187]
 buffer_store_dwordx4 v[156:159], v8, s[20:23], s6 offen offset:3072 sc1
 v_cvt_pk_bf16_f32 v152, v152, v153
 v_mfma_f32_16x16x32_bf16 v[184:187], a[116:119], a[148:151], v[184:187]
 v_cvt_pk_bf16_f32 v153, v154, v155
 v_cvt_pk_bf16_f32 v154, v168, v169
 v_mfma_f32_16x16x32_bf16 v[188:191], a[116:119], a[156:159], v[188:191]
 v_cvt_pk_bf16_f32 v155, v170, v171
 v_cvt_pk_bf16_f32 v148, v148, v149
 v_mfma_f32_16x16x32_bf16 v[188:191], a[112:115], a[152:155], v[188:191]
 buffer_store_dwordx4 v[152:155], v8, s[20:23], s6 offen offset:2048 sc1
 s_waitcnt lgkmcnt(4)
 v_mfma_f32_16x16x32_bf16 v[204:207], a[120:123], a[152:155], v[204:207]
 ds_read_b64_tr_b16 a[104:105], v55 offset:32768
 v_cvt_pk_bf16_f32 v149, v150, v151
 v_mfma_f32_16x16x32_bf16 v[204:207], a[124:127], a[156:159], v[204:207]
 ds_read_b64_tr_b16 a[106:107], v55 offset:36864
 v_cvt_pk_bf16_f32 v150, v164, v165
 v_mfma_f32_16x16x32_bf16 v[200:203], a[124:127], a[148:151], v[200:203]
 ds_read_b64_tr_b16 a[108:109], v55 offset:40960
 v_cvt_pk_bf16_f32 v151, v166, v167
 v_mfma_f32_16x16x32_bf16 v[200:203], a[120:123], a[144:147], v[200:203]
 ds_read_b64_tr_b16 a[110:111], v55 offset:45056
 v_cvt_pk_bf16_f32 v144, v144, v145
 v_mfma_f32_16x16x32_bf16 v[196:199], a[120:123], a[136:139], v[196:199]
 buffer_store_dwordx4 v[148:151], v8, s[20:23], s6 offen offset:1024 sc1
 v_cvt_pk_bf16_f32 v145, v146, v147
 v_mfma_f32_16x16x32_bf16 v[196:199], a[124:127], a[140:143], v[196:199]
 v_cvt_pk_bf16_f32 v146, v160, v161
 v_cvt_pk_bf16_f32 v147, v162, v163
 v_mfma_f32_16x16x32_bf16 v[192:195], a[124:127], a[132:135], v[192:195]
 buffer_store_dwordx4 v[144:147], v8, s[20:23], s6 offen offset:0 sc1
 v_mfma_f32_16x16x32_bf16 v[192:195], a[120:123], a[128:131], v[192:195]
 s_waitcnt lgkmcnt(4)
 v_mfma_f32_16x16x32_bf16 v[176:179], a[96:99], a[160:163], v[176:179]
 ds_read_b64_tr_b16 a[112:113], v54 offset:49152
 v_mfma_f32_16x16x32_bf16 v[176:179], a[100:103], a[164:167], v[176:179]
 ds_read_b64_tr_b16 a[114:115], v54 offset:53248
 v_mfma_f32_16x16x32_bf16 v[180:183], a[100:103], a[172:175], v[180:183]
 ds_read_b64_tr_b16 a[116:117], v54 offset:57344
 s_waitcnt vmcnt(5)
 v_cmp_le_u32 vcc, 1, v17
 v_mfma_f32_16x16x32_bf16 v[180:183], a[96:99], a[168:171], v[180:183]
 ds_read_b64_tr_b16 a[118:119], v54 offset:61440
 s_and_b32 s60, vcc_lo, 1
 s_andn2_b32 s61, s61, s60
 v_mfma_f32_16x16x32_bf16 v[184:187], a[96:99], a[176:179], v[184:187]
 v_mfma_f32_16x16x32_bf16 v[184:187], a[100:103], a[180:183], v[184:187]
 s_bitcmp1_b32 s60, 0
 s_cselect_b32 s14, 0x10000000, 0
 v_mfma_f32_16x16x32_bf16 v[188:191], a[100:103], a[188:191], v[188:191]
 buffer_load_dwordx4 v[208:211], v8, s[12:15], s52 offen offset:0 sc1
 v_mfma_f32_16x16x32_bf16 v[188:191], a[96:99], a[184:187], v[188:191]
 s_waitcnt lgkmcnt(4)
 v_mfma_f32_16x16x32_bf16 v[204:207], a[104:107], a[184:187], v[204:207]
 ds_read_b64_tr_b16 a[120:121], v55 offset:49152
 v_mfma_f32_16x16x32_bf16 v[204:207], a[108:111], a[188:191], v[204:207]
 ds_read_b64_tr_b16 a[122:123], v55 offset:53248
 v_mfma_f32_16x16x32_bf16 v[200:203], a[108:111], a[180:183], v[200:203]
 ds_read_b64_tr_b16 a[124:125], v55 offset:57344
 v_mfma_f32_16x16x32_bf16 v[200:203], a[104:107], a[176:179], v[200:203]
 ds_read_b64_tr_b16 a[126:127], v55 offset:61440
 v_mfma_f32_16x16x32_bf16 v[196:199], a[104:107], a[168:171], v[196:199]
 buffer_load_dwordx4 v[212:215], v8, s[12:15], s52 offen offset:1024 sc1
 v_mfma_f32_16x16x32_bf16 v[196:199], a[108:111], a[172:175], v[196:199]
 v_mfma_f32_16x16x32_bf16 v[192:195], a[108:111], a[164:167], v[192:195]
 buffer_load_dwordx4 v[216:219], v8, s[12:15], s52 offen offset:2048 sc1
 v_mfma_f32_16x16x32_bf16 v[192:195], a[104:107], a[160:163], v[192:195]
 s_waitcnt lgkmcnt(4)
 v_mfma_f32_16x16x32_bf16 v[176:179], a[112:115], a[0:3], v[176:179]
 ds_read_b64_tr_b16 a[96:97], v9 offset:0
 v_mfma_f32_16x16x32_bf16 v[176:179], a[116:119], a[4:7], v[176:179]
 ds_read_b64_tr_b16 a[98:99], v9 offset:8192
 v_mfma_f32_16x16x32_bf16 v[180:183], a[116:119], a[12:15], v[180:183]
 ds_read_b64_tr_b16 a[100:101], v9 offset:16384
 v_mfma_f32_16x16x32_bf16 v[180:183], a[112:115], a[8:11], v[180:183]
 ds_read_b64_tr_b16 a[102:103], v9 offset:24576
 v_mfma_f32_16x16x32_bf16 v[184:187], a[112:115], a[16:19], v[184:187]
 buffer_load_dwordx4 v[220:223], v8, s[12:15], s52 offen offset:3072 sc1
 v_mfma_f32_16x16x32_bf16 v[184:187], a[116:119], a[20:23], v[184:187]
 v_mfma_f32_16x16x32_bf16 v[188:191], a[116:119], a[28:31], v[188:191]
 v_mfma_f32_16x16x32_bf16 v[188:191], a[112:115], a[24:27], v[188:191]
 s_waitcnt lgkmcnt(4)
 v_mfma_f32_16x16x32_bf16 v[204:207], a[120:123], a[24:27], v[204:207]
 ds_read_b64_tr_b16 a[104:105], v10 offset:0
 v_mfma_f32_16x16x32_bf16 v[204:207], a[124:127], a[28:31], v[204:207]
 ds_read_b64_tr_b16 a[106:107], v10 offset:8192
 v_mfma_f32_16x16x32_bf16 v[200:203], a[124:127], a[20:23], v[200:203]
 ds_read_b64_tr_b16 a[108:109], v10 offset:16384
 v_mfma_f32_16x16x32_bf16 v[200:203], a[120:123], a[16:19], v[200:203]
 ds_read_b64_tr_b16 a[110:111], v10 offset:24576
 v_mfma_f32_16x16x32_bf16 v[196:199], a[120:123], a[8:11], v[196:199]
 v_mfma_f32_16x16x32_bf16 v[196:199], a[124:127], a[12:15], v[196:199]
 v_mfma_f32_16x16x32_bf16 v[192:195], a[124:127], a[4:7], v[192:195]
 v_mfma_f32_16x16x32_bf16 v[192:195], a[120:123], a[0:3], v[192:195]
 s_waitcnt lgkmcnt(4)
 v_mfma_f32_16x16x32_bf16 v[176:179], a[96:99], a[32:35], v[176:179]
 ds_read_b64_tr_b16 a[112:113], v9 offset:4096
 v_mfma_f32_16x16x32_bf16 v[176:179], a[100:103], a[36:39], v[176:179]
 ds_read_b64_tr_b16 a[114:115], v9 offset:12288
 v_mfma_f32_16x16x32_bf16 v[180:183], a[100:103], a[44:47], v[180:183]
 ds_read_b64_tr_b16 a[116:117], v9 offset:20480
 v_mfma_f32_16x16x32_bf16 v[180:183], a[96:99], a[40:43], v[180:183]
 ds_read_b64_tr_b16 a[118:119], v9 offset:28672
 v_mfma_f32_16x16x32_bf16 v[184:187], a[96:99], a[48:51], v[184:187]
 v_mfma_f32_16x16x32_bf16 v[184:187], a[100:103], a[52:55], v[184:187]
 v_mfma_f32_16x16x32_bf16 v[188:191], a[100:103], a[60:63], v[188:191]
 v_mfma_f32_16x16x32_bf16 v[188:191], a[96:99], a[56:59], v[188:191]
 s_waitcnt lgkmcnt(4)
 v_mfma_f32_16x16x32_bf16 v[204:207], a[104:107], a[56:59], v[204:207]
 ds_read_b64_tr_b16 a[120:121], v10 offset:4096
 v_mfma_f32_16x16x32_bf16 v[204:207], a[108:111], a[60:63], v[204:207]
 ds_read_b64_tr_b16 a[122:123], v10 offset:12288
 v_mfma_f32_16x16x32_bf16 v[200:203], a[108:111], a[52:55], v[200:203]
 ds_read_b64_tr_b16 a[124:125], v10 offset:20480
 v_mfma_f32_16x16x32_bf16 v[200:203], a[104:107], a[48:51], v[200:203]
 ds_read_b64_tr_b16 a[126:127], v10 offset:28672
 v_mfma_f32_16x16x32_bf16 v[196:199], a[104:107], a[40:43], v[196:199]
 v_mfma_f32_16x16x32_bf16 v[196:199], a[108:111], a[44:47], v[196:199]
 v_mfma_f32_16x16x32_bf16 v[192:195], a[108:111], a[36:39], v[192:195]
 v_mfma_f32_16x16x32_bf16 v[192:195], a[104:107], a[32:35], v[192:195]
 s_waitcnt lgkmcnt(4)
 v_mfma_f32_16x16x32_bf16 v[176:179], a[112:115], a[64:67], v[176:179]
 buffer_load_dword v17, v78, s[20:23], s87 offen sc1
 v_mfma_f32_16x16x32_bf16 v[176:179], a[116:119], a[68:71], v[176:179]
 v_mfma_f32_16x16x32_bf16 v[180:183], a[116:119], a[76:79], v[180:183]
 v_mfma_f32_16x16x32_bf16 v[180:183], a[112:115], a[72:75], v[180:183]
 v_mfma_f32_16x16x32_bf16 v[184:187], a[112:115], a[80:83], v[184:187]
 v_mfma_f32_16x16x32_bf16 v[184:187], a[116:119], a[84:87], v[184:187]
 v_mfma_f32_16x16x32_bf16 v[188:191], a[116:119], a[92:95], v[188:191]
 v_mfma_f32_16x16x32_bf16 v[188:191], a[112:115], a[88:91], v[188:191]
 s_waitcnt lgkmcnt(0)
 v_mfma_f32_16x16x32_bf16 v[204:207], a[120:123], a[88:91], v[204:207]
 v_mfma_f32_16x16x32_bf16 v[204:207], a[124:127], a[92:95], v[204:207]
 v_mfma_f32_16x16x32_bf16 v[200:203], a[124:127], a[84:87], v[200:203]
 v_mfma_f32_16x16x32_bf16 v[200:203], a[120:123], a[80:83], v[200:203]
 v_mfma_f32_16x16x32_bf16 v[196:199], a[120:123], a[72:75], v[196:199]
 s_waitcnt vmcnt(5)
 buffer_store_dword v1, v2, s[20:23], s34 offen offset:256 sc1
 v_mfma_f32_16x16x32_bf16 v[196:199], a[124:127], a[76:79], v[196:199]
 v_mfma_f32_16x16x32_bf16 v[192:195], a[124:127], a[68:71], v[192:195]
 v_mfma_f32_16x16x32_bf16 v[192:195], a[120:123], a[64:67], v[192:195]
 s_mov_b32 s99, 0
 s_waitcnt vmcnt(1)
L_xtop:
 v_cmp_le_u32 vcc, 1, v17
 s_cmp_lt_u32 s99, 131072
 s_cselect_b32 s3, 0, 7
 s_or_b32 s60, vcc_lo, s3
 s_and_b32 s60, s60, s61
 s_bitcmp1_b32 s60, 0
 s_cbranch_scc0 L_xe_n0
 buffer_load_dwordx4 v[208:211], v8, s[20:23], s52 offen offset:0 sc1
 buffer_load_dwordx4 v[212:215], v8, s[20:23], s52 offen offset:1024 sc1
 buffer_load_dwordx4 v[216:219], v8, s[20:23], s52 offen offset:2048 sc1
 buffer_load_dwordx4 v[220:223], v8, s[20:23], s52 offen offset:3072 sc1
L_xe_n0:
 s_bitcmp1_b32 s60, 1
 s_cbranch_scc0 L_xe_n1
 buffer_load_dwordx4 v[224:227], v8, s[20:23], s53 offen offset:0 sc1
 buffer_load_dwordx4 v[228:231], v8, s[20:23], s53 offen offset:1024 sc1
 buffer_load_dwordx4 v[232:235], v8, s[20:23], s53 offen offset:2048 sc1
 buffer_load_dwordx4 v[236:239], v8, s[20:23], s53 offen offset:3072 sc1
L_xe_n1:
 s_bitcmp1_b32 s60, 2
 s_cbranch_scc0 L_xe_n2
 buffer_load_dwordx4 v[240:243], v8, s[20:23], s7 offen offset:0 sc1
 buffer_load_dwordx4 v[244:247], v8, s[20:23], s7 offen offset:1024 sc1
 buffer_load_dwordx4 v[248:251], v8, s[20:23], s7 offen offset:2048 sc1
 buffer_load_dwordx4 v[252:255], v8, s[20:23], s7 offen offset:3072 sc1
L_xe_n2:
 s_andn2_b32 s61, s61, s60
 s_cmp_eq_u32 s61, 0
 s_cbranch_scc1 L_xdone
 s_sleep 1
 buffer_load_dword v17, v78, s[20:23], s87 offen sc1
 s_add_u32 s99, s99, 1
 s_waitcnt vmcnt(0)
 s_branch L_xtop
L_xdone:
 s_and_b32 s3, s60, 3
 s_cmp_eq_u32 s3, 0
 s_cbranch_scc1 L_xadd
 s_waitcnt vmcnt(0)
L_xadd:
 v_lshlrev_b32 v56, 16, v208
 v_and_b32 v57, 0xffff0000, v208
 v_lshlrev_b32 v58, 16, v209
 v_and_b32 v59, 0xffff0000, v209
 v_lshlrev_b32 v60, 16, v210
 v_and_b32 v61, 0xffff0000, v210
 v_lshlrev_b32 v62, 16, v211
 v_and_b32 v63, 0xffff0000, v211
 v_pk_add_f32 v[176:177], v[176:177], v[56:57]
 v_pk_add_f32 v[178:179], v[178:179], v[58:59]
 v_pk_add_f32 v[192:193], v[192:193], v[60:61]
 v_pk_add_f32 v[194:195], v[194:195], v[62:63]
 v_lshlrev_b32 v56, 16, v212
 v_and_b32 v57, 0xffff0000, v212
 v_lshlrev_b32 v58, 16, v213
 v_and_b32 v59, 0xffff0000, v213
 v_lshlrev_b32 v60, 16, v214
 v_and_b32 v61, 0xffff0000, v214
 v_lshlrev_b32 v62, 16, v215
 v_and_b32 v63, 0xffff0000, v215
 v_pk_add_f32 v[180:181], v[180:181], v[56:57]
 v_pk_add_f32 v[182:183], v[182:183], v[58:59]
 v_pk_add_f32 v[196:197], v[196:197], v[60:61]
 v_pk_add_f32 v[198:199], v[198:199], v[62:63]
 v_lshlrev_b32 v56, 16, v216
 v_and_b32 v57, 0xffff0000, v216
 v_lshlrev_b32 v58, 16, v217
 v_and_b32 v59, 0xffff0000, v217
 v_lshlrev_b32 v60, 16, v218
 v_and_b32 v61, 0xffff0000, v218
 v_lshlrev_b32 v62, 16, v219
 v_and_b32 v63, 0xffff0000, v219
 v_pk_add_f32 v[184:185], v[184:185], v[56:57]
 v_pk_add_f32 v[186:187], v[186:187], v[58:59]
 v_pk_add_f32 v[200:201], v[200:201], v[60:61]
 v_pk_add_f32 v[202:203], v[202:203], v[62:63]
 v_lshlrev_b32 v56, 16, v220
 v_and_b32 v57, 0xffff0000, v220
 v_lshlrev_b32 v58, 16, v221
 v_and_b32 v59, 0xffff0000, v221
 v_lshlrev_b32 v60, 16, v222
 v_and_b32 v61, 0xffff0000, v222
 v_lshlrev_b32 v62, 16, v223
 v_and_b32 v63, 0xffff0000, v223
 v_pk_add_f32 v[188:189], v[188:189], v[56:57]
 v_pk_add_f32 v[190:191], v[190:191], v[58:59]
 v_pk_add_f32 v[204:205], v[204:205], v[60:61]
 v_pk_add_f32 v[206:207], v[206:207], v[62:63]
 v_lshlrev_b32 v56, 16, v224
 v_and_b32 v57, 0xffff0000, v224
 v_lshlrev_b32 v58, 16, v225
 v_and_b32 v59, 0xffff0000, v225
 v_lshlrev_b32 v60, 16, v226
 v_and_b32 v61, 0xffff0000, v226
 v_lshlrev_b32 v62, 16, v227
 v_and_b32 v63, 0xffff0000, v227
 v_pk_add_f32 v[176:177], v[176:177], v[56:57]
 v_pk_add_f32 v[178:179], v[178:179], v[58:59]
 v_pk_add_f32 v[192:193], v[192:193], v[60:61]
 v_pk_add_f32 v[194:195], v[194:195], v[62:63]
 v_lshlrev_b32 v56, 16, v228
 v_and_b32 v57, 0xffff0000, v228
 v_lshlrev_b32 v58, 16, v229
 v_and_b32 v59, 0xffff0000, v229
 v_lshlrev_b32 v60, 16, v230
 v_and_b32 v61, 0xffff0000, v230
 v_lshlrev_b32 v62, 16, v231
 v_and_b32 v63, 0xffff0000, v231
 v_pk_add_f32 v[180:181], v[180:181], v[56:57]
 v_pk_add_f32 v[182:183], v[182:183], v[58:59]
 v_pk_add_f32 v[196:197], v[196:197], v[60:61]
 v_pk_add_f32 v[198:199], v[198:199], v[62:63]
 v_lshlrev_b32 v56, 16, v232
 v_and_b32 v57, 0xffff0000, v232
 v_lshlrev_b32 v58, 16, v233
 v_and_b32 v59, 0xffff0000, v233
 v_lshlrev_b32 v60, 16, v234
 v_and_b32 v61, 0xffff0000, v234
 v_lshlrev_b32 v62, 16, v235
 v_and_b32 v63, 0xffff0000, v235
 v_pk_add_f32 v[184:185], v[184:185], v[56:57]
 v_pk_add_f32 v[186:187], v[186:187], v[58:59]
 v_pk_add_f32 v[200:201], v[200:201], v[60:61]
 v_pk_add_f32 v[202:203], v[202:203], v[62:63]
 v_lshlrev_b32 v56, 16, v236
 v_and_b32 v57, 0xffff0000, v236
 v_lshlrev_b32 v58, 16, v237
 v_and_b32 v59, 0xffff0000, v237
 v_lshlrev_b32 v60, 16, v238
 v_and_b32 v61, 0xffff0000, v238
 v_lshlrev_b32 v62, 16, v239
 v_and_b32 v63, 0xffff0000, v239
 v_pk_add_f32 v[188:189], v[188:189], v[56:57]
 v_pk_add_f32 v[190:191], v[190:191], v[58:59]
 v_pk_add_f32 v[204:205], v[204:205], v[60:61]
 v_pk_add_f32 v[206:207], v[206:207], v[62:63]
 s_waitcnt vmcnt(3)
 v_lshlrev_b32 v56, 16, v240
 v_and_b32 v57, 0xffff0000, v240
 v_lshlrev_b32 v58, 16, v241
 v_and_b32 v59, 0xffff0000, v241
 v_lshlrev_b32 v60, 16, v242
 v_and_b32 v61, 0xffff0000, v242
 v_lshlrev_b32 v62, 16, v243
 v_and_b32 v63, 0xffff0000, v243
 v_pk_add_f32 v[176:177], v[176:177], v[56:57]
 v_pk_add_f32 v[178:179], v[178:179], v[58:59]
 v_pk_add_f32 v[192:193], v[192:193], v[60:61]
 v_pk_add_f32 v[194:195], v[194:195], v[62:63]
 v_cvt_pk_bf16_f32 v176, v176, v177
 v_cvt_pk_bf16_f32 v177, v178, v179
 v_cvt_pk_bf16_f32 v178, v192, v193
 v_cvt_pk_bf16_f32 v179, v194, v195
 s_add_u32 s3, s35, 0
 v_permlane16_swap_b32 v176, v178
 v_permlane16_swap_b32 v177, v179
 buffer_store_dwordx4 v[176:179], v76, s[24:27], s3 offen
 s_waitcnt vmcnt(3)
 v_lshlrev_b32 v56, 16, v244
 v_and_b32 v57, 0xffff0000, v244
 v_lshlrev_b32 v58, 16, v245
 v_and_b32 v59, 0xffff0000, v245
 v_lshlrev_b32 v60, 16, v246
 v_and_b32 v61, 0xffff0000, v246
 v_lshlrev_b32 v62, 16, v247
 v_and_b32 v63, 0xffff0000, v247
 v_pk_add_f32 v[180:181], v[180:181], v[56:57]
 v_pk_add_f32 v[182:183], v[182:183], v[58:59]
 v_pk_add_f32 v[196:197], v[196:197], v[60:61]
 v_pk_add_f32 v[198:199], v[198:199], v[62:63]
 v_cvt_pk_bf16_f32 v180, v180, v181
 v_cvt_pk_bf16_f32 v181, v182, v183
 v_cvt_pk_bf16_f32 v182, v196, v197
 v_cvt_pk_bf16_f32 v183, v198, v199
 s_add_u32 s3, s35, 32768
 v_permlane16_swap_b32 v180, v182
 v_permlane16_swap_b32 v181, v183
 buffer_store_dwordx4 v[180:183], v76, s[24:27], s3 offen
 s_waitcnt vmcnt(3)
 v_lshlrev_b32 v56, 16, v248
 v_and_b32 v57, 0xffff0000, v248
 v_lshlrev_b32 v58, 16, v249
 v_and_b32 v59, 0xffff0000, v249
 v_lshlrev_b32 v60, 16, v250
 v_and_b32 v61, 0xffff0000, v250
 v_lshlrev_b32 v62, 16, v251
 v_and_b32 v63, 0xffff0000, v251
 v_pk_add_f32 v[184:185], v[184:185], v[56:57]
 v_pk_add_f32 v[186:187], v[186:187], v[58:59]
 v_pk_add_f32 v[200:201], v[200:201], v[60:61]
 v_pk_add_f32 v[202:203], v[202:203], v[62:63]
 v_cvt_pk_bf16_f32 v184, v184, v185
 v_cvt_pk_bf16_f32 v185, v186, v187
 v_cvt_pk_bf16_f32 v186, v200, v201
 v_cvt_pk_bf16_f32 v187, v202, v203
 s_add_u32 s3, s35, 65536
 v_permlane16_swap_b32 v184, v186
 v_permlane16_swap_b32 v185, v187
 buffer_store_dwordx4 v[184:187], v76, s[24:27], s3 offen
 s_waitcnt vmcnt(3)
 v_lshlrev_b32 v56, 16, v252
 v_and_b32 v57, 0xffff0000, v252
 v_lshlrev_b32 v58, 16, v253
 v_and_b32 v59, 0xffff0000, v253
 v_lshlrev_b32 v60, 16, v254
 v_and_b32 v61, 0xffff0000, v254
 v_lshlrev_b32 v62, 16, v255
 v_and_b32 v63, 0xffff0000, v255
 v_pk_add_f32 v[188:189], v[188:189], v[56:57]
 v_pk_add_f32 v[190:191], v[190:191], v[58:59]
 v_pk_add_f32 v[204:205], v[204:205], v[60:61]
 v_pk_add_f32 v[206:207], v[206:207], v[62:63]
 v_cvt_pk_bf16_f32 v188, v188, v189
 v_cvt_pk_bf16_f32 v189, v190, v191
 v_cvt_pk_bf16_f32 v190, v204, v205
 v_cvt_pk_bf16_f32 v191, v206, v207
 s_add_u32 s3, s35, 98304
 v_permlane16_swap_b32 v188, v190
 v_permlane16_swap_b32 v189, v191
 buffer_store_dwordx4 v[188:191], v76, s[24:27], s3 offen
 s_endpgm
L_capx:
 v_accvgpr_write_b32 a248, v1
 v_lshrrev_b32 v1, 1, v19
 v_xor_b32 v1, v1, v19
 v_lshlrev_b32 v1, 1, v1
 v_and_or_b32 v1, v19, 1, v1
 v_lshlrev_b32 v1, 3, v1
 v_xor_b32 v1, v1, v10
 v_xor_b32 v1, s71, v1
 ds_read_b64 a[192:193], v1 offset:0
 ds_read_b64 a[196:197], v1 offset:2048
 ds_read_b64 a[200:201], v1 offset:4096
 ds_read_b64 a[204:205], v1 offset:6144
 v_xor_b32 v1, 32, v1
 ds_read_b64 a[194:195], v1 offset:0
 ds_read_b64 a[198:199], v1 offset:2048
 ds_read_b64 a[202:203], v1 offset:4096
 ds_read_b64 a[206:207], v1 offset:6144
 v_accvgpr_read_b32 v1, a248
 s_waitcnt lgkmcnt(0)
 s_setpc_b64 s[0:1]
L_cap0:
 s_call_b64 s[0:1], L_capx
 s_branch L_capb0
L_cap1:
 s_call_b64 s[0:1], L_capx
 s_branch L_capb1
L_cap2:
 s_call_b64 s[0:1], L_capx
 s_branch L_capb2
L_cap3:
 s_call_b64 s[0:1], L_capx
 s_branch L_capb3
L_cap4:
 s_call_b64 s[0:1], L_capx
 s_branch L_capb4
L_cap5:
 s_call_b64 s[0:1], L_capx
 s_branch L_capb5
L_cap6:
 s_call_b64 s[0:1], L_capx
 s_branch L_capb6
L_cap7:
 s_call_b64 s[0:1], L_capx
 s_branch L_capb7
L_cap8:
 s_call_b64 s[0:1], L_capx
 s_branch L_capb8
L_cap9:
 s_call_b64 s[0:1], L_capx
 s_branch L_capb9
L_cap10:
 s_call_b64 s[0:1], L_capx
 s_branch L_capb10
L_cap11:
 s_call_b64 s[0:1], L_capx
 s_branch L_capb11
L_cap12:
 s_call_b64 s[0:1], L_capx
 s_branch L_capb12
L_ps_wait:
 s_mov_b32 s99, 0
L_ps_spin:
 s_sleep 16
 buffer_load_dword v43, v18, s[48:51], 0 offen sc1
 s_add_u32 s99, s99, 1
 s_waitcnt vmcnt(0)
 v_cmp_gt_u32 vcc, 32, v43
 s_nop 0
 s_cbranch_vccz L_ps_ok
 s_cmp_lt_u32 s99, 131072
 s_cbranch_scc1 L_ps_spin
 s_branch L_ps_ok
L_cap13:
 s_call_b64 s[0:1], L_capx
 s_branch L_capb13
L_cap14:
 s_call_b64 s[0:1], L_capx
 s_branch L_capb14
L_cap15:
 s_call_b64 s[0:1], L_capx
 s_branch L_capb15
L_phx_wait:
 s_mov_b32 s99, 0
L_phx_spin:
 s_sleep 1
 buffer_load_dword v7, off, s[24:27], s87 offset:384 sc1
 s_add_u32 s99, s99, 1
 s_waitcnt vmcnt(0)
 v_cmp_gt_u32 vcc, s48, v7
 s_nop 0
 s_cbranch_vccz L_phx_ok
 s_cmp_lt_u32 s99, 131072
 s_cbranch_scc1 L_phx_spin
 s_branch L_phx_ok
L_ph1_wait:
 s_mov_b32 s99, 0
L_ph1_spin:
 s_sleep 1
 buffer_load_dword v17, v18, s[20:23], s86 offen offset:0 sc1
 s_add_u32 s99, s99, 1
 s_waitcnt vmcnt(0)
 v_cmp_gt_u32 vcc, 1, v17
 s_nop 0
 s_cbranch_vccz L_ph1_ok
 s_cmp_lt_u32 s99, 131072
 s_cbranch_scc1 L_ph1_spin
 s_branch L_ph1_ok
L_ph2_wait:
 s_mov_b32 s99, 0
L_ph2_spin:
 s_sleep 1
 buffer_load_dword v17, v18, s[20:23], s86 offen offset:128 sc1
 s_add_u32 s99, s99, 1
 s_waitcnt vmcnt(0)
 v_cmp_gt_u32 vcc, 1, v17
 s_nop 0
 s_cbranch_vccz L_ph2_ok
 s_cmp_lt_u32 s99, 131072
 s_cbranch_scc1 L_ph2_spin
 s_branch L_ph2_ok
L_end:
 s_endpgm
.section .rodata,"a"
.p2align 6
.amdhsa_kernel parallel_sum__sliding_local_dilated__dense_activation_gelu__prompt_kernel
  .amdhsa_next_free_vgpr 512
  .amdhsa_next_free_sgpr 102
  .amdhsa_accum_offset 256
  .amdhsa_group_segment_fixed_size 0
  .amdhsa_kernarg_size 88
  .amdhsa_user_sgpr_count 2
  .amdhsa_user_sgpr_kernarg_segment_ptr 1
  .amdhsa_system_sgpr_workgroup_id_x 1
  .amdhsa_float_denorm_mode_32 3
.end_amdhsa_kernel
```
